```python
import torch

def _softmax(x, axis=-1):
    return torch.softmax(x, dim=axis)
def _gelu(x):
    return torch.nn.functional.gelu(x, approximate="tanh")
def _silu(x):
    return torch.nn.functional.silu(x)
def _sigmoid(x):
    return torch.sigmoid(x)
def _layernorm(x, axis=-1, eps=1e-5):
    m = x.mean(dim=axis, keepdim=True)
    v = x.var(dim=axis, keepdim=True, unbiased=False)
    return (x - m) / torch.sqrt(v + eps)
def _scatter_add(tgt, idx, src, axis=0):
    return tgt.clone().index_add_(axis, idx, src)
def _segment_sum(src, seg, n):
    out = torch.zeros((n,) + src.shape[1:], dtype=src.dtype)
    return out.index_add_(0, seg, src)
def _pad(x, pw):
    flat = tuple(v for pair in reversed(pw) for v in pair)
    return torch.nn.functional.pad(x, flat)

kernel_name = 'standalone__mha_block_cached__near_ridge'

def setup_inputs():

    _w = (lambda a: (lambda t: t.to(torch.bfloat16) if t.is_floating_point() else t)(torch.as_tensor(a)))
    B, Sq, D = 8, 208, 512
    H, Sk, Dh = 32, 512, 128
    return {
        "x": _w((lambda *s: torch.randn(*s, dtype=torch.bfloat16) * 0.8)(B, Sq, D)),
        "k_cache": _w((lambda *s: torch.randn(*s, dtype=torch.bfloat16) * 0.8)(B, H, Sk, Dh)),
        "v_cache": _w((lambda *s: torch.randn(*s, dtype=torch.bfloat16) * 0.05)(B, H, Sk, Dh)),
        "wq": _w((lambda *s: torch.randn(*s, dtype=torch.bfloat16) * 0.8)(D, H * Dh) * (D ** -0.5)),
        "wo": _w((lambda *s: torch.randn(*s, dtype=torch.bfloat16) * 0.05)(H * Dh, D) * ((H * Dh) ** -0.5)),
    }

def reference(x, k_cache, v_cache, wq, wo):
    B, Sq, D = x.shape
    H, Dh = 32, 128
    q = (lambda x, *d: x.permute(*d))((x @ wq).reshape(B, Sq, H, Dh), 0, 2, 1, 3)
    scores = torch.einsum("bhqd,bhkd->bhqk", q, k_cache) * (Dh ** -0.5)
    p = _softmax(scores, axis=-1)
    o = torch.einsum("bhqk,bhkd->bhqd", p, v_cache)
    return (lambda x, *d: x.permute(*d))(o, 0, 2, 1, 3).reshape(B, Sq, H * Dh) @ wo
```

```asm
; @launch grid=(256,1,1) block=(256,1,1) lds=163840
.amdgcn_target "amdgcn-amd-amdhsa--gfx950"
.text
.globl standalone__mha_block_cached__near_ridge_kernel
.p2align 8
.type standalone__mha_block_cached__near_ridge_kernel,@function
standalone__mha_block_cached__near_ridge_kernel:
    s_load_dwordx16 s[4:19], s[0:1], 0
    s_cmp_ge_u32 s2, 256
    s_cbranch_scc1 L_end
    s_getpc_b64 s[44:45]
L_pcbase:
    v_lshrrev_b32 v2, 6, v0
    v_and_b32 v3, 7, v0
    v_lshl_add_u32 v2, v2, 3, v3
    s_lshr_b32 s46, s2, 3
    s_mul_i32 s46, s46, 12
    v_min_u32 v2, 11, v2
    v_add_u32 v2, s46, v2
    v_lshlrev_b32 v2, 7, v2
    v_min_u32 v2, L_codeend-L_pcbase-4, v2
    global_load_dword v3, v2, s[44:45]
    v_and_b32 v1, 63, v0
    v_lshrrev_b32 v8, 6, v0
    s_nop 0
    v_readfirstlane_b32 s42, v8
    s_and_b32 s44, s2, 7
    s_lshr_b32 s45, s2, 3
    s_and_b32 s40, s44, 1
    s_lshl_b32 s40, s40, 2
    s_lshr_b32 s46, s45, 3
    s_add_u32 s40, s40, s46
    s_lshr_b32 s41, s44, 1
    s_lshl_b32 s41, s41, 3
    s_and_b32 s46, s45, 7
    s_add_u32 s41, s41, s46
    s_mul_i32 s43, s40, 1
    s_add_u32 s43, s43, s41
    s_and_b32 s43, s43, 7
    s_and_b32 s55, s42, 1
    s_mul_i32 s53, s42, 7168
    s_lshl_b32 s54, s42, 12
    s_lshl_b32 s48, s42, 11
    s_lshl_b32 s45, s55, 11
    s_mov_b32 s46, 135168
    s_cmp_lt_u32 s42, 2
    s_cselect_b32 s49, 32768, s46
    s_add_u32 s49, s49, s45
    v_lshrrev_b32 v9, 4, v1
    v_and_b32 v10, 15, v1
    v_lshlrev_b32 v11, 2, v9
    v_xor_b32 v11, v11, v10
    v_lshlrev_b32 v11, 4, v11
    v_lshl_add_u32 v249, v9, 13, v11
    s_lshl_b32 s44, s42, 16
    v_add_u32 v249, s44, v249
    v_add_u32 v250, 31744, v249
    v_lshl_add_u32 v212, v9, 8, v11
    v_add_u32 v212, s54, v212
    v_lshrrev_b32 v8, 3, v1
    v_and_b32 v12, 7, v1
    v_xor_b32 v12, v12, v9
    v_lshlrev_b32 v12, 4, v12
    v_lshl_add_u32 v12, v8, 10, v12
    s_lshl_b32 s45, s55, 6
    v_xor_b32 v12, s45, v12
    s_mul_i32 s44, s42, 57344
    v_add_u32 v12, s44, v12
    v_xor_b32 v13, 64, v12
    v_add_u32 v242, 0, v12
    v_add_u32 v243, 7168, v13
    v_add_u32 v244, 14336, v12
    v_add_u32 v245, 21504, v13
    v_add_u32 v246, 32768, v12
    v_add_u32 v247, 39936, v13
    v_add_u32 v248, 47104, v12
    s_waitcnt lgkmcnt(0)
    s_lshl_b32 s44, s41, 8
    s_sub_u32 s45, 4194304, s44
    s_add_u32 s24, s10, s44
    s_addc_u32 s25, s11, 0
    s_and_b32 s25, s25, 0xffff
    s_mov_b32 s26, s45
    s_mov_b32 s27, 0x20000
    s_lshl_b32 s63, s43, 1
    s_add_u32 s63, s63, 0
    s_and_b32 s63, s63, 7
    s_lshl_b32 s63, s63, 18
    s_add_u32 m0, s48, 139264
    s_nop 0
    buffer_load_dwordx4 v249, s[24:27], s63 offen lds
    buffer_load_dwordx4 v250, s[24:27], s63 offen offset:1024 lds
    s_mul_i32 s44, s40, 212992
    s_add_u32 s20, s4, s44
    s_addc_u32 s21, s5, 0
    s_and_b32 s21, s21, 0xffff
    s_mov_b32 s22, 212992
    s_mov_b32 s23, 0x20000
    s_add_u32 s62, s43, 0
    s_and_b32 s62, s62, 3
    s_lshl_b32 s62, s62, 7
    s_add_u32 m0, s53, 36864
    s_nop 0
    buffer_load_dwordx4 v242, s[20:23], s62 offen lds
    buffer_load_dwordx4 v243, s[20:23], s62 offen offset:1024 lds
    buffer_load_dwordx4 v244, s[20:23], s62 offen offset:2048 lds
    buffer_load_dwordx4 v245, s[20:23], s62 offen offset:3072 lds
    s_add_u32 m0, s53, 40960
    s_nop 0
    buffer_load_dwordx4 v246, s[20:23], s62 offen lds
    buffer_load_dwordx4 v247, s[20:23], s62 offen offset:1024 lds
    buffer_load_dwordx4 v248, s[20:23], s62 offen offset:2048 lds
    s_lshl_b32 s63, s43, 1
    s_add_u32 s63, s63, 1
    s_and_b32 s63, s63, 7
    s_lshl_b32 s63, s63, 18
    s_add_u32 m0, s48, 155648
    s_nop 0
    buffer_load_dwordx4 v249, s[24:27], s63 offen lds
    buffer_load_dwordx4 v250, s[24:27], s63 offen offset:1024 lds
    s_lshl_b32 s63, s43, 1
    s_add_u32 s63, s63, 2
    s_and_b32 s63, s63, 7
    s_lshl_b32 s63, s63, 18
    s_add_u32 m0, s48, 16384
    s_nop 0
    buffer_load_dwordx4 v249, s[24:27], s63 offen lds
    buffer_load_dwordx4 v250, s[24:27], s63 offen offset:1024 lds
    v_xor_b32 v11, v9, v10
    v_xor_b32 v11, 0, v11
    v_lshlrev_b32 v11, 4, v11
    v_lshl_add_u32 v208, v9, 8, v11
    v_add_u32 v208, s54, v208
    v_xor_b32 v11, v9, v10
    v_xor_b32 v11, 4, v11
    v_lshlrev_b32 v11, 4, v11
    v_lshl_add_u32 v209, v9, 8, v11
    v_add_u32 v209, s54, v209
    v_xor_b32 v11, v9, v10
    v_xor_b32 v11, 8, v11
    v_lshlrev_b32 v11, 4, v11
    v_lshl_add_u32 v210, v9, 8, v11
    v_add_u32 v210, s54, v210
    v_xor_b32 v11, v9, v10
    v_xor_b32 v11, 12, v11
    v_lshlrev_b32 v11, 4, v11
    v_lshl_add_u32 v211, v9, 8, v11
    v_add_u32 v211, s54, v211
    s_lshl_b32 s44, s40, 5
    s_add_u32 s44, s44, s41
    s_lshl_b32 s44, s44, 17
    s_add_u32 s28, s6, s44
    s_addc_u32 s29, s7, 0
    s_and_b32 s29, s29, 0xffff
    s_mov_b32 s30, 131072
    s_mov_b32 s31, 0x20000
    s_add_u32 s32, s8, s44
    s_addc_u32 s33, s9, 0
    s_and_b32 s33, s33, 0xffff
    s_mov_b32 s34, 131072
    s_mov_b32 s35, 0x20000
    s_lshl_b32 s44, s40, 2
    s_lshr_b32 s45, s41, 3
    s_add_u32 s44, s44, s45
    s_mul_i32 s44, s44, 425984
    s_and_b32 s45, s41, 7
    s_lshl_b32 s45, s45, 12
    s_add_u32 s44, s44, s45
    s_add_u32 s36, s18, s44
    s_addc_u32 s37, s19, 0
    s_and_b32 s37, s37, 0xffff
    s_mov_b32 s38, 397312
    s_mov_b32 s39, 0x20000
    s_mov_b32 s56, 0x4e800000
    s_mov_b32 s57, 0x3e0293ee
    s_lshl_b32 s60, s55, 11
    s_xor_b32 s61, s60, 2048
    s_lshl_b32 s70, s42, 13
    s_lshr_b32 s66, s41, 3
    s_and_b32 s67, s41, 7
    s_lshl_b32 s65, s40, 5
    s_add_u32 s65, s65, s41
    s_lshr_b32 s101, s2, 3
    s_mul_i32 s3, s40, 3
    s_add_u32 s3, s3, s41
    s_lshr_b32 s44, s41, 3
    s_add_u32 s3, s3, s44
    s_lshl_b32 s3, s3, 14
    s_add_u32 s8, s18, 16777216
    s_addc_u32 s9, s19, 0
    s_and_b32 s9, s9, 0xffff
    s_mov_b32 s10, 10485760
    s_mov_b32 s11, 0x20000
    s_lshl_b32 s44, s65, 8
    v_mov_b32 v4, 0
    buffer_load_dword v5, v4, s[8:11], s44 offen sc1
    s_mul_i32 s100, s65, 24576
    s_add_u32 s100, s100, 4194304
    v_and_b32 v12, 7, v1
    v_lshlrev_b32 v13, 1, v9
    v_xor_b32 v12, v12, v13
    v_lshlrev_b32 v12, 4, v12
    v_lshl_add_u32 v221, v8, 10, v12
    v_lshrrev_b32 v8, 4, v1
    v_bfe_u32 v9, v1, 2, 2
    v_and_b32 v10, 3, v1
    v_lshrrev_b32 v11, 1, v8
    v_lshl_add_u32 v11, v11, 3, v9
    v_lshlrev_b32 v11, 8, v11
    v_and_b32 v12, 1, v8
    v_lshl_add_u32 v11, v12, 5, v11
    v_and_b32 v13, 1, v10
    v_lshl_add_u32 v11, v13, 4, v11
    v_lshrrev_b32 v13, 1, v10
    v_lshl_add_u32 v11, v13, 3, v11
    s_lshl_b32 s44, s55, 1
    v_xor_b32 v14, s44, v9
    v_xor_b32 v13, 0, v14
    v_lshl_add_u32 v226, v13, 6, v11
    v_add_u32 v222, 126976, v226
    v_xor_b32 v13, 1, v14
    v_lshl_add_u32 v227, v13, 6, v11
    v_add_u32 v223, 126976, v227
    v_xor_b32 v13, 2, v14
    v_lshl_add_u32 v228, v13, 6, v11
    v_add_u32 v224, 126976, v228
    v_xor_b32 v13, 3, v14
    v_lshl_add_u32 v229, v13, 6, v11
    v_add_u32 v225, 126976, v229
    v_lshrrev_b32 v11, 1, v8
    v_lshl_add_u32 v11, v11, 2, v9
    v_lshlrev_b32 v11, 8, v11
    v_lshl_add_u32 v11, v12, 5, v11
    v_lshl_add_u32 v11, v10, 3, v11
    s_lshl_b32 s45, s55, 13
    s_add_u32 s46, s45, 65536
    v_add_u32 v11, s46, v11
    v_xor_b32 v13, 0, v14
    v_lshl_add_u32 v192, v13, 6, v11
    v_xor_b32 v196, 8192, v192
    v_xor_b32 v13, 1, v14
    v_lshl_add_u32 v193, v13, 6, v11
    v_xor_b32 v197, 8192, v193
    v_xor_b32 v13, 2, v14
    v_lshl_add_u32 v194, v13, 6, v11
    v_xor_b32 v198, 8192, v194
    v_xor_b32 v13, 3, v14
    v_lshl_add_u32 v195, v13, 6, v11
    v_xor_b32 v199, 8192, v195
    v_lshl_add_u32 v11, v8, 3, v9
    v_lshlrev_b32 v11, 8, v11
    v_xor_b32 v15, s42, v9
    v_lshl_add_u32 v11, v15, 6, v11
    v_lshl_add_u32 v11, v10, 4, v11
    v_add_u32 v230, 126976, v11
    v_mov_b32 v251, v11
    v_mov_b32 v12, 32768
    v_mov_b32 v13, 131072
    v_cmp_gt_u32 vcc, 2, v8
    s_nop 1
    v_cndmask_b32 v12, v13, v12, vcc
    v_add_u32 v231, v12, v11
    v_lshl_add_u32 v11, v8, 2, v9
    v_lshlrev_b32 v11, 8, v11
    v_lshrrev_b32 v13, 1, v10
    v_lshl_add_u32 v11, v13, 5, v11
    v_and_b32 v13, 1, v10
    v_lshl_add_u32 v11, v13, 3, v11
    s_add_u32 s47, s70, 65536
    v_add_u32 v11, s47, v11
    v_xor_b32 v13, 0, v15
    v_lshl_add_u32 v204, v13, 6, v11
    v_xor_b32 v13, 1, v15
    v_lshl_add_u32 v205, v13, 6, v11
    v_xor_b32 v13, 2, v15
    v_lshl_add_u32 v206, v13, 6, v11
    v_xor_b32 v13, 3, v15
    v_lshl_add_u32 v207, v13, 6, v11
    v_and_b32 v11, 31, v1
    v_lshrrev_b32 v12, 5, v1
    v_and_b32 v13, 15, v1
    v_xor_b32 v13, v13, v12
    s_lshl_b32 s44, s55, 3
    v_xor_b32 v13, s44, v13
    v_lshlrev_b32 v14, 8, v11
    v_add_u32 v14, s45, v14
    v_xor_b32 v15, 0, v13
    v_lshl_add_u32 v176, v15, 4, v14
    v_xor_b32 v184, 8192, v176
    v_xor_b32 v15, 2, v13
    v_lshl_add_u32 v177, v15, 4, v14
    v_xor_b32 v185, 8192, v177
    v_xor_b32 v15, 4, v13
    v_lshl_add_u32 v178, v15, 4, v14
    v_xor_b32 v186, 8192, v178
    v_xor_b32 v15, 6, v13
    v_lshl_add_u32 v179, v15, 4, v14
    v_xor_b32 v187, 8192, v179
    v_xor_b32 v15, 8, v13
    v_lshl_add_u32 v180, v15, 4, v14
    v_xor_b32 v188, 8192, v180
    v_xor_b32 v15, 10, v13
    v_lshl_add_u32 v181, v15, 4, v14
    v_xor_b32 v189, 8192, v181
    v_xor_b32 v15, 12, v13
    v_lshl_add_u32 v182, v15, 4, v14
    v_xor_b32 v190, 8192, v182
    v_xor_b32 v15, 14, v13
    v_lshl_add_u32 v183, v15, 4, v14
    v_xor_b32 v191, 8192, v183
    v_bfe_u32 v13, v1, 1, 3
    v_xor_b32 v13, v13, v12
    v_lshlrev_b32 v14, 7, v11
    s_add_u32 s44, s54, 36864
    s_lshr_b32 s47, s42, 1
    s_lshl_b32 s47, s47, 12
    s_add_u32 s47, s47, 53248
    v_xor_b32 v15, 0, v13
    v_lshl_add_u32 v15, v15, 4, v14
    v_add_u32 v232, s44, v15
    v_add_u32 v236, s47, v15
    v_xor_b32 v15, 2, v13
    v_lshl_add_u32 v15, v15, 4, v14
    v_add_u32 v233, s44, v15
    v_add_u32 v237, s47, v15
    v_xor_b32 v15, 4, v13
    v_lshl_add_u32 v15, v15, 4, v14
    v_add_u32 v234, s44, v15
    v_add_u32 v238, s47, v15
    v_xor_b32 v15, 6, v13
    v_lshl_add_u32 v15, v15, 4, v14
    v_add_u32 v235, s44, v15
    v_add_u32 v239, s47, v15
    v_and_b32 v11, 15, v1
    v_xor_b32 v13, v11, v8
    v_lshlrev_b32 v14, 8, v11
    v_add_u32 v14, s70, v14
    v_xor_b32 v15, 0, v13
    v_lshl_add_u32 v200, v15, 4, v14
    v_xor_b32 v15, 4, v13
    v_lshl_add_u32 v201, v15, 4, v14
    v_xor_b32 v15, 8, v13
    v_lshl_add_u32 v202, v15, 4, v14
    v_xor_b32 v15, 12, v13
    v_lshl_add_u32 v203, v15, 4, v14
    v_bfe_u32 v13, v1, 1, 3
    v_xor_b32 v13, v13, v8
    v_lshlrev_b32 v14, 7, v11
    v_add_u32 v14, 61440, v14
    v_xor_b32 v15, 0, v13
    v_lshl_add_u32 v240, v15, 4, v14
    v_xor_b32 v15, 4, v13
    v_lshl_add_u32 v241, v15, 4, v14
    v_xor_b32 v11, 16, v1
    v_lshlrev_b32 v219, 2, v11
    v_lshlrev_b32 v8, 4, v1
    s_add_u32 s44, s54, 114688
    v_add_u32 v9, s44, v8
    s_lshl_b32 s45, s42, 10
    s_add_u32 s45, s45, 131072
    v_add_u32 v10, s45, v8
    s_add_u32 s62, s43, 1
    s_and_b32 s62, s62, 3
    s_lshl_b32 s62, s62, 7
    s_add_u32 m0, s53, 98304
    s_nop 0
    buffer_load_dwordx4 v242, s[20:23], s62 offen lds
    buffer_load_dwordx4 v243, s[20:23], s62 offen offset:1024 lds
    buffer_load_dwordx4 v244, s[20:23], s62 offen offset:2048 lds
    buffer_load_dwordx4 v245, s[20:23], s62 offen offset:3072 lds
    s_add_u32 m0, s53, 102400
    s_nop 0
    buffer_load_dwordx4 v246, s[20:23], s62 offen lds
    buffer_load_dwordx4 v247, s[20:23], s62 offen offset:1024 lds
    buffer_load_dwordx4 v248, s[20:23], s62 offen offset:2048 lds
    s_lshl_b32 s63, s43, 1
    s_add_u32 s63, s63, 3
    s_and_b32 s63, s63, 7
    s_lshl_b32 s63, s63, 18
    s_add_u32 m0, s48, 24576
    s_nop 0
    buffer_load_dwordx4 v249, s[24:27], s63 offen lds
    buffer_load_dwordx4 v250, s[24:27], s63 offen offset:1024 lds
    s_waitcnt vmcnt(14)
    s_barrier
    ds_read_b128 a[80:83], v232
    ds_read_b128 a[96:99], v236
    ds_read_b128 a[112:115], v240
    ds_read_b128 a[84:87], v233
    ds_read_b128 a[100:103], v237
    ds_read_b128 a[88:91], v234
    ds_read_b128 a[104:107], v238
    ds_read_b128 a[116:119], v241
    ds_read_b128 a[92:95], v235
    ds_read_b128 a[108:111], v239
    ds_read_b64_tr_b16 a[120:121], v222 offset:12288
    ds_read_b64_tr_b16 a[122:123], v222 offset:13312
    ds_read_b64_tr_b16 a[124:125], v223 offset:12288
    ds_read_b64_tr_b16 a[126:127], v223 offset:13312
    ds_read_b64_tr_b16 a[128:129], v224 offset:12288
    s_waitcnt lgkmcnt(14)
    ds_read_b64_tr_b16 a[130:131], v224 offset:13312
    s_waitcnt lgkmcnt(14)
    ds_read_b64_tr_b16 a[132:133], v225 offset:12288
    s_waitcnt lgkmcnt(14)
    ds_read_b64_tr_b16 a[134:135], v225 offset:13312
    s_waitcnt lgkmcnt(14)
    ds_read_b64_tr_b16 a[136:137], v222 offset:16384
    s_waitcnt lgkmcnt(14)
    ds_read_b64_tr_b16 a[138:139], v222 offset:17408
    s_waitcnt lgkmcnt(10)
    s_waitcnt vmcnt(12)
    s_barrier
    s_waitcnt lgkmcnt(8)
    v_mfma_f32_32x32x16_bf16 v[32:47], a[120:123], a[96:99], 0
    s_add_u32 s62, s43, 2
    s_and_b32 s62, s62, 3
    s_lshl_b32 s62, s62, 7
    s_add_u32 m0, s53, 65536
    s_nop 0
    buffer_load_dwordx4 v242, s[20:23], s62 offen lds
    v_mfma_f32_32x32x16_bf16 v[64:79], a[120:123], a[80:83], 0
    ds_read_b64_tr_b16 a[140:141], v223 offset:16384
    ds_read_b64_tr_b16 a[142:143], v223 offset:17408
    s_waitcnt lgkmcnt(8)
    v_mfma_f32_32x32x16_bf16 v[48:63], a[124:127], a[96:99], 0
    buffer_load_dwordx4 v243, s[20:23], s62 offen offset:1024 lds
    v_mfma_f32_32x32x16_bf16 v[80:95], a[124:127], a[80:83], 0
    ds_read_b64_tr_b16 a[216:217], v224 offset:16384
    ds_read_b64_tr_b16 a[218:219], v224 offset:17408
    s_waitcnt lgkmcnt(8)
    v_mfma_f32_32x32x16_bf16 v[96:111], a[128:131], a[80:83], 0
    ds_read_b64_tr_b16 a[220:221], v225 offset:16384
    ds_read_b64_tr_b16 a[222:223], v225 offset:17408
    buffer_load_dwordx4 v244, s[20:23], s62 offen offset:2048 lds
    s_waitcnt lgkmcnt(8)
    v_mfma_f32_32x32x16_bf16 v[112:127], a[132:135], a[80:83], 0
    ds_read_b64_tr_b16 a[224:225], v230 offset:12288
    ds_read_b64_tr_b16 a[226:227], v230 offset:13312
    s_waitcnt lgkmcnt(8)
    v_mfma_f32_32x32x16_bf16 v[32:47], a[136:139], a[100:103], v[32:47]
    buffer_load_dwordx4 v245, s[20:23], s62 offen offset:3072 lds
    v_mfma_f32_32x32x16_bf16 v[64:79], a[136:139], a[84:87], v[64:79]
    ds_read_b64_tr_b16 a[228:229], v230 offset:12296
    ds_read_b64_tr_b16 a[230:231], v230 offset:13320
    s_waitcnt lgkmcnt(8)
    v_mfma_f32_32x32x16_bf16 v[48:63], a[140:143], a[100:103], v[48:63]
    s_add_u32 s62, s43, 2
    s_and_b32 s62, s62, 3
    s_lshl_b32 s62, s62, 7
    s_add_u32 m0, s53, 69632
    s_nop 0
    buffer_load_dwordx4 v246, s[20:23], s62 offen lds
    v_mfma_f32_32x32x16_bf16 v[80:95], a[140:143], a[84:87], v[80:95]
    ds_read_b64_tr_b16 a[232:233], v222 offset:28672
    ds_read_b64_tr_b16 a[234:235], v222 offset:29696
    s_waitcnt lgkmcnt(8)
    v_mfma_f32_32x32x16_bf16 v[96:111], a[216:219], a[84:87], v[96:111]
    ds_read_b64_tr_b16 a[236:237], v223 offset:28672
    ds_read_b64_tr_b16 a[238:239], v223 offset:29696
    buffer_load_dwordx4 v247, s[20:23], s62 offen offset:1024 lds
    s_waitcnt lgkmcnt(8)
    v_mfma_f32_32x32x16_bf16 v[112:127], a[220:223], a[84:87], v[112:127]
    ds_read_b64_tr_b16 a[120:121], v224 offset:28672
    ds_read_b64_tr_b16 a[122:123], v224 offset:29696
    s_waitcnt lgkmcnt(8)
    v_mfma_f32_16x16x32_bf16 v[160:163], a[224:227], a[112:115], 0
    ds_read_b64_tr_b16 a[124:125], v225 offset:28672
    ds_read_b64_tr_b16 a[126:127], v225 offset:29696
    buffer_load_dwordx4 v248, s[20:23], s62 offen offset:2048 lds
    s_waitcnt lgkmcnt(8)
    v_mfma_f32_16x16x32_bf16 v[164:167], a[228:231], a[112:115], 0
    ds_read_b64_tr_b16 a[128:129], v222 offset:32768
    ds_read_b64_tr_b16 a[130:131], v222 offset:33792
    s_waitcnt vmcnt(9)
    s_barrier
    s_waitcnt lgkmcnt(8)
    v_mfma_f32_32x32x16_bf16 v[32:47], a[232:235], a[104:107], v[32:47]
    s_lshl_b32 s63, s43, 1
    s_add_u32 s63, s63, 4
    s_and_b32 s63, s63, 7
    s_lshl_b32 s63, s63, 18
    s_mov_b32 m0, s49
    s_nop 0
    buffer_load_dwordx4 v249, s[24:27], s63 offen lds
    ds_read_b128 a[176:179], v232 offset:61440
    v_mfma_f32_32x32x16_bf16 v[64:79], a[232:235], a[88:91], v[64:79]
    ds_read_b64_tr_b16 a[132:133], v223 offset:32768
    ds_read_b64_tr_b16 a[134:135], v223 offset:33792
    ds_read_b128 a[192:195], v236 offset:61440
    s_waitcnt lgkmcnt(10)
    v_mfma_f32_32x32x16_bf16 v[48:63], a[236:239], a[104:107], v[48:63]
    ds_read_b128 a[208:211], v240 offset:61440
    v_mfma_f32_32x32x16_bf16 v[80:95], a[236:239], a[88:91], v[80:95]
    ds_read_b64_tr_b16 a[136:137], v224 offset:32768
    ds_read_b64_tr_b16 a[138:139], v224 offset:33792
    buffer_load_dwordx4 v250, s[24:27], s63 offen offset:1024 lds
    ds_read_b128 a[180:183], v233 offset:61440
    s_waitcnt lgkmcnt(12)
    v_mfma_f32_32x32x16_bf16 v[96:111], a[120:123], a[88:91], v[96:111]
    ds_read_b64_tr_b16 a[140:141], v225 offset:32768
    ds_read_b64_tr_b16 a[142:143], v225 offset:33792
    ds_read_b128 a[196:199], v237 offset:61440
    s_waitcnt lgkmcnt(13)
    v_mfma_f32_32x32x16_bf16 v[112:127], a[124:127], a[88:91], v[112:127]
    ds_read_b64_tr_b16 a[216:217], v230 offset:28672
    ds_read_b64_tr_b16 a[218:219], v230 offset:29696
    s_waitcnt lgkmcnt(14)
    ds_read_b128 a[184:187], v234 offset:61440
    s_waitcnt lgkmcnt(14)
    v_mfma_f32_32x32x16_bf16 v[32:47], a[128:131], a[108:111], v[32:47]
    ds_read_b128 a[200:203], v238 offset:61440
    v_mfma_f32_32x32x16_bf16 v[64:79], a[128:131], a[92:95], v[64:79]
    s_waitcnt lgkmcnt(14)
    ds_read_b64_tr_b16 a[220:221], v230 offset:28680
    s_waitcnt lgkmcnt(14)
    ds_read_b64_tr_b16 a[222:223], v230 offset:29704
    s_lshl_b32 s63, s43, 1
    s_add_u32 s63, s63, 5
    s_and_b32 s63, s63, 7
    s_lshl_b32 s63, s63, 18
    s_add_u32 m0, s48, 126976
    s_nop 0
    buffer_load_dwordx4 v249, s[24:27], s63 offen lds
    s_waitcnt lgkmcnt(14)
    ds_read_b128 a[212:215], v241 offset:61440
    v_mfma_f32_32x32x16_bf16 v[48:63], a[132:135], a[108:111], v[48:63]
    s_waitcnt lgkmcnt(14)
    ds_read_b128 a[188:191], v235 offset:61440
    v_mfma_f32_32x32x16_bf16 v[80:95], a[132:135], a[92:95], v[80:95]
    s_waitcnt lgkmcnt(14)
    ds_read_b64_tr_b16 a[224:225], v226 offset:16384
    s_waitcnt lgkmcnt(14)
    ds_read_b64_tr_b16 a[226:227], v226 offset:17408
    s_waitcnt lgkmcnt(14)
    ds_read_b128 a[204:207], v239 offset:61440
    v_mfma_f32_32x32x16_bf16 v[96:111], a[136:139], a[92:95], v[96:111]
    s_waitcnt lgkmcnt(14)
    ds_read_b64_tr_b16 a[228:229], v227 offset:16384
    s_waitcnt lgkmcnt(14)
    ds_read_b64_tr_b16 a[230:231], v227 offset:17408
    buffer_load_dwordx4 v250, s[24:27], s63 offen offset:1024 lds
    s_waitcnt lgkmcnt(14)
    v_mfma_f32_32x32x16_bf16 v[112:127], a[140:143], a[92:95], v[112:127]
    ds_read_b64_tr_b16 a[232:233], v228 offset:16384
    s_waitcnt lgkmcnt(14)
    ds_read_b64_tr_b16 a[234:235], v228 offset:17408
    s_waitcnt lgkmcnt(13)
    v_mfma_f32_16x16x32_bf16 v[160:163], a[216:219], a[116:119], v[160:163]
    ds_read_b64_tr_b16 a[236:237], v229 offset:16384
    ds_read_b64_tr_b16 a[238:239], v229 offset:17408
    s_waitcnt lgkmcnt(11)
    v_mfma_f32_16x16x32_bf16 v[164:167], a[220:223], a[116:119], v[164:167]
    ds_read_b64_tr_b16 a[120:121], v226 offset:20480
    ds_read_b64_tr_b16 a[122:123], v226 offset:21504
    s_waitcnt lgkmcnt(8)
    s_waitcnt vmcnt(11)
    s_barrier
    v_mfma_f32_32x32x16_bf16 v[32:47], a[224:227], a[192:195], v[32:47]
    s_add_u32 s62, s43, 3
    s_and_b32 s62, s62, 3
    s_lshl_b32 s62, s62, 7
    s_add_u32 m0, s53, 36864
    s_nop 0
    buffer_load_dwordx4 v242, s[20:23], s62 offen lds
    v_mfma_f32_32x32x16_bf16 v[64:79], a[224:227], a[176:179], v[64:79]
    ds_read_b64_tr_b16 a[124:125], v227 offset:20480
    ds_read_b64_tr_b16 a[126:127], v227 offset:21504
    s_waitcnt lgkmcnt(8)
    v_mfma_f32_32x32x16_bf16 v[48:63], a[228:231], a[192:195], v[48:63]
    buffer_load_dwordx4 v243, s[20:23], s62 offen offset:1024 lds
    v_mfma_f32_32x32x16_bf16 v[80:95], a[228:231], a[176:179], v[80:95]
    ds_read_b64_tr_b16 a[128:129], v228 offset:20480
    ds_read_b64_tr_b16 a[130:131], v228 offset:21504
    s_waitcnt lgkmcnt(8)
    v_mfma_f32_32x32x16_bf16 v[96:111], a[232:235], a[176:179], v[96:111]
    ds_read_b64_tr_b16 a[132:133], v229 offset:20480
    ds_read_b64_tr_b16 a[134:135], v229 offset:21504
    buffer_load_dwordx4 v244, s[20:23], s62 offen offset:2048 lds
    s_waitcnt lgkmcnt(8)
    v_mfma_f32_32x32x16_bf16 v[112:127], a[236:239], a[176:179], v[112:127]
    ds_read_b64_tr_b16 a[136:137], v251 offset:16384
    ds_read_b64_tr_b16 a[138:139], v251 offset:17408
    s_waitcnt lgkmcnt(8)
    v_mfma_f32_32x32x16_bf16 v[32:47], a[120:123], a[196:199], v[32:47]
    buffer_load_dwordx4 v245, s[20:23], s62 offen offset:3072 lds
    v_mfma_f32_32x32x16_bf16 v[64:79], a[120:123], a[180:183], v[64:79]
    ds_read_b64_tr_b16 a[140:141], v251 offset:16392
    ds_read_b64_tr_b16 a[142:143], v251 offset:17416
    s_waitcnt lgkmcnt(8)
    v_mfma_f32_32x32x16_bf16 v[48:63], a[124:127], a[196:199], v[48:63]
    s_add_u32 s62, s43, 3
    s_and_b32 s62, s62, 3
    s_lshl_b32 s62, s62, 7
    s_add_u32 m0, s53, 40960
    s_nop 0
    buffer_load_dwordx4 v246, s[20:23], s62 offen lds
    v_mfma_f32_32x32x16_bf16 v[80:95], a[124:127], a[180:183], v[80:95]
    ds_read_b64_tr_b16 a[216:217], v226 offset:24576
    ds_read_b64_tr_b16 a[218:219], v226 offset:25600
    s_waitcnt lgkmcnt(8)
    v_mfma_f32_32x32x16_bf16 v[96:111], a[128:131], a[180:183], v[96:111]
    ds_read_b64_tr_b16 a[220:221], v227 offset:24576
    ds_read_b64_tr_b16 a[222:223], v227 offset:25600
    buffer_load_dwordx4 v247, s[20:23], s62 offen offset:1024 lds
    s_waitcnt lgkmcnt(8)
    v_mfma_f32_32x32x16_bf16 v[112:127], a[132:135], a[180:183], v[112:127]
    ds_read_b64_tr_b16 a[224:225], v228 offset:24576
    ds_read_b64_tr_b16 a[226:227], v228 offset:25600
    s_waitcnt lgkmcnt(8)
    v_mfma_f32_16x16x32_bf16 v[160:163], a[136:139], a[208:211], v[160:163]
    ds_read_b64_tr_b16 a[228:229], v229 offset:24576
    ds_read_b64_tr_b16 a[230:231], v229 offset:25600
    buffer_load_dwordx4 v248, s[20:23], s62 offen offset:2048 lds
    s_waitcnt lgkmcnt(8)
    v_mfma_f32_16x16x32_bf16 v[164:167], a[140:143], a[208:211], v[164:167]
    ds_read_b64_tr_b16 a[232:233], v226 offset:28672
    ds_read_b64_tr_b16 a[234:235], v226 offset:29696
    s_waitcnt vmcnt(9)
    s_barrier
    v_readfirstlane_b32 s68, v5
    s_nop 0
    s_and_b32 s44, s68, 3
    s_or_b32 s44, s44, 8
    s_lshl_b32 s45, s67, 2
    s_lshl_b32 s44, s44, s45
    s_lshr_b32 s45, s65, 3
    s_lshl_b32 s45, s45, 2
    v_mov_b32 v5, s44
    v_lshlrev_b32 v4, 10, v0
    s_mov_b32 s4, s16
    s_and_b32 s5, s17, 0xffff
    s_mov_b32 s6, 256
    s_mov_b32 s7, 0x20000
    buffer_atomic_or v5, v4, s[4:7], s45 offen sc1
    s_waitcnt lgkmcnt(8)
    v_mfma_f32_32x32x16_bf16 v[32:47], a[216:219], a[200:203], v[32:47]
    s_lshl_b32 s63, s43, 1
    s_add_u32 s63, s63, 6
    s_and_b32 s63, s63, 7
    s_lshl_b32 s63, s63, 18
    s_add_u32 m0, s48, 147456
    s_nop 0
    buffer_load_dwordx4 v249, s[24:27], s63 offen lds
    ds_read_b128 a[80:83], v232 offset:28672
    v_mfma_f32_32x32x16_bf16 v[64:79], a[216:219], a[184:187], v[64:79]
    ds_read_b64_tr_b16 a[236:237], v227 offset:28672
    ds_read_b64_tr_b16 a[238:239], v227 offset:29696
    ds_read_b128 a[96:99], v236 offset:28672
    s_waitcnt lgkmcnt(10)
    v_mfma_f32_32x32x16_bf16 v[48:63], a[220:223], a[200:203], v[48:63]
    ds_read_b128 a[112:115], v240 offset:28672
    v_mfma_f32_32x32x16_bf16 v[80:95], a[220:223], a[184:187], v[80:95]
    ds_read_b64_tr_b16 a[120:121], v228 offset:28672
    ds_read_b64_tr_b16 a[122:123], v228 offset:29696
    buffer_load_dwordx4 v250, s[24:27], s63 offen offset:1024 lds
    ds_read_b128 a[84:87], v233 offset:28672
    s_waitcnt lgkmcnt(12)
    v_mfma_f32_32x32x16_bf16 v[96:111], a[224:227], a[184:187], v[96:111]
    ds_read_b64_tr_b16 a[124:125], v229 offset:28672
    ds_read_b64_tr_b16 a[126:127], v229 offset:29696
    ds_read_b128 a[100:103], v237 offset:28672
    s_waitcnt lgkmcnt(13)
    v_mfma_f32_32x32x16_bf16 v[112:127], a[228:231], a[184:187], v[112:127]
    ds_read_b64_tr_b16 a[128:129], v251 offset:24576
    ds_read_b64_tr_b16 a[130:131], v251 offset:25600
    s_waitcnt lgkmcnt(14)
    ds_read_b128 a[88:91], v234 offset:28672
    s_waitcnt lgkmcnt(14)
    v_mfma_f32_32x32x16_bf16 v[32:47], a[232:235], a[204:207], v[32:47]
    ds_read_b128 a[104:107], v238 offset:28672
    v_mfma_f32_32x32x16_bf16 v[64:79], a[232:235], a[188:191], v[64:79]
    s_waitcnt lgkmcnt(14)
    ds_read_b64_tr_b16 a[132:133], v251 offset:24584
    s_waitcnt lgkmcnt(14)
    ds_read_b64_tr_b16 a[134:135], v251 offset:25608
    s_lshl_b32 s63, s43, 1
    s_add_u32 s63, s63, 7
    s_and_b32 s63, s63, 7
    s_lshl_b32 s63, s63, 18
    s_add_u32 m0, s48, 139264
    s_nop 0
    buffer_load_dwordx4 v249, s[24:27], s63 offen lds
    s_waitcnt lgkmcnt(14)
    ds_read_b128 a[116:119], v241 offset:28672
    v_mfma_f32_32x32x16_bf16 v[48:63], a[236:239], a[204:207], v[48:63]
    s_waitcnt lgkmcnt(14)
    ds_read_b128 a[92:95], v235 offset:28672
    v_mfma_f32_32x32x16_bf16 v[80:95], a[236:239], a[188:191], v[80:95]
    s_waitcnt lgkmcnt(14)
    ds_read_b64_tr_b16 a[136:137], v226 offset:32768
    s_waitcnt lgkmcnt(14)
    ds_read_b64_tr_b16 a[138:139], v226 offset:33792
    s_waitcnt lgkmcnt(14)
    ds_read_b128 a[108:111], v239 offset:28672
    v_mfma_f32_32x32x16_bf16 v[96:111], a[120:123], a[188:191], v[96:111]
    s_waitcnt lgkmcnt(14)
    ds_read_b64_tr_b16 a[140:141], v227 offset:32768
    s_waitcnt lgkmcnt(14)
    ds_read_b64_tr_b16 a[142:143], v227 offset:33792
    buffer_load_dwordx4 v250, s[24:27], s63 offen offset:1024 lds
    s_waitcnt lgkmcnt(14)
    v_mfma_f32_32x32x16_bf16 v[112:127], a[124:127], a[188:191], v[112:127]
    ds_read_b64_tr_b16 a[216:217], v228 offset:32768
    s_waitcnt lgkmcnt(14)
    ds_read_b64_tr_b16 a[218:219], v228 offset:33792
    s_waitcnt lgkmcnt(13)
    v_mfma_f32_16x16x32_bf16 v[160:163], a[128:131], a[212:215], v[160:163]
    ds_read_b64_tr_b16 a[220:221], v229 offset:32768
    ds_read_b64_tr_b16 a[222:223], v229 offset:33792
    s_waitcnt lgkmcnt(11)
    v_mfma_f32_16x16x32_bf16 v[164:167], a[132:135], a[212:215], v[164:167]
    ds_read_b64_tr_b16 a[224:225], v222 offset:8192
    ds_read_b64_tr_b16 a[226:227], v222 offset:9216
    s_waitcnt lgkmcnt(8)
    s_waitcnt vmcnt(12)
    s_barrier
    v_mfma_f32_32x32x16_bf16 v[32:47], a[136:139], a[96:99], v[32:47]
    s_add_u32 s62, s43, 4
    s_and_b32 s62, s62, 3
    s_lshl_b32 s62, s62, 7
    s_add_u32 s62, s62, 512
    s_add_u32 m0, s53, 98304
    s_nop 0
    buffer_load_dwordx4 v242, s[20:23], s62 offen lds
    v_mfma_f32_32x32x16_bf16 v[64:79], a[136:139], a[80:83], v[64:79]
    ds_read_b64_tr_b16 a[228:229], v223 offset:8192
    ds_read_b64_tr_b16 a[230:231], v223 offset:9216
    s_waitcnt lgkmcnt(8)
    v_mfma_f32_32x32x16_bf16 v[48:63], a[140:143], a[96:99], v[48:63]
    buffer_load_dwordx4 v243, s[20:23], s62 offen offset:1024 lds
    v_mfma_f32_32x32x16_bf16 v[80:95], a[140:143], a[80:83], v[80:95]
    ds_read_b64_tr_b16 a[232:233], v224 offset:8192
    ds_read_b64_tr_b16 a[234:235], v224 offset:9216
    s_waitcnt lgkmcnt(8)
    v_mfma_f32_32x32x16_bf16 v[96:111], a[216:219], a[80:83], v[96:111]
    ds_read_b64_tr_b16 a[236:237], v225 offset:8192
    ds_read_b64_tr_b16 a[238:239], v225 offset:9216
    buffer_load_dwordx4 v244, s[20:23], s62 offen offset:2048 lds
    s_waitcnt lgkmcnt(8)
    v_mfma_f32_32x32x16_bf16 v[112:127], a[220:223], a[80:83], v[112:127]
    ds_read_b64_tr_b16 a[120:121], v231
    ds_read_b64_tr_b16 a[122:123], v231 offset:1024
    s_waitcnt lgkmcnt(8)
    v_mfma_f32_32x32x16_bf16 v[32:47], a[224:227], a[100:103], v[32:47]
    buffer_load_dwordx4 v245, s[20:23], s62 offen offset:3072 lds
    v_mfma_f32_32x32x16_bf16 v[64:79], a[224:227], a[84:87], v[64:79]
    ds_read_b64_tr_b16 a[124:125], v231 offset:8
    ds_read_b64_tr_b16 a[126:127], v231 offset:1032
    s_waitcnt lgkmcnt(8)
    v_mfma_f32_32x32x16_bf16 v[48:63], a[228:231], a[100:103], v[48:63]
    s_add_u32 s62, s43, 4
    s_and_b32 s62, s62, 3
    s_lshl_b32 s62, s62, 7
    s_add_u32 s62, s62, 512
    s_add_u32 m0, s53, 102400
    s_nop 0
    buffer_load_dwordx4 v246, s[20:23], s62 offen lds
    v_mfma_f32_32x32x16_bf16 v[80:95], a[228:231], a[84:87], v[80:95]
    ds_read_b64_tr_b16 a[128:129], v222
    ds_read_b64_tr_b16 a[130:131], v222 offset:1024
    s_waitcnt lgkmcnt(8)
    v_mfma_f32_32x32x16_bf16 v[96:111], a[232:235], a[84:87], v[96:111]
    ds_read_b64_tr_b16 a[132:133], v223
    ds_read_b64_tr_b16 a[134:135], v223 offset:1024
    buffer_load_dwordx4 v247, s[20:23], s62 offen offset:1024 lds
    s_waitcnt lgkmcnt(8)
    v_mfma_f32_32x32x16_bf16 v[112:127], a[236:239], a[84:87], v[112:127]
    ds_read_b64_tr_b16 a[136:137], v224
    ds_read_b64_tr_b16 a[138:139], v224 offset:1024
    s_waitcnt lgkmcnt(8)
    v_mfma_f32_16x16x32_bf16 v[160:163], a[120:123], a[112:115], v[160:163]
    ds_read_b64_tr_b16 a[140:141], v225
    ds_read_b64_tr_b16 a[142:143], v225 offset:1024
    buffer_load_dwordx4 v248, s[20:23], s62 offen offset:2048 lds
    s_waitcnt lgkmcnt(8)
    v_mfma_f32_16x16x32_bf16 v[164:167], a[124:127], a[112:115], v[164:167]
    ds_read_b64_tr_b16 a[216:217], v222 offset:4096
    ds_read_b64_tr_b16 a[218:219], v222 offset:5120
    s_waitcnt vmcnt(9)
    s_barrier
    s_waitcnt lgkmcnt(8)
    v_mfma_f32_32x32x16_bf16 v[32:47], a[128:131], a[104:107], v[32:47]
    s_lshl_b32 s63, s43, 1
    s_add_u32 s63, s63, 8
    s_and_b32 s63, s63, 7
    s_lshl_b32 s63, s63, 18
    s_add_u32 m0, s48, 155648
    s_add_u32 s63, s63, 2097152
    buffer_load_dwordx4 v249, s[24:27], s63 offen lds
    ds_read_b128 a[176:179], v232
    v_mfma_f32_32x32x16_bf16 v[64:79], a[128:131], a[88:91], v[64:79]
    ds_read_b64_tr_b16 a[220:221], v223 offset:4096
    ds_read_b64_tr_b16 a[222:223], v223 offset:5120
    ds_read_b128 a[192:195], v236
    s_waitcnt lgkmcnt(10)
    v_mfma_f32_32x32x16_bf16 v[48:63], a[132:135], a[104:107], v[48:63]
    ds_read_b128 a[208:211], v240
    v_mfma_f32_32x32x16_bf16 v[80:95], a[132:135], a[88:91], v[80:95]
    ds_read_b64_tr_b16 a[224:225], v224 offset:4096
    ds_read_b64_tr_b16 a[226:227], v224 offset:5120
    buffer_load_dwordx4 v250, s[24:27], s63 offen offset:1024 lds
    ds_read_b128 a[180:183], v233
    s_waitcnt lgkmcnt(12)
    v_mfma_f32_32x32x16_bf16 v[96:111], a[136:139], a[88:91], v[96:111]
    ds_read_b64_tr_b16 a[228:229], v225 offset:4096
    ds_read_b64_tr_b16 a[230:231], v225 offset:5120
    ds_read_b128 a[196:199], v237
    s_waitcnt lgkmcnt(13)
    v_mfma_f32_32x32x16_bf16 v[112:127], a[140:143], a[88:91], v[112:127]
    ds_read_b64_tr_b16 a[232:233], v230
    ds_read_b64_tr_b16 a[234:235], v230 offset:1024
    s_waitcnt lgkmcnt(14)
    ds_read_b128 a[184:187], v234
    s_waitcnt lgkmcnt(14)
    v_mfma_f32_32x32x16_bf16 v[32:47], a[216:219], a[108:111], v[32:47]
    ds_read_b128 a[200:203], v238
    v_mfma_f32_32x32x16_bf16 v[64:79], a[216:219], a[92:95], v[64:79]
    s_waitcnt lgkmcnt(14)
    ds_read_b64_tr_b16 a[236:237], v230 offset:8
    s_waitcnt lgkmcnt(14)
    ds_read_b64_tr_b16 a[238:239], v230 offset:1032
    s_lshl_b32 s63, s43, 1
    s_add_u32 s63, s63, 9
    s_and_b32 s63, s63, 7
    s_lshl_b32 s63, s63, 18
    s_add_u32 m0, s48, 16384
    s_add_u32 s63, s63, 2097152
    buffer_load_dwordx4 v249, s[24:27], s63 offen lds
    s_waitcnt lgkmcnt(14)
    ds_read_b128 a[212:215], v241
    v_mfma_f32_32x32x16_bf16 v[48:63], a[220:223], a[108:111], v[48:63]
    s_waitcnt lgkmcnt(14)
    ds_read_b128 a[188:191], v235
    v_mfma_f32_32x32x16_bf16 v[80:95], a[220:223], a[92:95], v[80:95]
    s_waitcnt lgkmcnt(14)
    ds_read_b64_tr_b16 a[120:121], v222 offset:20480
    s_waitcnt lgkmcnt(14)
    ds_read_b64_tr_b16 a[122:123], v222 offset:21504
    s_waitcnt lgkmcnt(14)
    ds_read_b128 a[204:207], v239
    v_mfma_f32_32x32x16_bf16 v[96:111], a[224:227], a[92:95], v[96:111]
    s_waitcnt lgkmcnt(14)
    ds_read_b64_tr_b16 a[124:125], v223 offset:20480
    s_waitcnt lgkmcnt(14)
    ds_read_b64_tr_b16 a[126:127], v223 offset:21504
    buffer_load_dwordx4 v250, s[24:27], s63 offen offset:1024 lds
    s_waitcnt lgkmcnt(14)
    v_mfma_f32_32x32x16_bf16 v[112:127], a[228:231], a[92:95], v[112:127]
    ds_read_b64_tr_b16 a[128:129], v224 offset:20480
    s_waitcnt lgkmcnt(14)
    ds_read_b64_tr_b16 a[130:131], v224 offset:21504
    s_waitcnt lgkmcnt(13)
    v_mfma_f32_16x16x32_bf16 v[160:163], a[232:235], a[116:119], v[160:163]
    ds_read_b64_tr_b16 a[132:133], v225 offset:20480
    ds_read_b64_tr_b16 a[134:135], v225 offset:21504
    s_waitcnt lgkmcnt(11)
    v_mfma_f32_16x16x32_bf16 v[164:167], a[236:239], a[116:119], v[164:167]
    ds_read_b64_tr_b16 a[136:137], v222 offset:24576
    ds_read_b64_tr_b16 a[138:139], v222 offset:25600
    s_waitcnt lgkmcnt(8)
    s_waitcnt vmcnt(11)
    s_barrier
    v_mfma_f32_32x32x16_bf16 v[32:47], a[120:123], a[192:195], v[32:47]
    s_add_u32 s62, s43, 5
    s_and_b32 s62, s62, 3
    s_lshl_b32 s62, s62, 7
    s_add_u32 s62, s62, 512
    s_add_u32 m0, s53, 65536
    s_nop 0
    buffer_load_dwordx4 v242, s[20:23], s62 offen lds
    v_mfma_f32_32x32x16_bf16 v[64:79], a[120:123], a[176:179], v[64:79]
    ds_read_b64_tr_b16 a[140:141], v223 offset:24576
    ds_read_b64_tr_b16 a[142:143], v223 offset:25600
    s_waitcnt lgkmcnt(8)
    v_mfma_f32_32x32x16_bf16 v[48:63], a[124:127], a[192:195], v[48:63]
    buffer_load_dwordx4 v243, s[20:23], s62 offen offset:1024 lds
    v_mfma_f32_32x32x16_bf16 v[80:95], a[124:127], a[176:179], v[80:95]
    ds_read_b64_tr_b16 a[216:217], v224 offset:24576
    ds_read_b64_tr_b16 a[218:219], v224 offset:25600
    s_waitcnt lgkmcnt(8)
    v_mfma_f32_32x32x16_bf16 v[96:111], a[128:131], a[176:179], v[96:111]
    ds_read_b64_tr_b16 a[220:221], v225 offset:24576
    ds_read_b64_tr_b16 a[222:223], v225 offset:25600
    buffer_load_dwordx4 v244, s[20:23], s62 offen offset:2048 lds
    s_waitcnt lgkmcnt(8)
    v_mfma_f32_32x32x16_bf16 v[112:127], a[132:135], a[176:179], v[112:127]
    ds_read_b64_tr_b16 a[224:225], v230 offset:20480
    ds_read_b64_tr_b16 a[226:227], v230 offset:21504
    s_waitcnt lgkmcnt(8)
    v_mfma_f32_32x32x16_bf16 v[32:47], a[136:139], a[196:199], v[32:47]
    buffer_load_dwordx4 v245, s[20:23], s62 offen offset:3072 lds
    v_mfma_f32_32x32x16_bf16 v[64:79], a[136:139], a[180:183], v[64:79]
    ds_read_b64_tr_b16 a[228:229], v230 offset:20488
    ds_read_b64_tr_b16 a[230:231], v230 offset:21512
    s_waitcnt lgkmcnt(8)
    v_mfma_f32_32x32x16_bf16 v[48:63], a[140:143], a[196:199], v[48:63]
    s_add_u32 s62, s43, 5
    s_and_b32 s62, s62, 3
    s_lshl_b32 s62, s62, 7
    s_add_u32 s62, s62, 512
    s_add_u32 m0, s53, 69632
    s_nop 0
    buffer_load_dwordx4 v246, s[20:23], s62 offen lds
    v_mfma_f32_32x32x16_bf16 v[80:95], a[140:143], a[180:183], v[80:95]
    ds_read_b64_tr_b16 a[232:233], v222 offset:12288
    ds_read_b64_tr_b16 a[234:235], v222 offset:13312
    s_waitcnt lgkmcnt(8)
    v_mfma_f32_32x32x16_bf16 v[96:111], a[216:219], a[180:183], v[96:111]
    ds_read_b64_tr_b16 a[236:237], v223 offset:12288
    ds_read_b64_tr_b16 a[238:239], v223 offset:13312
    buffer_load_dwordx4 v247, s[20:23], s62 offen offset:1024 lds
    s_waitcnt lgkmcnt(8)
    v_mfma_f32_32x32x16_bf16 v[112:127], a[220:223], a[180:183], v[112:127]
    ds_read_b64_tr_b16 a[120:121], v224 offset:12288
    ds_read_b64_tr_b16 a[122:123], v224 offset:13312
    s_waitcnt lgkmcnt(8)
    v_mfma_f32_16x16x32_bf16 v[160:163], a[224:227], a[208:211], v[160:163]
    ds_read_b64_tr_b16 a[124:125], v225 offset:12288
    ds_read_b64_tr_b16 a[126:127], v225 offset:13312
    buffer_load_dwordx4 v248, s[20:23], s62 offen offset:2048 lds
    s_waitcnt lgkmcnt(8)
    v_mfma_f32_16x16x32_bf16 v[164:167], a[228:231], a[208:211], v[164:167]
    ds_read_b64_tr_b16 a[128:129], v222 offset:16384
    ds_read_b64_tr_b16 a[130:131], v222 offset:17408
    s_waitcnt vmcnt(9)
    s_barrier
    s_waitcnt lgkmcnt(8)
    v_mfma_f32_32x32x16_bf16 v[32:47], a[232:235], a[200:203], v[32:47]
    s_lshl_b32 s63, s43, 1
    s_add_u32 s63, s63, 10
    s_and_b32 s63, s63, 7
    s_lshl_b32 s63, s63, 18
    s_add_u32 m0, s48, 24576
    s_add_u32 s63, s63, 2097152
    buffer_load_dwordx4 v249, s[24:27], s63 offen lds
    ds_read_b128 a[80:83], v232 offset:61440
    v_mfma_f32_32x32x16_bf16 v[64:79], a[232:235], a[184:187], v[64:79]
    ds_read_b64_tr_b16 a[132:133], v223 offset:16384
    ds_read_b64_tr_b16 a[134:135], v223 offset:17408
    ds_read_b128 a[96:99], v236 offset:61440
    s_waitcnt lgkmcnt(10)
    v_mfma_f32_32x32x16_bf16 v[48:63], a[236:239], a[200:203], v[48:63]
    ds_read_b128 a[112:115], v240 offset:61440
    v_mfma_f32_32x32x16_bf16 v[80:95], a[236:239], a[184:187], v[80:95]
    ds_read_b64_tr_b16 a[136:137], v224 offset:16384
    ds_read_b64_tr_b16 a[138:139], v224 offset:17408
    buffer_load_dwordx4 v250, s[24:27], s63 offen offset:1024 lds
    ds_read_b128 a[84:87], v233 offset:61440
    s_waitcnt lgkmcnt(12)
    v_mfma_f32_32x32x16_bf16 v[96:111], a[120:123], a[184:187], v[96:111]
    ds_read_b64_tr_b16 a[140:141], v225 offset:16384
    ds_read_b64_tr_b16 a[142:143], v225 offset:17408
    ds_read_b128 a[100:103], v237 offset:61440
    s_waitcnt lgkmcnt(13)
    v_mfma_f32_32x32x16_bf16 v[112:127], a[124:127], a[184:187], v[112:127]
    ds_read_b64_tr_b16 a[216:217], v230 offset:12288
    ds_read_b64_tr_b16 a[218:219], v230 offset:13312
    s_waitcnt lgkmcnt(14)
    ds_read_b128 a[88:91], v234 offset:61440
    s_waitcnt lgkmcnt(14)
    v_mfma_f32_32x32x16_bf16 v[32:47], a[128:131], a[204:207], v[32:47]
    ds_read_b128 a[104:107], v238 offset:61440
    v_mfma_f32_32x32x16_bf16 v[64:79], a[128:131], a[188:191], v[64:79]
    s_waitcnt lgkmcnt(14)
    ds_read_b64_tr_b16 a[220:221], v230 offset:12296
    s_waitcnt lgkmcnt(14)
    ds_read_b64_tr_b16 a[222:223], v230 offset:13320
    s_lshl_b32 s63, s43, 1
    s_add_u32 s63, s63, 11
    s_and_b32 s63, s63, 7
    s_lshl_b32 s63, s63, 18
    s_mov_b32 m0, s49
    s_add_u32 s63, s63, 2097152
    buffer_load_dwordx4 v249, s[24:27], s63 offen lds
    s_waitcnt lgkmcnt(14)
    ds_read_b128 a[116:119], v241 offset:61440
    v_mfma_f32_32x32x16_bf16 v[48:63], a[132:135], a[204:207], v[48:63]
    s_waitcnt lgkmcnt(14)
    ds_read_b128 a[92:95], v235 offset:61440
    v_mfma_f32_32x32x16_bf16 v[80:95], a[132:135], a[188:191], v[80:95]
    s_waitcnt lgkmcnt(14)
    ds_read_b64_tr_b16 a[224:225], v222 offset:28672
    s_waitcnt lgkmcnt(14)
    ds_read_b64_tr_b16 a[226:227], v222 offset:29696
    s_waitcnt lgkmcnt(14)
    ds_read_b128 a[108:111], v239 offset:61440
    v_mfma_f32_32x32x16_bf16 v[96:111], a[136:139], a[188:191], v[96:111]
    s_waitcnt lgkmcnt(14)
    ds_read_b64_tr_b16 a[228:229], v223 offset:28672
    s_waitcnt lgkmcnt(14)
    ds_read_b64_tr_b16 a[230:231], v223 offset:29696
    buffer_load_dwordx4 v250, s[24:27], s63 offen offset:1024 lds
    s_waitcnt lgkmcnt(14)
    v_mfma_f32_32x32x16_bf16 v[112:127], a[140:143], a[188:191], v[112:127]
    ds_read_b64_tr_b16 a[232:233], v224 offset:28672
    s_waitcnt lgkmcnt(14)
    ds_read_b64_tr_b16 a[234:235], v224 offset:29696
    s_waitcnt lgkmcnt(13)
    v_mfma_f32_16x16x32_bf16 v[160:163], a[216:219], a[212:215], v[160:163]
    ds_read_b64_tr_b16 a[236:237], v225 offset:28672
    ds_read_b64_tr_b16 a[238:239], v225 offset:29696
    s_waitcnt lgkmcnt(11)
    v_mfma_f32_16x16x32_bf16 v[164:167], a[220:223], a[212:215], v[164:167]
    ds_read_b64_tr_b16 a[120:121], v222 offset:32768
    ds_read_b64_tr_b16 a[122:123], v222 offset:33792
    s_waitcnt lgkmcnt(8)
    s_waitcnt vmcnt(11)
    s_barrier
    v_mfma_f32_32x32x16_bf16 v[32:47], a[224:227], a[96:99], v[32:47]
    s_add_u32 s62, s43, 6
    s_and_b32 s62, s62, 3
    s_lshl_b32 s62, s62, 7
    s_add_u32 s62, s62, 512
    s_add_u32 m0, s53, 36864
    s_nop 0
    buffer_load_dwordx4 v242, s[20:23], s62 offen lds
    v_mfma_f32_32x32x16_bf16 v[64:79], a[224:227], a[80:83], v[64:79]
    ds_read_b64_tr_b16 a[124:125], v223 offset:32768
    ds_read_b64_tr_b16 a[126:127], v223 offset:33792
    s_waitcnt lgkmcnt(8)
    v_mfma_f32_32x32x16_bf16 v[48:63], a[228:231], a[96:99], v[48:63]
    buffer_load_dwordx4 v243, s[20:23], s62 offen offset:1024 lds
    v_mfma_f32_32x32x16_bf16 v[80:95], a[228:231], a[80:83], v[80:95]
    ds_read_b64_tr_b16 a[128:129], v224 offset:32768
    ds_read_b64_tr_b16 a[130:131], v224 offset:33792
    s_waitcnt lgkmcnt(8)
    v_mfma_f32_32x32x16_bf16 v[96:111], a[232:235], a[80:83], v[96:111]
    ds_read_b64_tr_b16 a[132:133], v225 offset:32768
    ds_read_b64_tr_b16 a[134:135], v225 offset:33792
    buffer_load_dwordx4 v244, s[20:23], s62 offen offset:2048 lds
    s_waitcnt lgkmcnt(8)
    v_mfma_f32_32x32x16_bf16 v[112:127], a[236:239], a[80:83], v[112:127]
    ds_read_b64_tr_b16 a[136:137], v230 offset:28672
    ds_read_b64_tr_b16 a[138:139], v230 offset:29696
    s_waitcnt lgkmcnt(8)
    v_mfma_f32_32x32x16_bf16 v[32:47], a[120:123], a[100:103], v[32:47]
    buffer_load_dwordx4 v245, s[20:23], s62 offen offset:3072 lds
    v_mfma_f32_32x32x16_bf16 v[64:79], a[120:123], a[84:87], v[64:79]
    ds_read_b64_tr_b16 a[140:141], v230 offset:28680
    ds_read_b64_tr_b16 a[142:143], v230 offset:29704
    s_waitcnt lgkmcnt(8)
    v_mfma_f32_32x32x16_bf16 v[48:63], a[124:127], a[100:103], v[48:63]
    s_add_u32 s62, s43, 6
    s_and_b32 s62, s62, 3
    s_lshl_b32 s62, s62, 7
    s_add_u32 s62, s62, 512
    s_add_u32 m0, s53, 40960
    s_nop 0
    buffer_load_dwordx4 v246, s[20:23], s62 offen lds
    v_mfma_f32_32x32x16_bf16 v[80:95], a[124:127], a[84:87], v[80:95]
    ds_read_b64_tr_b16 a[216:217], v226 offset:16384
    ds_read_b64_tr_b16 a[218:219], v226 offset:17408
    s_waitcnt lgkmcnt(8)
    v_mfma_f32_32x32x16_bf16 v[96:111], a[128:131], a[84:87], v[96:111]
    ds_read_b64_tr_b16 a[220:221], v227 offset:16384
    ds_read_b64_tr_b16 a[222:223], v227 offset:17408
    buffer_load_dwordx4 v247, s[20:23], s62 offen offset:1024 lds
    s_waitcnt lgkmcnt(8)
    v_mfma_f32_32x32x16_bf16 v[112:127], a[132:135], a[84:87], v[112:127]
    ds_read_b64_tr_b16 a[224:225], v228 offset:16384
    ds_read_b64_tr_b16 a[226:227], v228 offset:17408
    s_waitcnt lgkmcnt(8)
    v_mfma_f32_16x16x32_bf16 v[160:163], a[136:139], a[112:115], v[160:163]
    ds_read_b64_tr_b16 a[228:229], v229 offset:16384
    ds_read_b64_tr_b16 a[230:231], v229 offset:17408
    buffer_load_dwordx4 v248, s[20:23], s62 offen offset:2048 lds
    s_waitcnt lgkmcnt(8)
    v_mfma_f32_16x16x32_bf16 v[164:167], a[140:143], a[112:115], v[164:167]
    ds_read_b64_tr_b16 a[232:233], v226 offset:20480
    ds_read_b64_tr_b16 a[234:235], v226 offset:21504
    s_waitcnt vmcnt(9)
    s_barrier
    s_waitcnt lgkmcnt(8)
    v_mfma_f32_32x32x16_bf16 v[32:47], a[216:219], a[104:107], v[32:47]
    s_lshl_b32 s63, s43, 1
    s_add_u32 s63, s63, 12
    s_and_b32 s63, s63, 7
    s_lshl_b32 s63, s63, 18
    s_add_u32 m0, s48, 126976
    s_add_u32 s63, s63, 2097152
    buffer_load_dwordx4 v249, s[24:27], s63 offen lds
    ds_read_b128 a[176:179], v232 offset:28672
    v_mfma_f32_32x32x16_bf16 v[64:79], a[216:219], a[88:91], v[64:79]
    ds_read_b64_tr_b16 a[236:237], v227 offset:20480
    ds_read_b64_tr_b16 a[238:239], v227 offset:21504
    buffer_load_dwordx4 v250, s[24:27], s63 offen offset:1024 lds
    ds_read_b128 a[192:195], v236 offset:28672
    s_waitcnt lgkmcnt(10)
    v_mfma_f32_32x32x16_bf16 v[48:63], a[220:223], a[104:107], v[48:63]
    ds_read_b128 a[208:211], v240 offset:28672
    v_mfma_f32_32x32x16_bf16 v[80:95], a[220:223], a[88:91], v[80:95]
    ds_read_b64_tr_b16 a[120:121], v228 offset:20480
    ds_read_b64_tr_b16 a[122:123], v228 offset:21504
    s_lshl_b32 s63, s43, 1
    s_add_u32 s63, s63, 13
    s_and_b32 s63, s63, 7
    s_lshl_b32 s63, s63, 18
    s_add_u32 m0, s48, 147456
    s_add_u32 s63, s63, 2097152
    buffer_load_dwordx4 v249, s[24:27], s63 offen lds
    ds_read_b128 a[180:183], v233 offset:28672
    s_waitcnt lgkmcnt(12)
    v_mfma_f32_32x32x16_bf16 v[96:111], a[224:227], a[88:91], v[96:111]
    ds_read_b64_tr_b16 a[124:125], v229 offset:20480
    ds_read_b64_tr_b16 a[126:127], v229 offset:21504
    ds_read_b128 a[196:199], v237 offset:28672
    s_waitcnt lgkmcnt(13)
    v_mfma_f32_32x32x16_bf16 v[112:127], a[228:231], a[88:91], v[112:127]
    ds_read_b64_tr_b16 a[128:129], v251 offset:16384
    ds_read_b64_tr_b16 a[130:131], v251 offset:17408
    buffer_load_dwordx4 v250, s[24:27], s63 offen offset:1024 lds
    s_waitcnt lgkmcnt(14)
    ds_read_b128 a[184:187], v234 offset:28672
    s_waitcnt lgkmcnt(14)
    v_mfma_f32_32x32x16_bf16 v[32:47], a[232:235], a[108:111], v[32:47]
    ds_read_b128 a[200:203], v238 offset:28672
    v_mfma_f32_32x32x16_bf16 v[64:79], a[232:235], a[92:95], v[64:79]
    s_waitcnt lgkmcnt(14)
    ds_read_b64_tr_b16 a[132:133], v251 offset:16392
    s_waitcnt lgkmcnt(14)
    ds_read_b64_tr_b16 a[134:135], v251 offset:17416
    s_add_u32 s64, s3, 0
    s_and_b32 s64, s64, 114688
    s_add_u32 m0, s54, 0
    s_nop 0
    buffer_load_dwordx4 v208, s[28:31], s64 offen nt lds
    s_waitcnt lgkmcnt(14)
    ds_read_b128 a[212:215], v241 offset:28672
    v_mfma_f32_32x32x16_bf16 v[48:63], a[236:239], a[108:111], v[48:63]
    buffer_load_dwordx4 v209, s[28:31], s64 offen offset:1024 nt lds
    s_waitcnt lgkmcnt(14)
    ds_read_b128 a[188:191], v235 offset:28672
    v_mfma_f32_32x32x16_bf16 v[80:95], a[236:239], a[92:95], v[80:95]
    s_waitcnt lgkmcnt(14)
    ds_read_b64_tr_b16 a[136:137], v226 offset:24576
    s_waitcnt lgkmcnt(14)
    ds_read_b64_tr_b16 a[138:139], v226 offset:25600
    s_waitcnt lgkmcnt(14)
    ds_read_b128 a[204:207], v239 offset:28672
    v_mfma_f32_32x32x16_bf16 v[96:111], a[120:123], a[92:95], v[96:111]
    s_waitcnt lgkmcnt(14)
    ds_read_b64_tr_b16 a[140:141], v227 offset:24576
    s_waitcnt lgkmcnt(14)
    ds_read_b64_tr_b16 a[142:143], v227 offset:25600
    buffer_load_dwordx4 v210, s[28:31], s64 offen offset:2048 nt lds
    s_waitcnt lgkmcnt(14)
    v_mfma_f32_32x32x16_bf16 v[112:127], a[124:127], a[92:95], v[112:127]
    ds_read_b64_tr_b16 a[216:217], v228 offset:24576
    s_waitcnt lgkmcnt(14)
    ds_read_b64_tr_b16 a[218:219], v228 offset:25600
    s_waitcnt lgkmcnt(13)
    v_mfma_f32_16x16x32_bf16 v[160:163], a[128:131], a[116:119], v[160:163]
    ds_read_b64_tr_b16 a[220:221], v229 offset:24576
    ds_read_b64_tr_b16 a[222:223], v229 offset:25600
    buffer_load_dwordx4 v211, s[28:31], s64 offen offset:3072 nt lds
    s_waitcnt lgkmcnt(11)
    v_mfma_f32_16x16x32_bf16 v[164:167], a[132:135], a[116:119], v[164:167]
    ds_read_b64_tr_b16 a[224:225], v226 offset:28672
    ds_read_b64_tr_b16 a[226:227], v226 offset:29696
    s_waitcnt lgkmcnt(8)
    s_waitcnt vmcnt(15)
    s_barrier
    v_mfma_f32_32x32x16_bf16 v[32:47], a[136:139], a[192:195], v[32:47]
    s_add_u32 s62, s43, 7
    s_and_b32 s62, s62, 3
    s_lshl_b32 s62, s62, 7
    s_add_u32 s62, s62, 512
    s_add_u32 m0, s53, 98304
    s_nop 0
    buffer_load_dwordx4 v242, s[20:23], s62 offen lds
    v_mfma_f32_32x32x16_bf16 v[64:79], a[136:139], a[176:179], v[64:79]
    ds_read_b64_tr_b16 a[228:229], v227 offset:28672
    ds_read_b64_tr_b16 a[230:231], v227 offset:29696
    s_waitcnt lgkmcnt(8)
    v_mfma_f32_32x32x16_bf16 v[48:63], a[140:143], a[192:195], v[48:63]
    buffer_load_dwordx4 v243, s[20:23], s62 offen offset:1024 lds
    v_mfma_f32_32x32x16_bf16 v[80:95], a[140:143], a[176:179], v[80:95]
    ds_read_b64_tr_b16 a[232:233], v228 offset:28672
    ds_read_b64_tr_b16 a[234:235], v228 offset:29696
    s_waitcnt lgkmcnt(8)
    v_mfma_f32_32x32x16_bf16 v[96:111], a[216:219], a[176:179], v[96:111]
    ds_read_b64_tr_b16 a[236:237], v229 offset:28672
    ds_read_b64_tr_b16 a[238:239], v229 offset:29696
    buffer_load_dwordx4 v244, s[20:23], s62 offen offset:2048 lds
    s_waitcnt lgkmcnt(8)
    v_mfma_f32_32x32x16_bf16 v[112:127], a[220:223], a[176:179], v[112:127]
    ds_read_b64_tr_b16 a[120:121], v251 offset:24576
    ds_read_b64_tr_b16 a[122:123], v251 offset:25600
    s_waitcnt lgkmcnt(8)
    v_mfma_f32_32x32x16_bf16 v[32:47], a[224:227], a[196:199], v[32:47]
    buffer_load_dwordx4 v245, s[20:23], s62 offen offset:3072 lds
    v_mfma_f32_32x32x16_bf16 v[64:79], a[224:227], a[180:183], v[64:79]
    ds_read_b64_tr_b16 a[124:125], v251 offset:24584
    ds_read_b64_tr_b16 a[126:127], v251 offset:25608
    s_waitcnt lgkmcnt(8)
    v_mfma_f32_32x32x16_bf16 v[48:63], a[228:231], a[196:199], v[48:63]
    s_add_u32 s62, s43, 7
    s_and_b32 s62, s62, 3
    s_lshl_b32 s62, s62, 7
    s_add_u32 s62, s62, 512
    s_add_u32 m0, s53, 102400
    s_nop 0
    buffer_load_dwordx4 v246, s[20:23], s62 offen lds
    v_mfma_f32_32x32x16_bf16 v[80:95], a[228:231], a[180:183], v[80:95]
    ds_read_b64_tr_b16 a[128:129], v226 offset:32768
    ds_read_b64_tr_b16 a[130:131], v226 offset:33792
    s_waitcnt lgkmcnt(8)
    v_mfma_f32_32x32x16_bf16 v[96:111], a[232:235], a[180:183], v[96:111]
    ds_read_b64_tr_b16 a[132:133], v227 offset:32768
    ds_read_b64_tr_b16 a[134:135], v227 offset:33792
    buffer_load_dwordx4 v247, s[20:23], s62 offen offset:1024 lds
    s_waitcnt lgkmcnt(8)
    v_mfma_f32_32x32x16_bf16 v[112:127], a[236:239], a[180:183], v[112:127]
    ds_read_b64_tr_b16 a[136:137], v228 offset:32768
    ds_read_b64_tr_b16 a[138:139], v228 offset:33792
    s_waitcnt lgkmcnt(8)
    v_mfma_f32_16x16x32_bf16 v[160:163], a[120:123], a[208:211], v[160:163]
    ds_read_b64_tr_b16 a[140:141], v229 offset:32768
    ds_read_b64_tr_b16 a[142:143], v229 offset:33792
    buffer_load_dwordx4 v248, s[20:23], s62 offen offset:2048 lds
    s_waitcnt lgkmcnt(8)
    v_mfma_f32_16x16x32_bf16 v[164:167], a[124:127], a[208:211], v[164:167]
    ds_read_b64_tr_b16 a[216:217], v222 offset:8192
    ds_read_b64_tr_b16 a[218:219], v222 offset:9216
    s_waitcnt vmcnt(13)
    s_barrier
    s_waitcnt lgkmcnt(8)
    v_mfma_f32_32x32x16_bf16 v[32:47], a[128:131], a[200:203], v[32:47]
    s_lshl_b32 s63, s43, 1
    s_add_u32 s63, s63, 14
    s_and_b32 s63, s63, 7
    s_lshl_b32 s63, s63, 18
    s_add_u32 m0, s48, 139264
    s_add_u32 s63, s63, 2097152
    buffer_load_dwordx4 v249, s[24:27], s63 offen lds
    ds_read_b128 a[80:83], v232
    v_mfma_f32_32x32x16_bf16 v[64:79], a[128:131], a[184:187], v[64:79]
    ds_read_b64_tr_b16 a[220:221], v223 offset:8192
    ds_read_b64_tr_b16 a[222:223], v223 offset:9216
    buffer_load_dwordx4 v250, s[24:27], s63 offen offset:1024 lds
    ds_read_b128 a[96:99], v236
    s_waitcnt lgkmcnt(10)
    v_mfma_f32_32x32x16_bf16 v[48:63], a[132:135], a[200:203], v[48:63]
    s_lshl_b32 s63, s43, 1
    s_add_u32 s63, s63, 15
    s_and_b32 s63, s63, 7
    s_lshl_b32 s63, s63, 18
    s_add_u32 m0, s48, 155648
    s_add_u32 s63, s63, 2097152
    buffer_load_dwordx4 v249, s[24:27], s63 offen lds
    ds_read_b128 a[112:115], v240
    v_mfma_f32_32x32x16_bf16 v[80:95], a[132:135], a[184:187], v[80:95]
    ds_read_b64_tr_b16 a[224:225], v224 offset:8192
    ds_read_b64_tr_b16 a[226:227], v224 offset:9216
    ds_read_b128 a[84:87], v233
    s_waitcnt lgkmcnt(12)
    v_mfma_f32_32x32x16_bf16 v[96:111], a[136:139], a[184:187], v[96:111]
    ds_read_b64_tr_b16 a[228:229], v225 offset:8192
    ds_read_b64_tr_b16 a[230:231], v225 offset:9216
    buffer_load_dwordx4 v250, s[24:27], s63 offen offset:1024 lds
    ds_read_b128 a[100:103], v237
    s_waitcnt lgkmcnt(13)
    v_mfma_f32_32x32x16_bf16 v[112:127], a[140:143], a[184:187], v[112:127]
    ds_read_b64_tr_b16 a[232:233], v231
    ds_read_b64_tr_b16 a[234:235], v231 offset:1024
    s_add_u32 s64, s3, 0
    s_and_b32 s64, s64, 114688
    s_add_u32 m0, s54, 65536
    s_nop 0
    buffer_load_dwordx4 v212, s[32:35], s64 offen nt lds
    s_waitcnt lgkmcnt(14)
    ds_read_b128 a[88:91], v234
    s_waitcnt lgkmcnt(14)
    v_mfma_f32_32x32x16_bf16 v[32:47], a[216:219], a[204:207], v[32:47]
    ds_read_b128 a[104:107], v238
    v_mfma_f32_32x32x16_bf16 v[64:79], a[216:219], a[188:191], v[64:79]
    s_waitcnt lgkmcnt(14)
    ds_read_b64_tr_b16 a[236:237], v231 offset:8
    s_waitcnt lgkmcnt(14)
    ds_read_b64_tr_b16 a[238:239], v231 offset:1032
    buffer_load_dwordx4 v212, s[32:35], s64 offen offset:1024 nt lds
    s_waitcnt lgkmcnt(14)
    ds_read_b128 a[116:119], v241
    v_mfma_f32_32x32x16_bf16 v[48:63], a[220:223], a[204:207], v[48:63]
    buffer_load_dwordx4 v212, s[32:35], s64 offen offset:2048 nt lds
    s_waitcnt lgkmcnt(14)
    ds_read_b128 a[92:95], v235
    v_mfma_f32_32x32x16_bf16 v[80:95], a[220:223], a[188:191], v[80:95]
    s_waitcnt lgkmcnt(14)
    ds_read_b64_tr_b16 a[120:121], v222
    s_waitcnt lgkmcnt(14)
    ds_read_b64_tr_b16 a[122:123], v222 offset:1024
    buffer_load_dwordx4 v212, s[32:35], s64 offen offset:3072 nt lds
    s_waitcnt lgkmcnt(14)
    ds_read_b128 a[108:111], v239
    v_mfma_f32_32x32x16_bf16 v[96:111], a[224:227], a[188:191], v[96:111]
    s_waitcnt lgkmcnt(14)
    ds_read_b64_tr_b16 a[124:125], v223
    s_waitcnt lgkmcnt(14)
    ds_read_b64_tr_b16 a[126:127], v223 offset:1024
    s_waitcnt lgkmcnt(14)
    v_mfma_f32_32x32x16_bf16 v[112:127], a[228:231], a[188:191], v[112:127]
    ds_read_b64_tr_b16 a[128:129], v224
    s_waitcnt lgkmcnt(14)
    ds_read_b64_tr_b16 a[130:131], v224 offset:1024
    s_add_u32 s64, s3, 16384
    s_and_b32 s64, s64, 114688
    s_add_u32 m0, s54, 16384
    s_nop 0
    buffer_load_dwordx4 v208, s[28:31], s64 offen nt lds
    s_waitcnt lgkmcnt(13)
    v_mfma_f32_16x16x32_bf16 v[160:163], a[232:235], a[212:215], v[160:163]
    ds_read_b64_tr_b16 a[132:133], v225
    ds_read_b64_tr_b16 a[134:135], v225 offset:1024
    buffer_load_dwordx4 v209, s[28:31], s64 offen offset:1024 nt lds
    s_waitcnt lgkmcnt(11)
    v_mfma_f32_16x16x32_bf16 v[164:167], a[236:239], a[212:215], v[164:167]
    ds_read_b64_tr_b16 a[136:137], v222 offset:4096
    ds_read_b64_tr_b16 a[138:139], v222 offset:5120
    s_waitcnt lgkmcnt(8)
    s_waitcnt vmcnt(21)
    s_barrier
    v_mfma_f32_32x32x16_bf16 v[32:47], a[120:123], a[96:99], v[32:47]
    s_add_u32 s64, s3, 16384
    s_and_b32 s64, s64, 114688
    s_add_u32 m0, s54, 16384
    s_nop 0
    buffer_load_dwordx4 v210, s[28:31], s64 offen offset:2048 nt lds
    v_mfma_f32_32x32x16_bf16 v[64:79], a[120:123], a[80:83], v[64:79]
    ds_read_b64_tr_b16 a[140:141], v223 offset:4096
    ds_read_b64_tr_b16 a[142:143], v223 offset:5120
    s_waitcnt lgkmcnt(8)
    v_mfma_f32_32x32x16_bf16 v[48:63], a[124:127], a[96:99], v[48:63]
    v_mfma_f32_32x32x16_bf16 v[80:95], a[124:127], a[80:83], v[80:95]
    ds_read_b64_tr_b16 a[216:217], v224 offset:4096
    ds_read_b64_tr_b16 a[218:219], v224 offset:5120
    buffer_load_dwordx4 v211, s[28:31], s64 offen offset:3072 nt lds
    s_waitcnt lgkmcnt(8)
    v_mfma_f32_32x32x16_bf16 v[96:111], a[128:131], a[80:83], v[96:111]
    ds_read_b64_tr_b16 a[220:221], v225 offset:4096
    ds_read_b64_tr_b16 a[222:223], v225 offset:5120
    s_waitcnt lgkmcnt(8)
    v_mfma_f32_32x32x16_bf16 v[112:127], a[132:135], a[80:83], v[112:127]
    ds_read_b64_tr_b16 a[224:225], v230
    ds_read_b64_tr_b16 a[226:227], v230 offset:1024
    s_waitcnt lgkmcnt(8)
    v_mfma_f32_32x32x16_bf16 v[32:47], a[136:139], a[100:103], v[32:47]
    v_mfma_f32_32x32x16_bf16 v[64:79], a[136:139], a[84:87], v[64:79]
    ds_read_b64_tr_b16 a[228:229], v230 offset:8
    ds_read_b64_tr_b16 a[230:231], v230 offset:1032
    s_add_u32 s64, s3, 16384
    s_and_b32 s64, s64, 114688
    s_add_u32 m0, s54, 81920
    s_nop 0
    buffer_load_dwordx4 v212, s[32:35], s64 offen nt lds
    s_waitcnt lgkmcnt(8)
    v_mfma_f32_32x32x16_bf16 v[48:63], a[140:143], a[100:103], v[48:63]
    v_mfma_f32_32x32x16_bf16 v[80:95], a[140:143], a[84:87], v[80:95]
    ds_read_b64_tr_b16 a[232:233], v222 offset:20480
    ds_read_b64_tr_b16 a[234:235], v222 offset:21504
    s_waitcnt lgkmcnt(8)
    v_mfma_f32_32x32x16_bf16 v[96:111], a[216:219], a[84:87], v[96:111]
    ds_read_b64_tr_b16 a[236:237], v223 offset:20480
    ds_read_b64_tr_b16 a[238:239], v223 offset:21504
    buffer_load_dwordx4 v212, s[32:35], s64 offen offset:1024 nt lds
    s_waitcnt lgkmcnt(8)
    v_mfma_f32_32x32x16_bf16 v[112:127], a[220:223], a[84:87], v[112:127]
    ds_read_b64_tr_b16 a[120:121], v224 offset:20480
    ds_read_b64_tr_b16 a[122:123], v224 offset:21504
    s_waitcnt lgkmcnt(8)
    v_mfma_f32_16x16x32_bf16 v[160:163], a[224:227], a[112:115], v[160:163]
    ds_read_b64_tr_b16 a[124:125], v225 offset:20480
    ds_read_b64_tr_b16 a[126:127], v225 offset:21504
    s_waitcnt lgkmcnt(8)
    v_mfma_f32_16x16x32_bf16 v[164:167], a[228:231], a[112:115], v[164:167]
    ds_read_b64_tr_b16 a[128:129], v222 offset:24576
    ds_read_b64_tr_b16 a[130:131], v222 offset:25600
    s_waitcnt vmcnt(12)
    s_barrier
    s_lshl_b32 s44, s66, 20
    s_lshl_b32 s45, s101, 15
    s_add_u32 s45, s45, s70
    s_add_u32 s45, s44, s45
    s_add_u32 s48, s12, s45
    s_addc_u32 s49, s13, 0
    s_and_b32 s49, s49, 0xffff
    s_mov_b32 s50, 8192
    s_mov_b32 s51, 0x20000
    s_lshl_b32 s45, s42, 15
    s_add_u32 s44, s44, s45
    s_lshl_b32 s45, s67, 7
    s_add_u32 s44, s44, s45
    s_sub_u32 s45, 4194304, s44
    s_add_u32 s20, s12, s44
    s_addc_u32 s21, s13, 0
    s_and_b32 s21, s21, 0xffff
    s_mov_b32 s22, s45
    s_mov_b32 s23, 0x20000
    s_lshr_b32 s44, s65, 3
    s_mul_i32 s44, s44, 425984
    s_add_u32 s24, s18, s44
    s_addc_u32 s25, s19, 0
    s_and_b32 s25, s25, 0xffff
    s_mov_b32 s26, 425984
    s_mov_b32 s27, 0x20000
    s_waitcnt lgkmcnt(8)
    v_mfma_f32_32x32x16_bf16 v[32:47], a[232:235], a[104:107], v[32:47]
    s_add_u32 s64, s3, 16384
    s_and_b32 s64, s64, 114688
    s_add_u32 m0, s54, 81920
    s_nop 0
    buffer_load_dwordx4 v212, s[32:35], s64 offen offset:2048 nt lds
    ds_read_b128 a[176:179], v232 offset:61440
    v_mfma_f32_32x32x16_bf16 v[64:79], a[232:235], a[88:91], v[64:79]
    ds_read_b64_tr_b16 a[132:133], v223 offset:24576
    ds_read_b64_tr_b16 a[134:135], v223 offset:25600
    ds_read_b128 a[192:195], v236 offset:61440
    s_waitcnt lgkmcnt(10)
    v_mfma_f32_32x32x16_bf16 v[48:63], a[236:239], a[104:107], v[48:63]
    ds_read_b128 a[208:211], v240 offset:61440
    v_mfma_f32_32x32x16_bf16 v[80:95], a[236:239], a[88:91], v[80:95]
    ds_read_b64_tr_b16 a[136:137], v224 offset:24576
    ds_read_b64_tr_b16 a[138:139], v224 offset:25600
    ds_read_b128 a[180:183], v233 offset:61440
    s_waitcnt lgkmcnt(12)
    v_mfma_f32_32x32x16_bf16 v[96:111], a[120:123], a[88:91], v[96:111]
    ds_read_b64_tr_b16 a[140:141], v225 offset:24576
    ds_read_b64_tr_b16 a[142:143], v225 offset:25600
    ds_read_b128 a[196:199], v237 offset:61440
    s_waitcnt lgkmcnt(13)
    v_mfma_f32_32x32x16_bf16 v[112:127], a[124:127], a[88:91], v[112:127]
    ds_read_b64_tr_b16 a[216:217], v230 offset:20480
    ds_read_b64_tr_b16 a[218:219], v230 offset:21504
    s_waitcnt lgkmcnt(14)
    ds_read_b128 a[184:187], v234 offset:61440
    s_waitcnt lgkmcnt(14)
    v_mfma_f32_32x32x16_bf16 v[32:47], a[128:131], a[108:111], v[32:47]
    ds_read_b128 a[200:203], v238 offset:61440
    v_mfma_f32_32x32x16_bf16 v[64:79], a[128:131], a[92:95], v[64:79]
    s_waitcnt lgkmcnt(14)
    ds_read_b64_tr_b16 a[220:221], v230 offset:20488
    s_waitcnt lgkmcnt(14)
    ds_read_b64_tr_b16 a[222:223], v230 offset:21512
    buffer_load_dwordx4 v212, s[32:35], s64 offen offset:3072 nt lds
    s_waitcnt lgkmcnt(14)
    ds_read_b128 a[212:215], v241 offset:61440
    v_mfma_f32_32x32x16_bf16 v[48:63], a[132:135], a[108:111], v[48:63]
    s_waitcnt lgkmcnt(14)
    ds_read_b128 a[188:191], v235 offset:61440
    v_mfma_f32_32x32x16_bf16 v[80:95], a[132:135], a[92:95], v[80:95]
    s_waitcnt lgkmcnt(14)
    ds_read_b64_tr_b16 a[224:225], v230 offset:12288
    s_waitcnt lgkmcnt(14)
    ds_read_b64_tr_b16 a[226:227], v230 offset:13312
    s_waitcnt lgkmcnt(14)
    ds_read_b128 a[204:207], v239 offset:61440
    v_mfma_f32_32x32x16_bf16 v[96:111], a[136:139], a[92:95], v[96:111]
    s_waitcnt lgkmcnt(14)
    ds_read_b64_tr_b16 a[228:229], v230 offset:12296
    s_waitcnt lgkmcnt(14)
    ds_read_b64_tr_b16 a[230:231], v230 offset:13320
    s_waitcnt lgkmcnt(14)
    v_mfma_f32_32x32x16_bf16 v[112:127], a[140:143], a[92:95], v[112:127]
    ds_read_b64_tr_b16 a[232:233], v222 offset:12288
    s_waitcnt lgkmcnt(14)
    ds_read_b64_tr_b16 a[234:235], v222 offset:13312
    s_waitcnt lgkmcnt(13)
    v_mfma_f32_16x16x32_bf16 v[160:163], a[216:219], a[116:119], v[160:163]
    ds_read_b64_tr_b16 a[236:237], v222 offset:16384
    ds_read_b64_tr_b16 a[238:239], v222 offset:17408
    s_waitcnt lgkmcnt(11)
    v_mfma_f32_16x16x32_bf16 v[164:167], a[220:223], a[116:119], v[164:167]
    ds_read_b64_tr_b16 a[120:121], v223 offset:12288
    ds_read_b64_tr_b16 a[122:123], v223 offset:13312
    s_waitcnt lgkmcnt(8)
    s_waitcnt vmcnt(12)
    s_barrier
    v_mfma_f32_16x16x32_bf16 v[160:163], a[224:227], a[208:211], v[160:163]
    ds_read_b64_tr_b16 a[124:125], v223 offset:16384
    ds_read_b64_tr_b16 a[126:127], v223 offset:17408
    s_add_u32 s64, s3, 32768
    s_and_b32 s64, s64, 114688
    s_add_u32 m0, s54, 32768
    s_nop 0
    buffer_load_dwordx4 v208, s[28:31], s64 offen nt lds
    s_waitcnt lgkmcnt(8)
    v_mfma_f32_16x16x32_bf16 v[164:167], a[228:231], a[208:211], v[164:167]
    ds_read_b64_tr_b16 a[128:129], v230 offset:28672
    ds_read_b64_tr_b16 a[130:131], v230 offset:29696
    s_waitcnt lgkmcnt(8)
    v_mfma_f32_32x32x16_bf16 v[32:47], a[232:235], a[192:195], v[32:47]
    v_mfma_f32_32x32x16_bf16 v[64:79], a[232:235], a[176:179], v[64:79]
    ds_read_b64_tr_b16 a[132:133], v230 offset:28680
    ds_read_b64_tr_b16 a[134:135], v230 offset:29704
    s_waitcnt lgkmcnt(8)
    v_mfma_f32_32x32x16_bf16 v[32:47], a[236:239], a[196:199], v[32:47]
    v_mfma_f32_32x32x16_bf16 v[64:79], a[236:239], a[180:183], v[64:79]
    ds_read_b64_tr_b16 a[136:137], v222 offset:28672
    ds_read_b64_tr_b16 a[138:139], v222 offset:29696
    s_waitcnt lgkmcnt(8)
    v_mfma_f32_32x32x16_bf16 v[48:63], a[120:123], a[192:195], v[48:63]
    v_mfma_f32_32x32x16_bf16 v[80:95], a[120:123], a[176:179], v[80:95]
    ds_read_b64_tr_b16 a[140:141], v222 offset:32768
    ds_read_b64_tr_b16 a[142:143], v222 offset:33792
    buffer_load_dwordx4 v209, s[28:31], s64 offen offset:1024 nt lds
    s_waitcnt lgkmcnt(8)
    v_mfma_f32_32x32x16_bf16 v[48:63], a[124:127], a[196:199], v[48:63]
    v_mfma_f32_32x32x16_bf16 v[80:95], a[124:127], a[180:183], v[80:95]
    ds_read_b64_tr_b16 a[216:217], v223 offset:28672
    ds_read_b64_tr_b16 a[218:219], v223 offset:29696
    s_waitcnt lgkmcnt(8)
    v_mfma_f32_16x16x32_bf16 v[160:163], a[128:131], a[212:215], v[160:163]
    ds_read_b64_tr_b16 a[220:221], v223 offset:32768
    ds_read_b64_tr_b16 a[222:223], v223 offset:33792
    s_waitcnt lgkmcnt(8)
    v_mfma_f32_16x16x32_bf16 v[164:167], a[132:135], a[212:215], v[164:167]
    ds_read_b64_tr_b16 a[224:225], v224 offset:12288
    ds_read_b64_tr_b16 a[226:227], v224 offset:13312
    s_waitcnt lgkmcnt(8)
    v_mfma_f32_32x32x16_bf16 v[32:47], a[136:139], a[200:203], v[32:47]
    v_mfma_f32_32x32x16_bf16 v[64:79], a[136:139], a[184:187], v[64:79]
    ds_read_b64_tr_b16 a[228:229], v224 offset:16384
    ds_read_b64_tr_b16 a[230:231], v224 offset:17408
    v_mul_f32 v160, s57, v160
    v_mul_f32 v161, s57, v161
    v_cvt_pk_bf16_f32 v160, v160, v161
    v_mul_f32 v162, s57, v162
    v_mul_f32 v163, s57, v163
    s_waitcnt lgkmcnt(8)
    v_mfma_f32_32x32x16_bf16 v[32:47], a[140:143], a[204:207], v[32:47]
    buffer_load_dwordx4 v210, s[28:31], s64 offen offset:2048 nt lds
    v_cvt_pk_bf16_f32 v161, v162, v163
    v_mul_f32 v164, s57, v164
    v_mul_f32 v165, s57, v165
    v_cvt_pk_bf16_f32 v162, v164, v165
    v_mfma_f32_32x32x16_bf16 v[64:79], a[140:143], a[188:191], v[64:79]
    ds_read_b64_tr_b16 a[232:233], v224 offset:28672
    ds_read_b64_tr_b16 a[234:235], v224 offset:29696
    v_mul_f32 v166, s57, v166
    v_mul_f32 v167, s57, v167
    v_cvt_pk_bf16_f32 v163, v166, v167
    ds_write_b128 v10, v[160:163]
    s_waitcnt lgkmcnt(9)
    v_mfma_f32_32x32x16_bf16 v[48:63], a[216:219], a[200:203], v[48:63]
    v_mfma_f32_32x32x16_bf16 v[80:95], a[216:219], a[184:187], v[80:95]
    ds_read_b64_tr_b16 a[236:237], v224 offset:32768
    ds_read_b64_tr_b16 a[238:239], v224 offset:33792
    v_mul_f32 v32, s57, v32
    v_mul_f32 v33, s57, v33
    v_cvt_pk_bf16_f32 v32, v32, v33
    v_mul_f32 v34, s57, v34
    v_mul_f32 v35, s57, v35
    v_cvt_pk_bf16_f32 v33, v34, v35
    v_mul_f32 v36, s57, v36
    v_mul_f32 v37, s57, v37
    v_cvt_pk_bf16_f32 v34, v36, v37
    s_waitcnt lgkmcnt(9)
    v_mfma_f32_32x32x16_bf16 v[48:63], a[220:223], a[204:207], v[48:63]
    v_mul_f32 v38, s57, v38
    v_mul_f32 v39, s57, v39
    v_cvt_pk_bf16_f32 v35, v38, v39
    v_mul_f32 v40, s57, v40
    v_mul_f32 v41, s57, v41
    v_cvt_pk_bf16_f32 v36, v40, v41
    v_mul_f32 v42, s57, v42
    v_mul_f32 v43, s57, v43
    v_cvt_pk_bf16_f32 v37, v42, v43
    v_mul_f32 v44, s57, v44
    v_mul_f32 v45, s57, v45
    v_cvt_pk_bf16_f32 v38, v44, v45
    v_mul_f32 v46, s57, v46
    v_mfma_f32_32x32x16_bf16 v[80:95], a[220:223], a[188:191], v[80:95]
    ds_read_b64_tr_b16 a[120:121], v225 offset:12288
    ds_read_b64_tr_b16 a[122:123], v225 offset:13312
    v_mul_f32 v47, s57, v47
    v_cvt_pk_bf16_f32 v39, v46, v47
    ds_write_b128 v9, v[32:35]
    ds_write_b128 v9, v[36:39] offset:1024
    v_accvgpr_write_b32 a32, v32
    v_accvgpr_write_b32 a33, v33
    v_accvgpr_write_b32 a34, v34
    s_waitcnt lgkmcnt(11)
    v_mfma_f32_32x32x16_bf16 v[96:111], a[224:227], a[176:179], v[96:111]
    ds_read_b64_tr_b16 a[124:125], v225 offset:16384
    ds_read_b64_tr_b16 a[126:127], v225 offset:17408
    ds_read_b128 a[144:147], v176
    ds_read_b128 a[148:151], v177
    v_accvgpr_write_b32 a35, v35
    v_accvgpr_write_b32 a36, v36
    v_accvgpr_write_b32 a37, v37
    v_accvgpr_write_b32 a38, v38
    v_accvgpr_write_b32 a39, v39
    s_waitcnt lgkmcnt(13)
    v_mfma_f32_32x32x16_bf16 v[96:111], a[228:231], a[180:183], v[96:111]
    ds_read_b64_tr_b16 a[128:129], v225 offset:28672
    ds_read_b64_tr_b16 a[130:131], v225 offset:29696
    buffer_load_dwordx4 v211, s[28:31], s64 offen offset:3072 nt lds
    s_waitcnt lgkmcnt(14)
    ds_read_b128 a[152:155], v178
    v_mul_f32 v48, s57, v48
    v_mul_f32 v49, s57, v49
    v_cvt_pk_bf16_f32 v40, v48, v49
    s_waitcnt lgkmcnt(14)
    v_mfma_f32_32x32x16_bf16 v[96:111], a[232:235], a[184:187], v[96:111]
    ds_read_b64_tr_b16 a[132:133], v225 offset:32768
    s_waitcnt lgkmcnt(14)
    ds_read_b64_tr_b16 a[134:135], v225 offset:33792
    s_waitcnt lgkmcnt(14)
    ds_read_b128 a[156:159], v179
    v_mul_f32 v50, s57, v50
    v_mul_f32 v51, s57, v51
    v_cvt_pk_bf16_f32 v41, v50, v51
    v_mul_f32 v52, s57, v52
    v_mul_f32 v53, s57, v53
    v_cvt_pk_bf16_f32 v42, v52, v53
    v_mul_f32 v54, s57, v54
    v_mul_f32 v55, s57, v55
    s_waitcnt lgkmcnt(14)
    v_mfma_f32_32x32x16_bf16 v[96:111], a[236:239], a[188:191], v[96:111]
    ds_read_b128 a[160:163], v180
    v_cvt_pk_bf16_f32 v43, v54, v55
    v_mul_f32 v56, s57, v56
    v_mul_f32 v57, s57, v57
    v_cvt_pk_bf16_f32 v44, v56, v57
    v_mul_f32 v58, s57, v58
    v_mul_f32 v59, s57, v59
    v_cvt_pk_bf16_f32 v45, v58, v59
    v_mul_f32 v60, s57, v60
    v_mul_f32 v61, s57, v61
    v_cvt_pk_bf16_f32 v46, v60, v61
    v_mul_f32 v62, s57, v62
    v_mul_f32 v63, s57, v63
    s_waitcnt lgkmcnt(13)
    v_mfma_f32_32x32x16_bf16 v[112:127], a[120:123], a[176:179], v[112:127]
    ds_read_b128 a[164:167], v181
    v_cvt_pk_bf16_f32 v47, v62, v63
    ds_write_b128 v9, v[40:43] offset:2048
    s_waitcnt lgkmcnt(14)
    ds_write_b128 v9, v[44:47] offset:3072
    v_accvgpr_write_b32 a40, v40
    v_accvgpr_write_b32 a41, v41
    v_accvgpr_write_b32 a42, v42
    v_accvgpr_write_b32 a43, v43
    v_accvgpr_write_b32 a44, v44
    v_accvgpr_write_b32 a45, v45
    v_accvgpr_write_b32 a46, v46
    v_accvgpr_write_b32 a47, v47
    s_waitcnt lgkmcnt(12)
    v_mfma_f32_32x32x16_bf16 v[112:127], a[124:127], a[180:183], v[112:127]
    ds_read_b128 a[168:171], v182
    v_mul_f32 v64, s57, v64
    v_mul_f32 v65, s57, v65
    v_cvt_pk_bf16_f32 v64, v64, v65
    v_mul_f32 v66, s57, v66
    v_mul_f32 v67, s57, v67
    v_cvt_pk_bf16_f32 v65, v66, v67
    v_mul_f32 v68, s57, v68
    v_mul_f32 v69, s57, v69
    v_cvt_pk_bf16_f32 v66, v68, v69
    v_mul_f32 v70, s57, v70
    s_waitcnt lgkmcnt(9)
    v_mfma_f32_32x32x16_bf16 v[112:127], a[128:131], a[184:187], v[112:127]
    ds_read_b128 a[172:175], v183
    v_mul_f32 v71, s57, v71
    v_cvt_pk_bf16_f32 v67, v70, v71
    v_mul_f32 v72, s57, v72
    v_mul_f32 v73, s57, v73
    v_cvt_pk_bf16_f32 v68, v72, v73
    v_mul_f32 v74, s57, v74
    v_mul_f32 v75, s57, v75
    v_cvt_pk_bf16_f32 v69, v74, v75
    v_mul_f32 v76, s57, v76
    v_mul_f32 v77, s57, v77
    s_waitcnt lgkmcnt(7)
    v_mfma_f32_32x32x16_bf16 v[112:127], a[132:135], a[188:191], v[112:127]
    v_cvt_pk_bf16_f32 v70, v76, v77
    v_mul_f32 v78, s57, v78
    v_mul_f32 v79, s57, v79
    v_cvt_pk_bf16_f32 v71, v78, v79
    v_accvgpr_write_b32 a0, v64
    v_accvgpr_write_b32 a1, v65
    v_accvgpr_write_b32 a2, v66
    v_accvgpr_write_b32 a3, v67
    v_accvgpr_write_b32 a4, v68
    v_accvgpr_write_b32 a5, v69
    v_accvgpr_write_b32 a6, v70
    v_accvgpr_write_b32 a7, v71
    v_mul_f32 v80, s57, v80
    v_mul_f32 v81, s57, v81
    v_cvt_pk_bf16_f32 v80, v80, v81
    v_mul_f32 v82, s57, v82
    v_mul_f32 v83, s57, v83
    v_cvt_pk_bf16_f32 v81, v82, v83
    v_mul_f32 v84, s57, v84
    v_mul_f32 v85, s57, v85
    v_cvt_pk_bf16_f32 v82, v84, v85
    v_mul_f32 v86, s57, v86
    v_mul_f32 v87, s57, v87
    v_cvt_pk_bf16_f32 v83, v86, v87
    v_mul_f32 v88, s57, v88
    v_mul_f32 v89, s57, v89
    v_cvt_pk_bf16_f32 v84, v88, v89
    v_mul_f32 v90, s57, v90
    v_mul_f32 v91, s57, v91
    v_cvt_pk_bf16_f32 v85, v90, v91
    v_mul_f32 v92, s57, v92
    v_mul_f32 v93, s57, v93
    v_cvt_pk_bf16_f32 v86, v92, v93
    v_mul_f32 v94, s57, v94
    v_mul_f32 v95, s57, v95
    v_cvt_pk_bf16_f32 v87, v94, v95
    v_accvgpr_write_b32 a8, v80
    v_accvgpr_write_b32 a9, v81
    v_accvgpr_write_b32 a10, v82
    v_accvgpr_write_b32 a11, v83
    v_accvgpr_write_b32 a12, v84
    v_accvgpr_write_b32 a13, v85
    v_accvgpr_write_b32 a14, v86
    v_accvgpr_write_b32 a15, v87
    v_xor_b32 v9, 4096, v9
    v_add_u32 v10, 131072, v8
    v_mfma_f32_32x32x16_bf16 v[16:31], a[144:147], a[0:3], 0
    v_mul_f32 v96, s57, v96
    v_mul_f32 v97, s57, v97
    v_cvt_pk_bf16_f32 v96, v96, v97
    v_mul_f32 v98, s57, v98
    v_mul_f32 v99, s57, v99
    v_cvt_pk_bf16_f32 v97, v98, v99
    v_mul_f32 v100, s57, v100
    v_mul_f32 v101, s57, v101
    v_mfma_f32_32x32x16_bf16 v[16:31], a[148:151], a[4:7], v[16:31]
    v_cvt_pk_bf16_f32 v98, v100, v101
    v_mul_f32 v102, s57, v102
    v_mul_f32 v103, s57, v103
    v_cvt_pk_bf16_f32 v99, v102, v103
    v_mul_f32 v104, s57, v104
    v_mul_f32 v105, s57, v105
    v_cvt_pk_bf16_f32 v100, v104, v105
    v_mul_f32 v106, s57, v106
    v_mfma_f32_32x32x16_bf16 v[16:31], a[152:155], a[8:11], v[16:31]
    v_mul_f32 v107, s57, v107
    v_cvt_pk_bf16_f32 v101, v106, v107
    v_mul_f32 v108, s57, v108
    v_mul_f32 v109, s57, v109
    v_cvt_pk_bf16_f32 v102, v108, v109
    v_mul_f32 v110, s57, v110
    v_mul_f32 v111, s57, v111
    v_cvt_pk_bf16_f32 v103, v110, v111
    v_mul_f32 v112, s57, v112
    s_waitcnt lgkmcnt(6)
    v_mfma_f32_32x32x16_bf16 v[16:31], a[156:159], a[12:15], v[16:31]
    v_accvgpr_write_b32 a16, v96
    v_accvgpr_write_b32 a17, v97
    v_accvgpr_write_b32 a18, v98
    v_accvgpr_write_b32 a19, v99
    v_accvgpr_write_b32 a20, v100
    v_accvgpr_write_b32 a21, v101
    v_accvgpr_write_b32 a22, v102
    v_accvgpr_write_b32 a23, v103
    s_waitcnt lgkmcnt(5)
    v_mfma_f32_32x32x16_bf16 v[16:31], a[160:163], a[16:19], v[16:31]
    v_mul_f32 v113, s57, v113
    v_cvt_pk_bf16_f32 v112, v112, v113
    v_mul_f32 v114, s57, v114
    v_mul_f32 v115, s57, v115
    v_cvt_pk_bf16_f32 v113, v114, v115
    v_mul_f32 v116, s57, v116
    v_mul_f32 v117, s57, v117
    v_cvt_pk_bf16_f32 v114, v116, v117
    v_mul_f32 v118, s57, v118
    v_mul_f32 v119, s57, v119
    v_cvt_pk_bf16_f32 v115, v118, v119
    v_mul_f32 v120, s57, v120
    v_mul_f32 v121, s57, v121
    v_cvt_pk_bf16_f32 v116, v120, v121
    v_mul_f32 v122, s57, v122
    v_mul_f32 v123, s57, v123
    s_waitcnt lgkmcnt(4)
    v_mfma_f32_32x32x16_bf16 v[16:31], a[164:167], a[20:23], v[16:31]
    v_cvt_pk_bf16_f32 v117, v122, v123
    v_mul_f32 v124, s57, v124
    v_mul_f32 v125, s57, v125
    v_cvt_pk_bf16_f32 v118, v124, v125
    v_mul_f32 v126, s57, v126
    v_mul_f32 v127, s57, v127
    v_cvt_pk_bf16_f32 v119, v126, v127
    v_accvgpr_write_b32 a24, v112
    v_accvgpr_write_b32 a25, v113
    v_accvgpr_write_b32 a26, v114
    v_accvgpr_write_b32 a27, v115
    v_accvgpr_write_b32 a28, v116
    v_accvgpr_write_b32 a29, v117
    v_accvgpr_write_b32 a30, v118
    v_accvgpr_write_b32 a31, v119
    s_waitcnt lgkmcnt(1)
    v_mfma_f32_32x32x16_bf16 v[16:31], a[168:171], a[24:27], v[16:31]
    s_waitcnt lgkmcnt(0)
    s_barrier
    ds_read_b128 a[48:51], v9
    ds_read_b128 a[52:55], v9 offset:1024
    ds_read_b128 a[56:59], v9 offset:2048
    ds_read_b128 a[60:63], v9 offset:3072
    ds_read_b128 a[64:67], v10
    ds_read_b128 a[68:71], v10 offset:1024
    ds_read_b128 a[72:75], v10 offset:2048
    ds_read_b128 a[76:79], v10 offset:3072
    v_mfma_f32_32x32x16_bf16 v[16:31], a[172:175], a[28:31], v[16:31]
    v_mfma_f32_32x32x16_bf16 v[32:47], a[144:147], a[32:35], 0
    ds_read_b128 a[144:147], v184
    s_add_u32 s64, s3, 32768
    s_and_b32 s64, s64, 114688
    v_mfma_f32_32x32x16_bf16 v[32:47], a[148:151], a[36:39], v[32:47]
    ds_read_b128 a[148:151], v185
    s_add_u32 m0, s54, 98304
    s_nop 0
    buffer_load_dwordx4 v212, s[32:35], s64 offen nt lds
    s_nop 2
    v_max_f32 v2, v16, v17
    v_max3_f32 v2, v2, v18, v19
    v_max3_f32 v2, v2, v20, v21
    v_max3_f32 v2, v2, v22, v23
    v_max3_f32 v2, v2, v24, v25
    v_max3_f32 v2, v2, v26, v27
    v_max3_f32 v2, v2, v28, v29
    v_max3_f32 v2, v2, v30, v31
    v_mfma_f32_32x32x16_bf16 v[32:47], a[152:155], a[40:43], v[32:47]
    ds_read_b128 a[152:155], v186
    v_mov_b32 v3, v2
    s_nop 1
    v_permlane32_swap_b32 v2, v3
    v_max_f32 v2, v2, v3
    v_sub_f32 v224, 0, v2
    v_add_f32 v16, v224, v16
    v_exp_f32 v2, v16
    v_add_f32 v17, v224, v17
    v_exp_f32 v3, v17
    v_mov_b32 v214, v2
    v_add_f32 v18, v224, v18
    v_exp_f32 v4, v18
    v_add_f32 v214, v214, v3
    v_cvt_pk_bf16_f32 v48, v2, v3
    v_add_f32 v19, v224, v19
    v_exp_f32 v5, v19
    v_mfma_f32_32x32x16_bf16 v[32:47], a[156:159], a[44:47], v[32:47]
    ds_read_b128 a[156:159], v187
    buffer_load_dwordx4 v212, s[32:35], s64 offen offset:1024 nt lds
    v_add_f32 v214, v214, v4
    v_add_f32 v20, v224, v20
    v_exp_f32 v2, v20
    v_add_f32 v214, v214, v5
    v_cvt_pk_bf16_f32 v49, v4, v5
    v_add_f32 v21, v224, v21
    v_exp_f32 v3, v21
    v_add_f32 v214, v214, v2
    v_add_f32 v22, v224, v22
    s_waitcnt lgkmcnt(11)
    v_mfma_f32_32x32x16_bf16 v[32:47], a[160:163], a[48:51], v[32:47]
    ds_read_b128 a[160:163], v188
    buffer_load_dwordx4 v212, s[32:35], s64 offen offset:2048 nt lds
    v_exp_f32 v4, v22
    v_add_f32 v214, v214, v3
    v_cvt_pk_bf16_f32 v50, v2, v3
    v_add_f32 v23, v224, v23
    v_exp_f32 v5, v23
    v_add_f32 v214, v214, v4
    v_add_f32 v24, v224, v24
    v_exp_f32 v2, v24
    v_add_f32 v214, v214, v5
    s_waitcnt lgkmcnt(11)
    v_mfma_f32_32x32x16_bf16 v[32:47], a[164:167], a[52:55], v[32:47]
    ds_read_b128 a[164:167], v189
    buffer_load_dwordx4 v212, s[32:35], s64 offen offset:3072 nt lds
    v_cvt_pk_bf16_f32 v51, v4, v5
    v_add_f32 v25, v224, v25
    v_exp_f32 v3, v25
    v_add_f32 v214, v214, v2
    v_add_f32 v26, v224, v26
    v_exp_f32 v4, v26
    v_add_f32 v214, v214, v3
    v_cvt_pk_bf16_f32 v52, v2, v3
    v_add_f32 v27, v224, v27
    s_waitcnt lgkmcnt(11)
    v_mfma_f32_32x32x16_bf16 v[32:47], a[168:171], a[56:59], v[32:47]
    ds_read_b128 a[168:171], v190
    v_exp_f32 v5, v27
    v_add_f32 v214, v214, v4
    v_add_f32 v28, v224, v28
    v_exp_f32 v2, v28
    v_add_f32 v214, v214, v5
    v_cvt_pk_bf16_f32 v53, v4, v5
    v_add_f32 v29, v224, v29
    v_exp_f32 v3, v29
    v_add_f32 v214, v214, v2
    v_add_f32 v30, v224, v30
    v_exp_f32 v4, v30
    v_add_f32 v214, v214, v3
    v_cvt_pk_bf16_f32 v54, v2, v3
    v_add_f32 v31, v224, v31
    v_exp_f32 v5, v31
    s_waitcnt lgkmcnt(11)
    v_mfma_f32_32x32x16_bf16 v[32:47], a[172:175], a[60:63], v[32:47]
    ds_read_b128 a[172:175], v191
    v_add_f32 v214, v214, v4
    v_add_f32 v214, v214, v5
    v_cvt_pk_bf16_f32 v55, v4, v5
    v_mov_b32 v225, v224
    v_mov_b32 v226, v224
    v_mov_b32 v227, v224
    v_mov_b32 v228, v224
    v_mov_b32 v229, v224
    v_mov_b32 v230, v224
    v_mov_b32 v231, v224
    v_mov_b32 v232, v224
    v_mov_b32 v233, v224
    v_mov_b32 v234, v224
    v_mov_b32 v235, v224
    v_mov_b32 v236, v224
    v_mov_b32 v237, v224
    v_mov_b32 v238, v224
    v_mov_b32 v239, v224
    s_waitcnt lgkmcnt(0)
    s_waitcnt vmcnt(12)
    s_barrier
    v_mfma_f32_32x32x16_bf16 v[16:31], a[144:147], a[0:3], v[224:239]
    ds_read_b64_tr_b16 a[176:177], v192
    ds_read_b64_tr_b16 a[178:179], v192 offset:2048
    ds_read_b64_tr_b16 a[180:181], v193
    v_max_f32 v2, v32, v33
    v_max3_f32 v2, v2, v34, v35
    v_max3_f32 v2, v2, v36, v37
    v_max3_f32 v2, v2, v38, v39
    v_max3_f32 v2, v2, v40, v41
    v_mfma_f32_32x32x16_bf16 v[16:31], a[148:151], a[4:7], v[16:31]
    ds_read_b64_tr_b16 a[182:183], v193 offset:2048
    ds_read_b64_tr_b16 a[184:185], v194
    ds_read_b64_tr_b16 a[186:187], v194 offset:2048
    v_max3_f32 v2, v2, v42, v43
    v_max3_f32 v2, v2, v44, v45
    v_max3_f32 v2, v2, v46, v47
    v_mov_b32 v3, v2
    v_mfma_f32_32x32x16_bf16 v[16:31], a[152:155], a[8:11], v[16:31]
    ds_read_b64_tr_b16 a[188:189], v195
    ds_read_b64_tr_b16 a[190:191], v195 offset:2048
    v_permlane32_swap_b32 v2, v3
    v_max_f32 v2, v2, v3
    v_sub_f32 v240, 0, v2
    v_add_f32 v32, v240, v32
    v_exp_f32 v2, v32
    v_mfma_f32_32x32x16_bf16 v[16:31], a[156:159], a[12:15], v[16:31]
    ds_read_b64_tr_b16 a[192:193], v192 offset:4096
    ds_read_b64_tr_b16 a[194:195], v192 offset:6144
    ds_read_b64_tr_b16 a[196:197], v193 offset:4096
    v_add_f32 v33, v240, v33
    v_exp_f32 v3, v33
    v_mov_b32 v216, v2
    v_add_f32 v34, v240, v34
    v_mfma_f32_32x32x16_bf16 v[16:31], a[160:163], a[16:19], v[16:31]
    ds_read_b64_tr_b16 a[198:199], v193 offset:6144
    ds_read_b64_tr_b16 a[200:201], v194 offset:4096
    ds_read_b64_tr_b16 a[202:203], v194 offset:6144
    v_exp_f32 v4, v34
    v_add_f32 v216, v216, v3
    v_cvt_pk_bf16_f32 v56, v2, v3
    v_mfma_f32_32x32x16_bf16 v[16:31], a[164:167], a[20:23], v[16:31]
    ds_read_b64_tr_b16 a[204:205], v195 offset:4096
    s_waitcnt lgkmcnt(14)
    ds_read_b64_tr_b16 a[206:207], v195 offset:6144
    v_add_f32 v35, v240, v35
    v_exp_f32 v5, v35
    v_add_f32 v216, v216, v4
    v_add_f32 v36, v240, v36
    v_exp_f32 v2, v36
    v_mfma_f32_32x32x16_bf16 v[16:31], a[168:171], a[24:27], v[16:31]
    v_add_f32 v216, v216, v5
    v_cvt_pk_bf16_f32 v57, v4, v5
    v_add_f32 v37, v240, v37
    v_exp_f32 v3, v37
    v_add_f32 v216, v216, v2
    v_add_f32 v38, v240, v38
    v_exp_f32 v4, v38
    v_mfma_f32_32x32x16_bf16 v[16:31], a[172:175], a[28:31], v[16:31]
    s_waitcnt lgkmcnt(8)
    ds_read_b128 a[144:147], v176 offset:16384
    ds_read_b128 a[148:151], v177 offset:16384
    v_add_f32 v216, v216, v3
    v_cvt_pk_bf16_f32 v58, v2, v3
    v_add_f32 v39, v240, v39
    v_exp_f32 v5, v39
    v_mfma_f32_32x32x16_bf16 v[64:79], a[176:179], v[48:51], 0
    ds_read_b128 a[152:155], v178 offset:16384
    v_add_f32 v216, v216, v4
    v_add_f32 v40, v240, v40
    v_exp_f32 v2, v40
    v_add_f32 v216, v216, v5
    v_cvt_pk_bf16_f32 v59, v4, v5
    v_add_f32 v41, v240, v41
    v_mfma_f32_32x32x16_bf16 v[80:95], a[180:183], v[48:51], 0
    ds_read_b128 a[156:159], v179 offset:16384
    v_exp_f32 v3, v41
    v_add_f32 v216, v216, v2
    v_add_f32 v42, v240, v42
    v_exp_f32 v4, v42
    v_add_f32 v216, v216, v3
    v_cvt_pk_bf16_f32 v60, v2, v3
    v_mfma_f32_32x32x16_bf16 v[96:111], a[184:187], v[48:51], 0
    ds_read_b128 a[160:163], v180 offset:16384
    ds_read_b128 a[164:167], v181 offset:16384
    v_add_f32 v43, v240, v43
    v_exp_f32 v5, v43
    v_add_f32 v216, v216, v4
    v_add_f32 v44, v240, v44
    v_exp_f32 v2, v44
    v_mfma_f32_32x32x16_bf16 v[112:127], a[188:191], v[48:51], 0
    s_waitcnt lgkmcnt(6)
    ds_read_b128 a[168:171], v182 offset:16384
    v_add_f32 v216, v216, v5
    v_cvt_pk_bf16_f32 v61, v4, v5
    v_add_f32 v45, v240, v45
    v_exp_f32 v3, v45
    v_add_f32 v216, v216, v2
    v_add_f32 v46, v240, v46
    v_mfma_f32_32x32x16_bf16 v[64:79], a[192:195], v[52:55], v[64:79]
    ds_read_b128 a[172:175], v183 offset:16384
    v_exp_f32 v4, v46
    v_add_f32 v216, v216, v3
    v_cvt_pk_bf16_f32 v62, v2, v3
    v_add_f32 v47, v240, v47
    v_exp_f32 v5, v47
    v_mfma_f32_32x32x16_bf16 v[80:95], a[196:199], v[52:55], v[80:95]
    v_add_f32 v216, v216, v4
    v_add_f32 v216, v216, v5
    v_cvt_pk_bf16_f32 v63, v4, v5
    v_mov_b32 v241, v240
    v_mov_b32 v242, v240
    v_mov_b32 v243, v240
    v_mov_b32 v244, v240
    v_mov_b32 v245, v240
    v_mov_b32 v246, v240
    v_mfma_f32_32x32x16_bf16 v[96:111], a[200:203], v[52:55], v[96:111]
    v_mov_b32 v247, v240
    v_mov_b32 v248, v240
    v_mov_b32 v249, v240
    v_mov_b32 v250, v240
    v_mov_b32 v251, v240
    v_mov_b32 v252, v240
    v_mov_b32 v253, v240
    v_mov_b32 v254, v240
    v_mov_b32 v255, v240
    v_mfma_f32_32x32x16_bf16 v[112:127], a[204:207], v[52:55], v[112:127]
    s_waitcnt lgkmcnt(4)
    ds_read_b128 a[208:211], v200
    ds_read_b128 a[212:215], v201
    v_mfma_f32_32x32x16_bf16 v[32:47], a[144:147], a[0:3], v[224:239]
    ds_read_b128 a[216:219], v202
    ds_read_b128 a[220:223], v203
    s_add_u32 s64, s3, 49152
    v_exp_f32 v2, v16
    s_waitcnt lgkmcnt(3)
    v_mfma_f32_16x16x32_bf16 v[160:163], a[208:211], a[64:67], 0
    ds_read_b128 a[208:211], v200 offset:4096
    v_lshlrev_b32 v223, 7, v1
    v_mfma_f32_32x32x16_bf16 v[32:47], a[148:151], a[4:7], v[32:47]
    s_and_b32 s64, s64, 114688
    v_exp_f32 v3, v17
    v_add_f32 v213, v214, v2
    s_waitcnt lgkmcnt(3)
    v_mfma_f32_16x16x32_bf16 v[160:163], a[212:215], a[68:71], v[160:163]
    ds_read_b128 a[212:215], v201 offset:4096
    v_exp_f32 v4, v18
    v_mfma_f32_32x32x16_bf16 v[32:47], a[152:155], a[8:11], v[32:47]
    s_add_u32 m0, s54, 49152
    v_add_f32 v213, v213, v3
    v_cvt_pk_bf16_f32 v48, v2, v3
    v_lshlrev_b32 v222, 4, v1
    s_waitcnt lgkmcnt(3)
    v_mfma_f32_16x16x32_bf16 v[160:163], a[216:219], a[72:75], v[160:163]
    ds_read_b128 a[216:219], v202 offset:4096
    v_exp_f32 v5, v19
    v_mfma_f32_32x32x16_bf16 v[32:47], a[156:159], a[12:15], v[32:47]
    buffer_load_dwordx4 v208, s[28:31], s64 offen nt lds
    v_add_f32 v213, v213, v4
    v_exp_f32 v2, v20
    s_waitcnt lgkmcnt(3)
    v_mfma_f32_16x16x32_bf16 v[160:163], a[220:223], a[76:79], v[160:163]
    ds_read_b128 a[220:223], v203 offset:4096
    v_mfma_f32_32x32x16_bf16 v[32:47], a[160:163], a[16:19], v[32:47]
    v_add_f32 v213, v213, v5
    v_cvt_pk_bf16_f32 v49, v4, v5
    v_exp_f32 v3, v21
    s_lshl_b32 s45, s42, 11
    s_waitcnt lgkmcnt(3)
    v_mfma_f32_16x16x32_bf16 v[164:167], a[208:211], a[64:67], 0
    v_add_f32 v213, v213, v2
    v_mfma_f32_32x32x16_bf16 v[32:47], a[164:167], a[20:23], v[32:47]
    buffer_load_dwordx4 v209, s[28:31], s64 offen offset:1024 nt lds
    v_exp_f32 v4, v22
    v_add_f32 v213, v213, v3
    s_waitcnt lgkmcnt(2)
    v_mfma_f32_16x16x32_bf16 v[164:167], a[212:215], a[68:71], v[164:167]
    v_cvt_pk_bf16_f32 v50, v2, v3
    v_mfma_f32_32x32x16_bf16 v[32:47], a[168:171], a[24:27], v[32:47]
    v_exp_f32 v5, v23
    v_add_f32 v213, v213, v4
    v_add_u32 v222, s45, v222
    s_waitcnt lgkmcnt(1)
    v_mfma_f32_16x16x32_bf16 v[164:167], a[216:219], a[72:75], v[164:167]
    v_exp_f32 v2, v24
    v_mfma_f32_32x32x16_bf16 v[32:47], a[172:175], a[28:31], v[32:47]
    buffer_load_dwordx4 v210, s[28:31], s64 offen offset:2048 nt lds
    v_add_f32 v213, v213, v5
    v_cvt_pk_bf16_f32 v51, v4, v5
    v_accvgpr_write_b32 a240, -1
    s_waitcnt lgkmcnt(0)
    v_mfma_f32_16x16x32_bf16 v[164:167], a[220:223], a[76:79], v[164:167]
    v_exp_f32 v3, v25
    v_mfma_f32_32x32x16_bf16 v[128:143], a[176:179], v[56:59], 0
    v_add_f32 v213, v213, v2
    v_exp_f32 v4, v26
    v_add_f32 v213, v213, v3
    v_mfma_f32_32x32x16_bf16 v[144:159], a[180:183], v[56:59], 0
    v_cvt_pk_bf16_f32 v52, v2, v3
    v_exp_f32 v5, v27
    v_accvgpr_write_b32 a241, -1
    v_max_f32 v6, v160, v161
    v_max3_f32 v6, v6, v162, v163
    v_max3_f32 v6, v6, v164, v165
    v_max3_f32 v6, v6, v166, v167
    ds_bpermute_b32 v7, v219, v6
    s_waitcnt lgkmcnt(0)
    v_max_f32 v6, v6, v7
    v_mfma_f32_32x32x16_bf16 a[80:95], a[184:187], v[56:59], 0
    buffer_load_dwordx4 v211, s[28:31], s64 offen offset:3072 nt lds
    v_add_f32 v213, v213, v4
    v_exp_f32 v2, v28
    v_mov_b32 v7, v6
    s_nop 1
    v_permlane32_swap_b32 v6, v7
    v_max_f32 v6, v6, v7
    v_mfma_f32_32x32x16_bf16 a[96:111], a[188:191], v[56:59], 0
    v_add_f32 v213, v213, v5
    v_cvt_pk_bf16_f32 v53, v4, v5
    v_exp_f32 v3, v29
    v_sub_f32 v172, 0, v6
    v_add_f32 v160, v172, v160
    v_exp_f32 v6, v160
    v_add_f32 v161, v172, v161
    v_mfma_f32_32x32x16_bf16 v[128:143], a[192:195], v[60:63], v[128:143]
    v_add_f32 v213, v213, v2
    v_exp_f32 v4, v30
    v_accvgpr_write_b32 a242, -1
    v_exp_f32 v7, v161
    v_mov_b32 v217, v6
    v_add_f32 v162, v172, v162
    v_exp_f32 v8, v162
    v_mfma_f32_32x32x16_bf16 v[144:159], a[196:199], v[60:63], v[144:159]
    v_add_f32 v213, v213, v3
    v_cvt_pk_bf16_f32 v54, v2, v3
    v_exp_f32 v5, v31
    v_accvgpr_write_b32 a243, -1
    v_add_f32 v217, v217, v7
    v_cvt_pk_bf16_f32 v168, v6, v7
    v_add_f32 v163, v172, v163
    v_mfma_f32_32x32x16_bf16 a[80:95], a[200:203], v[60:63], a[80:95]
    v_add_f32 v213, v213, v4
    v_add_f32 v213, v213, v5
    v_cvt_pk_bf16_f32 v55, v4, v5
    v_cmp_lt_f32 vcc, s56, v213
    v_exp_f32 v9, v163
    v_add_f32 v217, v217, v8
    v_add_f32 v164, v172, v164
    v_exp_f32 v6, v164
    v_mfma_f32_32x32x16_bf16 a[96:111], a[204:207], v[60:63], a[96:111]
    s_cbranch_vccnz L_stub2
L_back2:
    v_mfma_f32_32x32x16_bf16 v[16:31], a[144:147], a[32:35], v[240:255]
    ds_read_b64_tr_b16 a[176:177], v196
    ds_read_b64_tr_b16 a[178:179], v196 offset:2048
    ds_read_b64_tr_b16 a[180:181], v197
    s_add_u32 s64, s3, 49152
    v_exp_f32 v2, v32
    v_mfma_f32_32x32x16_bf16 v[16:31], a[148:151], a[36:39], v[16:31]
    ds_read_b64_tr_b16 a[182:183], v197 offset:2048
    ds_read_b64_tr_b16 a[184:185], v198
    ds_read_b64_tr_b16 a[186:187], v198 offset:2048
    s_and_b32 s64, s64, 114688
    v_exp_f32 v3, v33
    v_add_f32 v217, v217, v9
    v_mfma_f32_32x32x16_bf16 v[16:31], a[152:155], a[40:43], v[16:31]
    ds_read_b64_tr_b16 a[188:189], v199
    ds_read_b64_tr_b16 a[190:191], v199 offset:2048
    s_add_u32 m0, s54, 114688
    v_add_f32 v214, v213, v2
    v_exp_f32 v4, v34
    v_add_f32 v214, v214, v3
    v_mfma_f32_32x32x16_bf16 v[16:31], a[156:159], a[44:47], v[16:31]
    ds_read_b64_tr_b16 a[192:193], v196 offset:4096
    ds_read_b64_tr_b16 a[194:195], v196 offset:6144
    ds_read_b64_tr_b16 a[196:197], v197 offset:4096
    v_cvt_pk_bf16_f32 v56, v2, v3
    v_exp_f32 v5, v35
    v_cvt_pk_bf16_f32 v169, v8, v9
    v_mfma_f32_32x32x16_bf16 v[16:31], a[160:163], a[48:51], v[16:31]
    ds_read_b64_tr_b16 a[198:199], v197 offset:6144
    ds_read_b64_tr_b16 a[200:201], v198 offset:4096
    ds_read_b64_tr_b16 a[202:203], v198 offset:6144
    buffer_load_dwordx4 v212, s[32:35], s64 offen nt lds
    v_add_f32 v214, v214, v4
    v_mfma_f32_32x32x16_bf16 v[16:31], a[164:167], a[52:55], v[16:31]
    ds_read_b64_tr_b16 a[204:205], v199 offset:4096
    s_waitcnt lgkmcnt(14)
    ds_read_b64_tr_b16 a[206:207], v199 offset:6144
    v_exp_f32 v2, v36
    v_add_f32 v214, v214, v5
    v_cvt_pk_bf16_f32 v57, v4, v5
    v_add_f32 v165, v172, v165
    v_mfma_f32_32x32x16_bf16 v[16:31], a[168:171], a[56:59], v[16:31]
    buffer_load_dwordx4 v212, s[32:35], s64 offen offset:1024 nt lds
    v_exp_f32 v3, v37
    v_add_f32 v214, v214, v2
    v_exp_f32 v4, v38
    v_mfma_f32_32x32x16_bf16 v[16:31], a[172:175], a[60:63], v[16:31]
    s_waitcnt lgkmcnt(8)
    ds_read_b128 a[144:147], v184 offset:16384
    ds_read_b128 a[148:151], v185 offset:16384
    v_add_f32 v214, v214, v3
    v_cvt_pk_bf16_f32 v58, v2, v3
    v_exp_f32 v5, v39
    v_mfma_f32_32x32x16_bf16 v[64:79], a[176:179], v[48:51], v[64:79]
    ds_read_b128 a[152:155], v186 offset:16384
    v_add_f32 v214, v214, v4
    v_exp_f32 v2, v40
    v_add_f32 v214, v214, v5
    v_exp_f32 v7, v165
    v_add_f32 v217, v217, v6
    v_mfma_f32_32x32x16_bf16 v[80:95], a[180:183], v[48:51], v[80:95]
    ds_read_b128 a[156:159], v187 offset:16384
    buffer_load_dwordx4 v212, s[32:35], s64 offen offset:2048 nt lds
    v_cvt_pk_bf16_f32 v59, v4, v5
    v_exp_f32 v3, v41
    v_add_f32 v214, v214, v2
    v_mfma_f32_32x32x16_bf16 v[96:111], a[184:187], v[48:51], v[96:111]
    ds_read_b128 a[160:163], v188 offset:16384
    ds_read_b128 a[164:167], v189 offset:16384
    v_exp_f32 v4, v42
    v_add_f32 v214, v214, v3
    v_cvt_pk_bf16_f32 v60, v2, v3
    v_add_f32 v166, v172, v166
    v_mfma_f32_32x32x16_bf16 v[112:127], a[188:191], v[48:51], v[112:127]
    s_waitcnt lgkmcnt(6)
    ds_read_b128 a[168:171], v190 offset:16384
    v_exp_f32 v5, v43
    v_add_f32 v214, v214, v4
    v_exp_f32 v2, v44
    v_mfma_f32_32x32x16_bf16 v[64:79], a[192:195], v[52:55], v[64:79]
    ds_read_b128 a[172:175], v191 offset:16384
    buffer_load_dwordx4 v212, s[32:35], s64 offen offset:3072 nt lds
    v_add_f32 v214, v214, v5
    v_cvt_pk_bf16_f32 v61, v4, v5
    v_exp_f32 v8, v166
    v_mfma_f32_32x32x16_bf16 v[80:95], a[196:199], v[52:55], v[80:95]
    v_exp_f32 v3, v45
    v_add_f32 v214, v214, v2
    v_exp_f32 v4, v46
    v_add_f32 v214, v214, v3
    v_cvt_pk_bf16_f32 v62, v2, v3
    v_add_f32 v217, v217, v7
    v_mfma_f32_32x32x16_bf16 v[96:111], a[200:203], v[52:55], v[96:111]
    v_exp_f32 v5, v47
    v_add_f32 v214, v214, v4
    v_add_f32 v214, v214, v5
    v_cvt_pk_bf16_f32 v63, v4, v5
    v_cmp_lt_f32 vcc, s56, v214
    v_mfma_f32_32x32x16_bf16 v[112:127], a[204:207], v[52:55], v[112:127]
    s_cbranch_vccnz L_stub3
L_back3:
    s_waitcnt lgkmcnt(0)
    s_waitcnt vmcnt(12)
    s_barrier
    v_mfma_f32_32x32x16_bf16 v[32:47], a[144:147], a[0:3], v[224:239]
    ds_read_b64_tr_b16 a[176:177], v192 offset:16384
    ds_read_b64_tr_b16 a[178:179], v192 offset:18432
    ds_read_b64_tr_b16 a[180:181], v193 offset:16384
    v_exp_f32 v2, v16
    v_cvt_pk_bf16_f32 v170, v6, v7
    v_add_f32 v167, v172, v167
    v_exp_f32 v9, v167
    v_mfma_f32_32x32x16_bf16 v[32:47], a[148:151], a[4:7], v[32:47]
    ds_read_b64_tr_b16 a[182:183], v193 offset:18432
    ds_read_b64_tr_b16 a[184:185], v194 offset:16384
    ds_read_b64_tr_b16 a[186:187], v194 offset:18432
    v_exp_f32 v3, v17
    v_add_f32 v215, v216, v2
    v_mfma_f32_32x32x16_bf16 v[32:47], a[152:155], a[8:11], v[32:47]
    ds_read_b64_tr_b16 a[188:189], v195 offset:16384
    ds_read_b64_tr_b16 a[190:191], v195 offset:18432
    v_exp_f32 v4, v18
    v_add_f32 v215, v215, v3
    v_cvt_pk_bf16_f32 v48, v2, v3
    v_add_f32 v217, v217, v8
    v_mfma_f32_32x32x16_bf16 v[32:47], a[156:159], a[12:15], v[32:47]
    ds_read_b64_tr_b16 a[192:193], v192 offset:20480
    ds_read_b64_tr_b16 a[194:195], v192 offset:22528
    ds_read_b64_tr_b16 a[196:197], v193 offset:20480
    v_exp_f32 v5, v19
    v_add_f32 v217, v217, v9
    v_cvt_pk_bf16_f32 v171, v8, v9
    v_mov_b32 v173, v172
    v_mov_b32 v174, v172
    v_mfma_f32_32x32x16_bf16 v[32:47], a[160:163], a[16:19], v[32:47]
    ds_read_b64_tr_b16 a[198:199], v193 offset:22528
    ds_read_b64_tr_b16 a[200:201], v194 offset:20480
    ds_read_b64_tr_b16 a[202:203], v194 offset:22528
    v_add_f32 v215, v215, v4
    v_exp_f32 v2, v20
    v_mfma_f32_32x32x16_bf16 v[32:47], a[164:167], a[20:23], v[32:47]
    ds_read_b64_tr_b16 a[204:205], v195 offset:20480
    s_waitcnt lgkmcnt(14)
    ds_read_b64_tr_b16 a[206:207], v195 offset:22528
    v_add_f32 v215, v215, v5
    v_cvt_pk_bf16_f32 v49, v4, v5
    v_exp_f32 v3, v21
    v_mov_b32 v175, v172
    v_mfma_f32_32x32x16_bf16 v[32:47], a[168:171], a[24:27], v[32:47]
    v_add_f32 v215, v215, v2
    v_exp_f32 v4, v22
    v_add_f32 v215, v215, v3
    v_cvt_pk_bf16_f32 v50, v2, v3
    v_mfma_f32_32x32x16_bf16 v[32:47], a[172:175], a[28:31], v[32:47]
    s_waitcnt lgkmcnt(8)
    ds_read_b128 a[144:147], v176 offset:32768
    ds_read_b128 a[148:151], v177 offset:32768
    v_exp_f32 v5, v23
    v_add_f32 v215, v215, v4
    v_mfma_f32_32x32x16_bf16 v[64:79], a[176:179], v[56:59], v[64:79]
    ds_read_b128 a[152:155], v178 offset:32768
    v_exp_f32 v2, v24
    v_add_f32 v215, v215, v5
    v_cvt_pk_bf16_f32 v51, v4, v5
    v_mfma_f32_32x32x16_bf16 v[80:95], a[180:183], v[56:59], v[80:95]
    ds_read_b128 a[156:159], v179 offset:32768
    v_exp_f32 v3, v25
    v_add_f32 v215, v215, v2
    v_exp_f32 v4, v26
    v_mfma_f32_32x32x16_bf16 v[96:111], a[184:187], v[56:59], v[96:111]
    ds_read_b128 a[160:163], v180 offset:32768
    ds_read_b128 a[164:167], v181 offset:32768
    v_add_f32 v215, v215, v3
    v_cvt_pk_bf16_f32 v52, v2, v3
    v_exp_f32 v5, v27
    v_mfma_f32_32x32x16_bf16 v[112:127], a[188:191], v[56:59], v[112:127]
    s_waitcnt lgkmcnt(6)
    ds_read_b128 a[168:171], v182 offset:32768
    v_add_f32 v215, v215, v4
    v_exp_f32 v2, v28
    v_mfma_f32_32x32x16_bf16 v[64:79], a[192:195], v[60:63], v[64:79]
    ds_read_b128 a[172:175], v183 offset:32768
    v_add_f32 v215, v215, v5
    v_cvt_pk_bf16_f32 v53, v4, v5
    v_exp_f32 v3, v29
    v_add_f32 v215, v215, v2
    v_mfma_f32_32x32x16_bf16 v[80:95], a[196:199], v[60:63], v[80:95]
    v_exp_f32 v4, v30
    v_add_f32 v215, v215, v3
    v_cvt_pk_bf16_f32 v54, v2, v3
    v_mfma_f32_32x32x16_bf16 v[96:111], a[200:203], v[60:63], v[96:111]
    v_exp_f32 v5, v31
    v_add_f32 v215, v215, v4
    v_add_f32 v215, v215, v5
    v_cvt_pk_bf16_f32 v55, v4, v5
    v_cmp_lt_f32 vcc, s56, v215
    v_mfma_f32_32x32x16_bf16 v[112:127], a[204:207], v[60:63], v[112:127]
    s_cbranch_vccnz L_stub4
L_back4:
    s_waitcnt lgkmcnt(4)
    v_mfma_f32_32x32x16_bf16 v[16:31], a[144:147], a[0:3], v[224:239]
    s_add_u32 s64, s3, 65536
    s_and_b32 s64, s64, 114688
    v_exp_f32 v2, v32
    v_exp_f32 v3, v33
    v_mfma_f32_32x32x16_bf16 v[16:31], a[148:151], a[4:7], v[16:31]
    s_add_u32 m0, s54, 0
    v_add_f32 v213, v214, v2
    v_exp_f32 v4, v34
    v_mfma_f32_32x32x16_bf16 v[16:31], a[152:155], a[8:11], v[16:31]
    buffer_load_dwordx4 v208, s[28:31], s64 offen nt lds
    v_add_f32 v213, v213, v3
    v_cvt_pk_bf16_f32 v56, v2, v3
    v_mfma_f32_32x32x16_bf16 v[16:31], a[156:159], a[12:15], v[16:31]
    s_waitcnt lgkmcnt(0)
    ds_read_b64_tr_b16 a[208:209], v204
    ds_read_b64_tr_b16 a[210:211], v204 offset:4096
    v_exp_f32 v5, v35
    v_add_f32 v213, v213, v4
    v_mfma_f32_32x32x16_bf16 v[16:31], a[160:163], a[16:19], v[16:31]
    ds_read_b64_tr_b16 a[212:213], v204 offset:16
    ds_read_b64_tr_b16 a[214:215], v204 offset:4112
    buffer_load_dwordx4 v209, s[28:31], s64 offen offset:1024 nt lds
    v_exp_f32 v2, v36
    v_mfma_f32_32x32x16_bf16 v[16:31], a[164:167], a[20:23], v[16:31]
    ds_read_b64_tr_b16 a[216:217], v205
    ds_read_b64_tr_b16 a[218:219], v205 offset:4096
    v_add_f32 v213, v213, v5
    v_cvt_pk_bf16_f32 v57, v4, v5
    v_exp_f32 v3, v37
    v_mfma_f32_32x32x16_bf16 v[16:31], a[168:171], a[24:27], v[16:31]
    ds_read_b64_tr_b16 a[220:221], v205 offset:16
    ds_read_b64_tr_b16 a[222:223], v205 offset:4112
    buffer_load_dwordx4 v210, s[28:31], s64 offen offset:2048 nt lds
    v_add_f32 v213, v213, v2
    v_mfma_f32_32x32x16_bf16 v[16:31], a[172:175], a[28:31], v[16:31]
    buffer_load_dwordx4 v211, s[28:31], s64 offen offset:3072 nt lds
    v_exp_f32 v4, v38
    v_add_f32 v213, v213, v3
    v_mfma_f32_32x32x16_bf16 v[128:143], a[176:179], v[48:51], v[128:143]
    v_cvt_pk_bf16_f32 v58, v2, v3
    v_exp_f32 v5, v39
    v_add_f32 v213, v213, v4
    s_waitcnt lgkmcnt(6)
    v_mfma_f32_16x16x32_bf16 a[112:115], a[208:211], v[168:171], 0
    ds_read_b64_tr_b16 a[208:209], v206
    ds_read_b64_tr_b16 a[210:211], v206 offset:4096
    s_add_u32 s71, s67, 0
    v_mfma_f32_32x32x16_bf16 v[144:159], a[180:183], v[48:51], v[144:159]
    s_and_b32 s71, s71, 7
    v_exp_f32 v2, v40
    v_add_f32 v213, v213, v5
    v_cvt_pk_bf16_f32 v59, v4, v5
    s_waitcnt lgkmcnt(6)
    v_mfma_f32_16x16x32_bf16 a[116:119], a[212:215], v[168:171], 0
    ds_read_b64_tr_b16 a[212:213], v206 offset:16
    ds_read_b64_tr_b16 a[214:215], v206 offset:4112
    s_lshl_b32 s71, s71, 17
    v_mfma_f32_32x32x16_bf16 a[80:95], a[184:187], v[48:51], a[80:95]
    s_add_u32 m0, s54, 131072
    v_exp_f32 v3, v41
    v_add_f32 v213, v213, v2
    v_exp_f32 v4, v42
    s_waitcnt lgkmcnt(6)
    v_mfma_f32_16x16x32_bf16 a[120:123], a[216:219], v[168:171], 0
    ds_read_b64_tr_b16 a[216:217], v207
    ds_read_b64_tr_b16 a[218:219], v207 offset:4096
    buffer_load_dwordx4 v221, s[20:23], s71 offen lds
    v_mfma_f32_32x32x16_bf16 a[96:111], a[188:191], v[48:51], a[96:111]
    v_add_f32 v213, v213, v3
    v_cvt_pk_bf16_f32 v60, v2, v3
    v_exp_f32 v5, v43
    s_waitcnt lgkmcnt(6)
    v_mfma_f32_16x16x32_bf16 a[124:127], a[220:223], v[168:171], 0
    ds_read_b64_tr_b16 a[220:221], v207 offset:16
    ds_read_b64_tr_b16 a[222:223], v207 offset:4112
    s_add_u32 s71, s71, 7168
    buffer_load_dwordx4 v221, s[20:23], s71 offen offset:1024 lds
    v_mfma_f32_32x32x16_bf16 v[128:143], a[192:195], v[52:55], v[128:143]
    v_add_f32 v213, v213, v4
    v_exp_f32 v2, v44
    v_add_f32 v213, v213, v5
    s_waitcnt lgkmcnt(6)
    v_mfma_f32_16x16x32_bf16 a[128:131], a[208:211], v[168:171], 0
    s_add_u32 s71, s71, 7168
    v_cvt_pk_bf16_f32 v61, v4, v5
    v_mfma_f32_32x32x16_bf16 v[144:159], a[196:199], v[52:55], v[144:159]
    buffer_load_dwordx4 v221, s[20:23], s71 offen offset:2048 lds
    v_exp_f32 v3, v45
    v_add_f32 v213, v213, v2
    s_waitcnt lgkmcnt(4)
    v_mfma_f32_16x16x32_bf16 a[132:135], a[212:215], v[168:171], 0
    v_exp_f32 v4, v46
    v_mfma_f32_32x32x16_bf16 a[80:95], a[200:203], v[52:55], a[80:95]
    s_add_u32 s71, s71, 7168
    v_add_f32 v213, v213, v3
    v_cvt_pk_bf16_f32 v62, v2, v3
    v_exp_f32 v5, v47
    s_waitcnt lgkmcnt(2)
    v_mfma_f32_16x16x32_bf16 a[136:139], a[216:219], v[168:171], 0
    buffer_load_dwordx4 v221, s[20:23], s71 offen offset:3072 lds
    v_mfma_f32_32x32x16_bf16 a[96:111], a[204:207], v[52:55], a[96:111]
    v_add_f32 v213, v213, v4
    v_add_f32 v213, v213, v5
    v_cvt_pk_bf16_f32 v63, v4, v5
    v_cmp_lt_f32 vcc, s56, v213
    s_waitcnt lgkmcnt(0)
    v_mfma_f32_16x16x32_bf16 a[140:143], a[220:223], v[168:171], 0
    s_cbranch_vccnz L_stub5
L_back5:
    v_mfma_f32_32x32x16_bf16 v[32:47], a[144:147], a[32:35], v[240:255]
    ds_read_b64_tr_b16 a[176:177], v196 offset:16384
    ds_read_b64_tr_b16 a[178:179], v196 offset:18432
    ds_read_b64_tr_b16 a[180:181], v197 offset:16384
    v_exp_f32 v2, v16
    v_mfma_f32_32x32x16_bf16 v[32:47], a[148:151], a[36:39], v[32:47]
    ds_read_b64_tr_b16 a[182:183], v197 offset:18432
    ds_read_b64_tr_b16 a[184:185], v198 offset:16384
    ds_read_b64_tr_b16 a[186:187], v198 offset:18432
    v_exp_f32 v3, v17
    v_add_f32 v214, v213, v2
    v_mfma_f32_32x32x16_bf16 v[32:47], a[152:155], a[40:43], v[32:47]
    ds_read_b64_tr_b16 a[188:189], v199 offset:16384
    ds_read_b64_tr_b16 a[190:191], v199 offset:18432
    v_exp_f32 v4, v18
    v_add_f32 v214, v214, v3
    v_cvt_pk_bf16_f32 v48, v2, v3
    v_mfma_f32_32x32x16_bf16 v[32:47], a[156:159], a[44:47], v[32:47]
    ds_read_b64_tr_b16 a[192:193], v196 offset:20480
    ds_read_b64_tr_b16 a[194:195], v196 offset:22528
    ds_read_b64_tr_b16 a[196:197], v197 offset:20480
    v_exp_f32 v5, v19
    v_mfma_f32_32x32x16_bf16 v[32:47], a[160:163], a[48:51], v[32:47]
    ds_read_b64_tr_b16 a[198:199], v197 offset:22528
    ds_read_b64_tr_b16 a[200:201], v198 offset:20480
    ds_read_b64_tr_b16 a[202:203], v198 offset:22528
    v_add_f32 v214, v214, v4
    v_exp_f32 v2, v20
    v_mfma_f32_32x32x16_bf16 v[32:47], a[164:167], a[52:55], v[32:47]
    ds_read_b64_tr_b16 a[204:205], v199 offset:20480
    s_waitcnt lgkmcnt(14)
    ds_read_b64_tr_b16 a[206:207], v199 offset:22528
    v_add_f32 v214, v214, v5
    v_cvt_pk_bf16_f32 v49, v4, v5
    v_exp_f32 v3, v21
    v_mfma_f32_32x32x16_bf16 v[32:47], a[168:171], a[56:59], v[32:47]
    v_add_f32 v214, v214, v2
    v_exp_f32 v4, v22
    v_add_f32 v214, v214, v3
    v_cvt_pk_bf16_f32 v50, v2, v3
    v_mfma_f32_32x32x16_bf16 v[32:47], a[172:175], a[60:63], v[32:47]
    s_waitcnt lgkmcnt(8)
    ds_read_b128 a[144:147], v184 offset:32768
    ds_read_b128 a[148:151], v185 offset:32768
    v_exp_f32 v5, v23
    v_add_f32 v214, v214, v4
    v_mfma_f32_32x32x16_bf16 v[64:79], a[176:179], v[56:59], v[64:79]
    ds_read_b128 a[152:155], v186 offset:32768
    v_exp_f32 v2, v24
    v_add_f32 v214, v214, v5
    v_cvt_pk_bf16_f32 v51, v4, v5
    v_mfma_f32_32x32x16_bf16 v[80:95], a[180:183], v[56:59], v[80:95]
    ds_read_b128 a[156:159], v187 offset:32768
    v_exp_f32 v3, v25
    v_add_f32 v214, v214, v2
    v_exp_f32 v4, v26
    v_mfma_f32_32x32x16_bf16 v[96:111], a[184:187], v[56:59], v[96:111]
    ds_read_b128 a[160:163], v188 offset:32768
    ds_read_b128 a[164:167], v189 offset:32768
    v_add_f32 v214, v214, v3
    v_cvt_pk_bf16_f32 v52, v2, v3
    v_exp_f32 v5, v27
    v_mfma_f32_32x32x16_bf16 v[112:127], a[188:191], v[56:59], v[112:127]
    s_waitcnt lgkmcnt(6)
    ds_read_b128 a[168:171], v190 offset:32768
    v_add_f32 v214, v214, v4
    v_exp_f32 v2, v28
    v_mfma_f32_32x32x16_bf16 v[64:79], a[192:195], v[60:63], v[64:79]
    ds_read_b128 a[172:175], v191 offset:32768
    v_add_f32 v214, v214, v5
    v_cvt_pk_bf16_f32 v53, v4, v5
    v_exp_f32 v3, v29
    v_add_f32 v214, v214, v2
    v_mfma_f32_32x32x16_bf16 v[80:95], a[196:199], v[60:63], v[80:95]
    v_exp_f32 v4, v30
    v_add_f32 v214, v214, v3
    v_cvt_pk_bf16_f32 v54, v2, v3
    v_mfma_f32_32x32x16_bf16 v[96:111], a[200:203], v[60:63], v[96:111]
    v_exp_f32 v5, v31
    v_add_f32 v214, v214, v4
    v_add_f32 v214, v214, v5
    v_cvt_pk_bf16_f32 v55, v4, v5
    v_cmp_lt_f32 vcc, s56, v214
    v_mfma_f32_32x32x16_bf16 v[112:127], a[204:207], v[60:63], v[112:127]
    s_cbranch_vccnz L_stub6
L_back6:
    s_waitcnt lgkmcnt(0)
    s_waitcnt vmcnt(12)
    s_barrier
    v_mfma_f32_32x32x16_bf16 v[16:31], a[144:147], a[0:3], v[224:239]
    ds_read_b64_tr_b16 a[176:177], v192 offset:32768
    ds_read_b64_tr_b16 a[178:179], v192 offset:34816
    ds_read_b64_tr_b16 a[180:181], v193 offset:32768
    v_exp_f32 v2, v32
    v_mfma_f32_32x32x16_bf16 v[16:31], a[148:151], a[4:7], v[16:31]
    ds_read_b64_tr_b16 a[182:183], v193 offset:34816
    ds_read_b64_tr_b16 a[184:185], v194 offset:32768
    ds_read_b64_tr_b16 a[186:187], v194 offset:34816
    v_exp_f32 v3, v33
    v_add_f32 v216, v215, v2
    v_mfma_f32_32x32x16_bf16 v[16:31], a[152:155], a[8:11], v[16:31]
    ds_read_b64_tr_b16 a[188:189], v195 offset:32768
    ds_read_b64_tr_b16 a[190:191], v195 offset:34816
    v_exp_f32 v4, v34
    v_add_f32 v216, v216, v3
    v_cvt_pk_bf16_f32 v56, v2, v3
    v_mfma_f32_32x32x16_bf16 v[16:31], a[156:159], a[12:15], v[16:31]
    ds_read_b64_tr_b16 a[192:193], v192 offset:36864
    ds_read_b64_tr_b16 a[194:195], v192 offset:38912
    ds_read_b64_tr_b16 a[196:197], v193 offset:36864
    v_exp_f32 v5, v35
    v_mfma_f32_32x32x16_bf16 v[16:31], a[160:163], a[16:19], v[16:31]
    ds_read_b64_tr_b16 a[198:199], v193 offset:38912
    ds_read_b64_tr_b16 a[200:201], v194 offset:36864
    ds_read_b64_tr_b16 a[202:203], v194 offset:38912
    v_add_f32 v216, v216, v4
    v_exp_f32 v2, v36
    v_mfma_f32_32x32x16_bf16 v[16:31], a[164:167], a[20:23], v[16:31]
    ds_read_b64_tr_b16 a[204:205], v195 offset:36864
    s_waitcnt lgkmcnt(14)
    ds_read_b64_tr_b16 a[206:207], v195 offset:38912
    v_add_f32 v216, v216, v5
    v_cvt_pk_bf16_f32 v57, v4, v5
    v_exp_f32 v3, v37
    v_mfma_f32_32x32x16_bf16 v[16:31], a[168:171], a[24:27], v[16:31]
    v_add_f32 v216, v216, v2
    v_exp_f32 v4, v38
    v_add_f32 v216, v216, v3
    v_cvt_pk_bf16_f32 v58, v2, v3
    v_mfma_f32_32x32x16_bf16 v[16:31], a[172:175], a[28:31], v[16:31]
    s_waitcnt lgkmcnt(8)
    ds_read_b128 a[144:147], v176 offset:49152
    ds_read_b128 a[148:151], v177 offset:49152
    v_exp_f32 v5, v39
    v_add_f32 v216, v216, v4
    v_mfma_f32_32x32x16_bf16 v[64:79], a[176:179], v[48:51], v[64:79]
    ds_read_b128 a[152:155], v178 offset:49152
    v_exp_f32 v2, v40
    v_add_f32 v216, v216, v5
    v_cvt_pk_bf16_f32 v59, v4, v5
    v_mfma_f32_32x32x16_bf16 v[80:95], a[180:183], v[48:51], v[80:95]
    ds_read_b128 a[156:159], v179 offset:49152
    v_exp_f32 v3, v41
    v_add_f32 v216, v216, v2
    v_exp_f32 v4, v42
    v_mfma_f32_32x32x16_bf16 v[96:111], a[184:187], v[48:51], v[96:111]
    ds_read_b128 a[160:163], v180 offset:49152
    ds_read_b128 a[164:167], v181 offset:49152
    v_add_f32 v216, v216, v3
    v_cvt_pk_bf16_f32 v60, v2, v3
    v_exp_f32 v5, v43
    v_mfma_f32_32x32x16_bf16 v[112:127], a[188:191], v[48:51], v[112:127]
    s_waitcnt lgkmcnt(6)
    ds_read_b128 a[168:171], v182 offset:49152
    v_add_f32 v216, v216, v4
    v_exp_f32 v2, v44
    v_mfma_f32_32x32x16_bf16 v[64:79], a[192:195], v[52:55], v[64:79]
    ds_read_b128 a[172:175], v183 offset:49152
    v_add_f32 v216, v216, v5
    v_cvt_pk_bf16_f32 v61, v4, v5
    v_exp_f32 v3, v45
    v_add_f32 v216, v216, v2
    v_mfma_f32_32x32x16_bf16 v[80:95], a[196:199], v[52:55], v[80:95]
    v_exp_f32 v4, v46
    v_add_f32 v216, v216, v3
    v_cvt_pk_bf16_f32 v62, v2, v3
    v_mfma_f32_32x32x16_bf16 v[96:111], a[200:203], v[52:55], v[96:111]
    v_exp_f32 v5, v47
    v_add_f32 v216, v216, v4
    v_add_f32 v216, v216, v5
    v_cvt_pk_bf16_f32 v63, v4, v5
    v_cmp_lt_f32 vcc, s56, v216
    v_mfma_f32_32x32x16_bf16 v[112:127], a[204:207], v[52:55], v[112:127]
    s_cbranch_vccnz L_stub7
L_back7:
    s_waitcnt lgkmcnt(4)
    ds_read_b128 a[208:211], v200 offset:32768
    ds_read_b128 a[212:215], v201 offset:32768
    v_mfma_f32_32x32x16_bf16 v[32:47], a[144:147], a[0:3], v[224:239]
    ds_read_b128 a[216:219], v202 offset:32768
    ds_read_b128 a[220:223], v203 offset:32768
    s_add_u32 s64, s3, 65536
    s_and_b32 s64, s64, 114688
    v_exp_f32 v2, v16
    s_waitcnt lgkmcnt(3)
    v_mfma_f32_16x16x32_bf16 v[160:163], a[208:211], a[64:67], v[172:175]
    ds_read_b128 a[208:211], v200 offset:36864
    s_add_u32 m0, s54, 65536
    v_mfma_f32_32x32x16_bf16 v[32:47], a[148:151], a[4:7], v[32:47]
    buffer_load_dwordx4 v212, s[32:35], s64 offen nt lds
    v_exp_f32 v3, v17
    v_add_f32 v213, v214, v2
    s_waitcnt lgkmcnt(3)
    v_mfma_f32_16x16x32_bf16 v[160:163], a[212:215], a[68:71], v[160:163]
    ds_read_b128 a[212:215], v201 offset:36864
    v_mfma_f32_32x32x16_bf16 v[32:47], a[152:155], a[8:11], v[32:47]
    buffer_load_dwordx4 v212, s[32:35], s64 offen offset:1024 nt lds
    v_exp_f32 v4, v18
    v_add_f32 v213, v213, v3
    v_cvt_pk_bf16_f32 v48, v2, v3
    s_waitcnt lgkmcnt(3)
    v_mfma_f32_16x16x32_bf16 v[160:163], a[216:219], a[72:75], v[160:163]
    ds_read_b128 a[216:219], v202 offset:36864
    v_mfma_f32_32x32x16_bf16 v[32:47], a[156:159], a[12:15], v[32:47]
    buffer_load_dwordx4 v212, s[32:35], s64 offen offset:2048 nt lds
    v_exp_f32 v5, v19
    v_add_f32 v213, v213, v4
    s_waitcnt lgkmcnt(3)
    v_mfma_f32_16x16x32_bf16 v[160:163], a[220:223], a[76:79], v[160:163]
    ds_read_b128 a[220:223], v203 offset:36864
    buffer_load_dwordx4 v212, s[32:35], s64 offen offset:3072 nt lds
    v_mfma_f32_32x32x16_bf16 v[32:47], a[160:163], a[16:19], v[32:47]
    v_exp_f32 v2, v20
    v_add_f32 v213, v213, v5
    v_cvt_pk_bf16_f32 v49, v4, v5
    s_waitcnt lgkmcnt(3)
    v_mfma_f32_16x16x32_bf16 v[164:167], a[208:211], a[64:67], v[172:175]
    s_add_u32 s71, s67, 1
    v_exp_f32 v3, v21
    v_mfma_f32_32x32x16_bf16 v[32:47], a[164:167], a[20:23], v[32:47]
    s_and_b32 s71, s71, 7
    v_add_f32 v213, v213, v2
    v_exp_f32 v4, v22
    s_waitcnt lgkmcnt(2)
    v_mfma_f32_16x16x32_bf16 v[164:167], a[212:215], a[68:71], v[164:167]
    s_lshl_b32 s71, s71, 17
    v_add_f32 v213, v213, v3
    v_mfma_f32_32x32x16_bf16 v[32:47], a[168:171], a[24:27], v[32:47]
    s_add_u32 m0, s54, 147456
    v_cvt_pk_bf16_f32 v50, v2, v3
    v_exp_f32 v5, v23
    v_add_f32 v213, v213, v4
    s_waitcnt lgkmcnt(1)
    v_mfma_f32_16x16x32_bf16 v[164:167], a[216:219], a[72:75], v[164:167]
    buffer_load_dwordx4 v221, s[20:23], s71 offen lds
    v_mfma_f32_32x32x16_bf16 v[32:47], a[172:175], a[28:31], v[32:47]
    v_exp_f32 v2, v24
    v_add_f32 v213, v213, v5
    v_cvt_pk_bf16_f32 v51, v4, v5
    s_waitcnt lgkmcnt(0)
    v_mfma_f32_16x16x32_bf16 v[164:167], a[220:223], a[76:79], v[164:167]
    s_add_u32 s71, s71, 7168
    buffer_load_dwordx4 v221, s[20:23], s71 offen offset:1024 lds
    v_mfma_f32_32x32x16_bf16 v[128:143], a[176:179], v[56:59], v[128:143]
    v_exp_f32 v3, v25
    v_add_f32 v213, v213, v2
    v_exp_f32 v4, v26
    v_mfma_f32_32x32x16_bf16 v[144:159], a[180:183], v[56:59], v[144:159]
    s_add_u32 s71, s71, 7168
    v_add_f32 v213, v213, v3
    v_cvt_pk_bf16_f32 v52, v2, v3
    v_exp_f32 v5, v27
    v_exp_f32 v6, v160
    v_mfma_f32_32x32x16_bf16 a[80:95], a[184:187], v[56:59], a[80:95]
    buffer_load_dwordx4 v221, s[20:23], s71 offen offset:2048 lds
    v_add_f32 v213, v213, v4
    v_exp_f32 v2, v28
    v_exp_f32 v7, v161
    v_add_f32 v218, v217, v6
    v_mfma_f32_32x32x16_bf16 a[96:111], a[188:191], v[56:59], a[96:111]
    v_add_f32 v213, v213, v5
    v_cvt_pk_bf16_f32 v53, v4, v5
    v_exp_f32 v3, v29
    v_exp_f32 v8, v162
    v_add_f32 v218, v218, v7
    v_cvt_pk_bf16_f32 v168, v6, v7
    v_mfma_f32_32x32x16_bf16 v[128:143], a[192:195], v[60:63], v[128:143]
    s_add_u32 s71, s71, 7168
    v_add_f32 v213, v213, v2
    v_exp_f32 v4, v30
    v_add_f32 v213, v213, v3
    v_exp_f32 v9, v163
    v_mfma_f32_32x32x16_bf16 v[144:159], a[196:199], v[60:63], v[144:159]
    buffer_load_dwordx4 v221, s[20:23], s71 offen offset:3072 lds
    v_cvt_pk_bf16_f32 v54, v2, v3
    v_exp_f32 v5, v31
    v_add_f32 v218, v218, v8
    v_exp_f32 v6, v164
    v_mfma_f32_32x32x16_bf16 a[80:95], a[200:203], v[60:63], a[80:95]
    v_add_f32 v213, v213, v4
    v_add_f32 v213, v213, v5
    v_cvt_pk_bf16_f32 v55, v4, v5
    v_cmp_lt_f32 vcc, s56, v213
    v_add_f32 v218, v218, v9
    v_cvt_pk_bf16_f32 v169, v8, v9
    v_exp_f32 v7, v165
    v_mfma_f32_32x32x16_bf16 a[96:111], a[204:207], v[60:63], a[96:111]
    s_cbranch_vccnz L_stub8
L_back8:
    v_mfma_f32_32x32x16_bf16 v[16:31], a[144:147], a[32:35], v[240:255]
    ds_read_b64_tr_b16 a[176:177], v196 offset:32768
    ds_read_b64_tr_b16 a[178:179], v196 offset:34816
    ds_read_b64_tr_b16 a[180:181], v197 offset:32768
    s_add_u32 s64, s3, 81920
    v_exp_f32 v2, v32
    v_mfma_f32_32x32x16_bf16 v[16:31], a[148:151], a[36:39], v[16:31]
    ds_read_b64_tr_b16 a[182:183], v197 offset:34816
    ds_read_b64_tr_b16 a[184:185], v198 offset:32768
    ds_read_b64_tr_b16 a[186:187], v198 offset:34816
    s_and_b32 s64, s64, 114688
    v_exp_f32 v3, v33
    v_mfma_f32_32x32x16_bf16 v[16:31], a[152:155], a[40:43], v[16:31]
    ds_read_b64_tr_b16 a[188:189], v199 offset:32768
    ds_read_b64_tr_b16 a[190:191], v199 offset:34816
    s_add_u32 m0, s54, 16384
    v_add_f32 v214, v213, v2
    v_exp_f32 v4, v34
    v_add_f32 v214, v214, v3
    v_add_f32 v218, v218, v6
    v_mfma_f32_32x32x16_bf16 v[16:31], a[156:159], a[44:47], v[16:31]
    ds_read_b64_tr_b16 a[192:193], v196 offset:36864
    ds_read_b64_tr_b16 a[194:195], v196 offset:38912
    ds_read_b64_tr_b16 a[196:197], v197 offset:36864
    v_cvt_pk_bf16_f32 v56, v2, v3
    v_exp_f32 v5, v35
    v_mfma_f32_32x32x16_bf16 v[16:31], a[160:163], a[48:51], v[16:31]
    ds_read_b64_tr_b16 a[198:199], v197 offset:38912
    ds_read_b64_tr_b16 a[200:201], v198 offset:36864
    ds_read_b64_tr_b16 a[202:203], v198 offset:38912
    buffer_load_dwordx4 v208, s[28:31], s64 offen nt lds
    v_add_f32 v214, v214, v4
    v_mfma_f32_32x32x16_bf16 v[16:31], a[164:167], a[52:55], v[16:31]
    ds_read_b64_tr_b16 a[204:205], v199 offset:36864
    s_waitcnt lgkmcnt(14)
    ds_read_b64_tr_b16 a[206:207], v199 offset:38912
    v_exp_f32 v2, v36
    v_add_f32 v214, v214, v5
    v_cvt_pk_bf16_f32 v57, v4, v5
    v_mfma_f32_32x32x16_bf16 v[16:31], a[168:171], a[56:59], v[16:31]
    buffer_load_dwordx4 v209, s[28:31], s64 offen offset:1024 nt lds
    v_exp_f32 v3, v37
    v_add_f32 v214, v214, v2
    v_exp_f32 v4, v38
    v_mfma_f32_32x32x16_bf16 v[16:31], a[172:175], a[60:63], v[16:31]
    s_waitcnt lgkmcnt(8)
    ds_read_b128 a[144:147], v184 offset:49152
    ds_read_b128 a[148:151], v185 offset:49152
    v_add_f32 v214, v214, v3
    v_cvt_pk_bf16_f32 v58, v2, v3
    v_exp_f32 v5, v39
    v_mfma_f32_32x32x16_bf16 v[64:79], a[176:179], v[48:51], v[64:79]
    ds_read_b128 a[152:155], v186 offset:49152
    v_add_f32 v214, v214, v4
    v_exp_f32 v2, v40
    v_add_f32 v214, v214, v5
    v_exp_f32 v8, v166
    v_mfma_f32_32x32x16_bf16 v[80:95], a[180:183], v[48:51], v[80:95]
    ds_read_b128 a[156:159], v187 offset:49152
    buffer_load_dwordx4 v210, s[28:31], s64 offen offset:2048 nt lds
    v_cvt_pk_bf16_f32 v59, v4, v5
    v_exp_f32 v3, v41
    v_add_f32 v214, v214, v2
    v_mfma_f32_32x32x16_bf16 v[96:111], a[184:187], v[48:51], v[96:111]
    ds_read_b128 a[160:163], v188 offset:49152
    ds_read_b128 a[164:167], v189 offset:49152
    v_exp_f32 v4, v42
    v_add_f32 v214, v214, v3
    v_cvt_pk_bf16_f32 v60, v2, v3
    v_mfma_f32_32x32x16_bf16 v[112:127], a[188:191], v[48:51], v[112:127]
    s_waitcnt lgkmcnt(6)
    ds_read_b128 a[168:171], v190 offset:49152
    v_exp_f32 v5, v43
    v_add_f32 v214, v214, v4
    v_exp_f32 v2, v44
    v_mfma_f32_32x32x16_bf16 v[64:79], a[192:195], v[52:55], v[64:79]
    ds_read_b128 a[172:175], v191 offset:49152
    buffer_load_dwordx4 v211, s[28:31], s64 offen offset:3072 nt lds
    v_add_f32 v214, v214, v5
    v_cvt_pk_bf16_f32 v61, v4, v5
    v_add_f32 v218, v218, v7
    v_cvt_pk_bf16_f32 v170, v6, v7
    v_mfma_f32_32x32x16_bf16 v[80:95], a[196:199], v[52:55], v[80:95]
    v_exp_f32 v3, v45
    v_add_f32 v214, v214, v2
    v_exp_f32 v4, v46
    v_add_f32 v214, v214, v3
    v_cvt_pk_bf16_f32 v62, v2, v3
    v_mfma_f32_32x32x16_bf16 v[96:111], a[200:203], v[52:55], v[96:111]
    v_exp_f32 v5, v47
    v_add_f32 v214, v214, v4
    v_add_f32 v214, v214, v5
    v_cvt_pk_bf16_f32 v63, v4, v5
    v_cmp_lt_f32 vcc, s56, v214
    v_mfma_f32_32x32x16_bf16 v[112:127], a[204:207], v[52:55], v[112:127]
    s_cbranch_vccnz L_stub9
L_back9:
    s_waitcnt lgkmcnt(0)
    s_waitcnt vmcnt(16)
    s_barrier
    v_mfma_f32_32x32x16_bf16 v[32:47], a[144:147], a[0:3], v[224:239]
    ds_read_b64_tr_b16 a[176:177], v192 offset:49152
    ds_read_b64_tr_b16 a[178:179], v192 offset:51200
    ds_read_b64_tr_b16 a[180:181], v193 offset:49152
    v_exp_f32 v2, v16
    v_exp_f32 v9, v167
    v_mfma_f32_32x32x16_bf16 v[32:47], a[148:151], a[4:7], v[32:47]
    ds_read_b64_tr_b16 a[182:183], v193 offset:51200
    ds_read_b64_tr_b16 a[184:185], v194 offset:49152
    ds_read_b64_tr_b16 a[186:187], v194 offset:51200
    v_exp_f32 v3, v17
    v_add_f32 v215, v216, v2
    v_add_f32 v218, v218, v8
    v_mfma_f32_32x32x16_bf16 v[32:47], a[152:155], a[8:11], v[32:47]
    ds_read_b64_tr_b16 a[188:189], v195 offset:49152
    ds_read_b64_tr_b16 a[190:191], v195 offset:51200
    v_exp_f32 v4, v18
    v_add_f32 v215, v215, v3
    v_cvt_pk_bf16_f32 v48, v2, v3
    v_mfma_f32_32x32x16_bf16 v[32:47], a[156:159], a[12:15], v[32:47]
    ds_read_b64_tr_b16 a[192:193], v192 offset:53248
    ds_read_b64_tr_b16 a[194:195], v192 offset:55296
    ds_read_b64_tr_b16 a[196:197], v193 offset:53248
    v_exp_f32 v5, v19
    v_add_f32 v218, v218, v9
    v_cvt_pk_bf16_f32 v171, v8, v9
    v_mfma_f32_32x32x16_bf16 v[32:47], a[160:163], a[16:19], v[32:47]
    ds_read_b64_tr_b16 a[198:199], v193 offset:55296
    ds_read_b64_tr_b16 a[200:201], v194 offset:53248
    ds_read_b64_tr_b16 a[202:203], v194 offset:55296
    v_add_f32 v215, v215, v4
    v_exp_f32 v2, v20
    v_cmp_lt_f32 vcc, s56, v218
    v_mfma_f32_32x32x16_bf16 v[32:47], a[164:167], a[20:23], v[32:47]
    ds_read_b64_tr_b16 a[204:205], v195 offset:53248
    s_waitcnt lgkmcnt(14)
    ds_read_b64_tr_b16 a[206:207], v195 offset:55296
    v_add_f32 v215, v215, v5
    v_cvt_pk_bf16_f32 v49, v4, v5
    v_exp_f32 v3, v21
    v_mfma_f32_32x32x16_bf16 v[32:47], a[168:171], a[24:27], v[32:47]
    v_add_f32 v215, v215, v2
    v_exp_f32 v4, v22
    v_add_f32 v215, v215, v3
    v_cvt_pk_bf16_f32 v50, v2, v3
    v_mfma_f32_32x32x16_bf16 v[32:47], a[172:175], a[28:31], v[32:47]
    s_waitcnt lgkmcnt(8)
    s_cbranch_vccnz L_stub101
L_back101:
    v_mov_b32 v217, v218
    ds_read_b128 a[144:147], v176
    ds_read_b128 a[148:151], v177
    v_exp_f32 v5, v23
    v_add_f32 v215, v215, v4
    v_mfma_f32_32x32x16_bf16 v[64:79], a[176:179], v[56:59], v[64:79]
    ds_read_b128 a[152:155], v178
    v_exp_f32 v2, v24
    v_add_f32 v215, v215, v5
    v_cvt_pk_bf16_f32 v51, v4, v5
    v_mfma_f32_32x32x16_bf16 v[80:95], a[180:183], v[56:59], v[80:95]
    ds_read_b128 a[156:159], v179
    v_exp_f32 v3, v25
    v_add_f32 v215, v215, v2
    v_exp_f32 v4, v26
    v_mfma_f32_32x32x16_bf16 v[96:111], a[184:187], v[56:59], v[96:111]
    ds_read_b128 a[160:163], v180
    ds_read_b128 a[164:167], v181
    v_add_f32 v215, v215, v3
    v_cvt_pk_bf16_f32 v52, v2, v3
    v_exp_f32 v5, v27
    v_mfma_f32_32x32x16_bf16 v[112:127], a[188:191], v[56:59], v[112:127]
    s_waitcnt lgkmcnt(6)
    ds_read_b128 a[168:171], v182
    v_add_f32 v215, v215, v4
    v_exp_f32 v2, v28
    v_mfma_f32_32x32x16_bf16 v[64:79], a[192:195], v[60:63], v[64:79]
    ds_read_b128 a[172:175], v183
    v_add_f32 v215, v215, v5
    v_cvt_pk_bf16_f32 v53, v4, v5
    v_exp_f32 v3, v29
    v_add_f32 v215, v215, v2
    v_mfma_f32_32x32x16_bf16 v[80:95], a[196:199], v[60:63], v[80:95]
    v_exp_f32 v4, v30
    v_add_f32 v215, v215, v3
    v_cvt_pk_bf16_f32 v54, v2, v3
    v_mfma_f32_32x32x16_bf16 v[96:111], a[200:203], v[60:63], v[96:111]
    v_exp_f32 v5, v31
    v_add_f32 v215, v215, v4
    v_add_f32 v215, v215, v5
    v_cvt_pk_bf16_f32 v55, v4, v5
    v_cmp_lt_f32 vcc, s56, v215
    v_mfma_f32_32x32x16_bf16 v[112:127], a[204:207], v[60:63], v[112:127]
    s_cbranch_vccnz L_stub10
L_back10:
    s_waitcnt lgkmcnt(4)
    v_mfma_f32_32x32x16_bf16 v[16:31], a[144:147], a[0:3], v[224:239]
    s_add_u32 s64, s3, 81920
    v_exp_f32 v2, v32
    v_exp_f32 v3, v33
    v_mfma_f32_32x32x16_bf16 v[16:31], a[148:151], a[4:7], v[16:31]
    v_add_f32 v213, v214, v2
    v_exp_f32 v4, v34
    v_mfma_f32_32x32x16_bf16 v[16:31], a[152:155], a[8:11], v[16:31]
    s_and_b32 s64, s64, 114688
    v_add_f32 v213, v213, v3
    v_cvt_pk_bf16_f32 v56, v2, v3
    v_exp_f32 v5, v35
    v_mfma_f32_32x32x16_bf16 v[16:31], a[156:159], a[12:15], v[16:31]
    s_waitcnt lgkmcnt(0)
    ds_read_b64_tr_b16 a[208:209], v204 offset:32768
    ds_read_b64_tr_b16 a[210:211], v204 offset:36864
    v_add_f32 v213, v213, v4
    v_exp_f32 v2, v36
    v_mfma_f32_32x32x16_bf16 v[16:31], a[160:163], a[16:19], v[16:31]
    ds_read_b64_tr_b16 a[212:213], v204 offset:32784
    ds_read_b64_tr_b16 a[214:215], v204 offset:36880
    s_add_u32 m0, s54, 81920
    v_add_f32 v213, v213, v5
    v_cvt_pk_bf16_f32 v57, v4, v5
    v_mfma_f32_32x32x16_bf16 v[16:31], a[164:167], a[20:23], v[16:31]
    ds_read_b64_tr_b16 a[216:217], v205 offset:32768
    ds_read_b64_tr_b16 a[218:219], v205 offset:36864
    v_exp_f32 v3, v37
    v_mfma_f32_32x32x16_bf16 v[16:31], a[168:171], a[24:27], v[16:31]
    ds_read_b64_tr_b16 a[220:221], v205 offset:32784
    ds_read_b64_tr_b16 a[222:223], v205 offset:36880
    buffer_load_dwordx4 v212, s[32:35], s64 offen nt lds
    v_add_f32 v213, v213, v2
    v_mfma_f32_32x32x16_bf16 v[16:31], a[172:175], a[28:31], v[16:31]
    v_exp_f32 v4, v38
    v_add_f32 v213, v213, v3
    v_cvt_pk_bf16_f32 v58, v2, v3
    v_mfma_f32_32x32x16_bf16 v[128:143], a[176:179], v[48:51], v[128:143]
    v_exp_f32 v5, v39
    v_add_f32 v213, v213, v4
    v_exp_f32 v2, v40
    s_waitcnt lgkmcnt(6)
    v_mfma_f32_16x16x32_bf16 a[112:115], a[208:211], v[168:171], a[112:115]
    ds_read_b64_tr_b16 a[208:209], v206 offset:32768
    ds_read_b64_tr_b16 a[210:211], v206 offset:36864
    v_mfma_f32_32x32x16_bf16 v[144:159], a[180:183], v[48:51], v[144:159]
    buffer_load_dwordx4 v212, s[32:35], s64 offen offset:1024 nt lds
    v_add_f32 v213, v213, v5
    v_cvt_pk_bf16_f32 v59, v4, v5
    s_waitcnt lgkmcnt(6)
    v_mfma_f32_16x16x32_bf16 a[116:119], a[212:215], v[168:171], a[116:119]
    ds_read_b64_tr_b16 a[212:213], v206 offset:32784
    ds_read_b64_tr_b16 a[214:215], v206 offset:36880
    v_mfma_f32_32x32x16_bf16 a[80:95], a[184:187], v[48:51], a[80:95]
    v_exp_f32 v3, v41
    v_add_f32 v213, v213, v2
    v_exp_f32 v4, v42
    s_waitcnt lgkmcnt(6)
    v_mfma_f32_16x16x32_bf16 a[120:123], a[216:219], v[168:171], a[120:123]
    ds_read_b64_tr_b16 a[216:217], v207 offset:32768
    ds_read_b64_tr_b16 a[218:219], v207 offset:36864
    v_mfma_f32_32x32x16_bf16 a[96:111], a[188:191], v[48:51], a[96:111]
    buffer_load_dwordx4 v212, s[32:35], s64 offen offset:2048 nt lds
    v_add_f32 v213, v213, v3
    v_cvt_pk_bf16_f32 v60, v2, v3
    s_waitcnt lgkmcnt(6)
    v_mfma_f32_16x16x32_bf16 a[124:127], a[220:223], v[168:171], a[124:127]
    ds_read_b64_tr_b16 a[220:221], v207 offset:32784
    ds_read_b64_tr_b16 a[222:223], v207 offset:36880
    v_mfma_f32_32x32x16_bf16 v[128:143], a[192:195], v[52:55], v[128:143]
    v_exp_f32 v5, v43
    v_add_f32 v213, v213, v4
    v_exp_f32 v2, v44
    s_waitcnt lgkmcnt(6)
    v_mfma_f32_16x16x32_bf16 a[128:131], a[208:211], v[168:171], a[128:131]
    v_add_f32 v213, v213, v5
    v_mfma_f32_32x32x16_bf16 v[144:159], a[196:199], v[52:55], v[144:159]
    buffer_load_dwordx4 v212, s[32:35], s64 offen offset:3072 nt lds
    v_cvt_pk_bf16_f32 v61, v4, v5
    v_exp_f32 v3, v45
    s_waitcnt lgkmcnt(4)
    v_mfma_f32_16x16x32_bf16 a[132:135], a[212:215], v[168:171], a[132:135]
    v_add_f32 v213, v213, v2
    v_mfma_f32_32x32x16_bf16 a[80:95], a[200:203], v[52:55], a[80:95]
    v_exp_f32 v4, v46
    v_add_f32 v213, v213, v3
    v_cvt_pk_bf16_f32 v62, v2, v3
    s_waitcnt lgkmcnt(2)
    v_mfma_f32_16x16x32_bf16 a[136:139], a[216:219], v[168:171], a[136:139]
    v_exp_f32 v5, v47
    v_mfma_f32_32x32x16_bf16 a[96:111], a[204:207], v[52:55], a[96:111]
    v_add_f32 v213, v213, v4
    v_add_f32 v213, v213, v5
    v_cvt_pk_bf16_f32 v63, v4, v5
    v_cmp_lt_f32 vcc, s56, v213
    s_waitcnt lgkmcnt(0)
    v_mfma_f32_16x16x32_bf16 a[140:143], a[220:223], v[168:171], a[140:143]
    s_cbranch_vccnz L_stub11
L_back11:
    v_mfma_f32_32x32x16_bf16 v[32:47], a[144:147], a[32:35], v[240:255]
    ds_read_b64_tr_b16 a[176:177], v196 offset:49152
    ds_read_b64_tr_b16 a[178:179], v196 offset:51200
    ds_read_b64_tr_b16 a[180:181], v197 offset:49152
    s_add_u32 s64, s3, 98304
    v_exp_f32 v2, v16
    v_mfma_f32_32x32x16_bf16 v[32:47], a[148:151], a[36:39], v[32:47]
    ds_read_b64_tr_b16 a[182:183], v197 offset:51200
    ds_read_b64_tr_b16 a[184:185], v198 offset:49152
    ds_read_b64_tr_b16 a[186:187], v198 offset:51200
    s_and_b32 s64, s64, 114688
    v_exp_f32 v3, v17
    v_mfma_f32_32x32x16_bf16 v[32:47], a[152:155], a[40:43], v[32:47]
    ds_read_b64_tr_b16 a[188:189], v199 offset:49152
    ds_read_b64_tr_b16 a[190:191], v199 offset:51200
    s_add_u32 m0, s54, 32768
    v_add_f32 v214, v213, v2
    v_exp_f32 v4, v18
    v_add_f32 v214, v214, v3
    v_mfma_f32_32x32x16_bf16 v[32:47], a[156:159], a[44:47], v[32:47]
    ds_read_b64_tr_b16 a[192:193], v196 offset:53248
    ds_read_b64_tr_b16 a[194:195], v196 offset:55296
    ds_read_b64_tr_b16 a[196:197], v197 offset:53248
    v_cvt_pk_bf16_f32 v48, v2, v3
    v_exp_f32 v5, v19
    v_mfma_f32_32x32x16_bf16 v[32:47], a[160:163], a[48:51], v[32:47]
    ds_read_b64_tr_b16 a[198:199], v197 offset:55296
    ds_read_b64_tr_b16 a[200:201], v198 offset:53248
    ds_read_b64_tr_b16 a[202:203], v198 offset:55296
    buffer_load_dwordx4 v208, s[28:31], s64 offen nt lds
    v_add_f32 v214, v214, v4
    v_mfma_f32_32x32x16_bf16 v[32:47], a[164:167], a[52:55], v[32:47]
    ds_read_b64_tr_b16 a[204:205], v199 offset:53248
    s_waitcnt lgkmcnt(14)
    ds_read_b64_tr_b16 a[206:207], v199 offset:55296
    v_exp_f32 v2, v20
    v_add_f32 v214, v214, v5
    v_cvt_pk_bf16_f32 v49, v4, v5
    v_mfma_f32_32x32x16_bf16 v[32:47], a[168:171], a[56:59], v[32:47]
    buffer_load_dwordx4 v209, s[28:31], s64 offen offset:1024 nt lds
    v_exp_f32 v3, v21
    v_add_f32 v214, v214, v2
    v_exp_f32 v4, v22
    v_mfma_f32_32x32x16_bf16 v[32:47], a[172:175], a[60:63], v[32:47]
    s_waitcnt lgkmcnt(8)
    ds_read_b128 a[144:147], v184
    ds_read_b128 a[148:151], v185
    v_add_f32 v214, v214, v3
    v_cvt_pk_bf16_f32 v50, v2, v3
    v_exp_f32 v5, v23
    v_mfma_f32_32x32x16_bf16 v[64:79], a[176:179], v[56:59], v[64:79]
    ds_read_b128 a[152:155], v186
    v_add_f32 v214, v214, v4
    v_exp_f32 v2, v24
    v_add_f32 v214, v214, v5
    v_mfma_f32_32x32x16_bf16 v[80:95], a[180:183], v[56:59], v[80:95]
    ds_read_b128 a[156:159], v187
    buffer_load_dwordx4 v210, s[28:31], s64 offen offset:2048 nt lds
    v_cvt_pk_bf16_f32 v51, v4, v5
    v_exp_f32 v3, v25
    v_add_f32 v214, v214, v2
    v_mfma_f32_32x32x16_bf16 v[96:111], a[184:187], v[56:59], v[96:111]
    ds_read_b128 a[160:163], v188
    ds_read_b128 a[164:167], v189
    v_exp_f32 v4, v26
    v_add_f32 v214, v214, v3
    v_cvt_pk_bf16_f32 v52, v2, v3
    v_mfma_f32_32x32x16_bf16 v[112:127], a[188:191], v[56:59], v[112:127]
    s_waitcnt lgkmcnt(6)
    ds_read_b128 a[168:171], v190
    v_exp_f32 v5, v27
    v_add_f32 v214, v214, v4
    v_exp_f32 v2, v28
    v_mfma_f32_32x32x16_bf16 v[64:79], a[192:195], v[60:63], v[64:79]
    ds_read_b128 a[172:175], v191
    buffer_load_dwordx4 v211, s[28:31], s64 offen offset:3072 nt lds
    v_add_f32 v214, v214, v5
    v_cvt_pk_bf16_f32 v53, v4, v5
    v_mfma_f32_32x32x16_bf16 v[80:95], a[196:199], v[60:63], v[80:95]
    v_exp_f32 v3, v29
    v_add_f32 v214, v214, v2
    v_exp_f32 v4, v30
    v_add_f32 v214, v214, v3
    v_cvt_pk_bf16_f32 v54, v2, v3
    v_mfma_f32_32x32x16_bf16 v[96:111], a[200:203], v[60:63], v[96:111]
    v_exp_f32 v5, v31
    v_add_f32 v214, v214, v4
    v_add_f32 v214, v214, v5
    v_cvt_pk_bf16_f32 v55, v4, v5
    v_cmp_lt_f32 vcc, s56, v214
    v_mfma_f32_32x32x16_bf16 v[112:127], a[204:207], v[60:63], v[112:127]
    s_cbranch_vccnz L_stub12
L_back12:
    s_waitcnt lgkmcnt(0)
    s_waitcnt vmcnt(8)
    s_barrier
    v_mfma_f32_32x32x16_bf16 v[16:31], a[144:147], a[0:3], v[224:239]
    ds_read_b64_tr_b16 a[176:177], v192
    ds_read_b64_tr_b16 a[178:179], v192 offset:2048
    ds_read_b64_tr_b16 a[180:181], v193
    v_exp_f32 v2, v32
    v_mfma_f32_32x32x16_bf16 v[16:31], a[148:151], a[4:7], v[16:31]
    ds_read_b64_tr_b16 a[182:183], v193 offset:2048
    ds_read_b64_tr_b16 a[184:185], v194
    ds_read_b64_tr_b16 a[186:187], v194 offset:2048
    v_exp_f32 v3, v33
    v_add_f32 v216, v215, v2
    v_mfma_f32_32x32x16_bf16 v[16:31], a[152:155], a[8:11], v[16:31]
    ds_read_b64_tr_b16 a[188:189], v195
    ds_read_b64_tr_b16 a[190:191], v195 offset:2048
    v_exp_f32 v4, v34
    v_add_f32 v216, v216, v3
    v_cvt_pk_bf16_f32 v56, v2, v3
    v_mfma_f32_32x32x16_bf16 v[16:31], a[156:159], a[12:15], v[16:31]
    ds_read_b64_tr_b16 a[192:193], v192 offset:4096
    ds_read_b64_tr_b16 a[194:195], v192 offset:6144
    ds_read_b64_tr_b16 a[196:197], v193 offset:4096
    v_exp_f32 v5, v35
    v_mfma_f32_32x32x16_bf16 v[16:31], a[160:163], a[16:19], v[16:31]
    ds_read_b64_tr_b16 a[198:199], v193 offset:6144
    ds_read_b64_tr_b16 a[200:201], v194 offset:4096
    ds_read_b64_tr_b16 a[202:203], v194 offset:6144
    v_add_f32 v216, v216, v4
    v_exp_f32 v2, v36
    v_mfma_f32_32x32x16_bf16 v[16:31], a[164:167], a[20:23], v[16:31]
    ds_read_b64_tr_b16 a[204:205], v195 offset:4096
    s_waitcnt lgkmcnt(14)
    ds_read_b64_tr_b16 a[206:207], v195 offset:6144
    v_add_f32 v216, v216, v5
    v_cvt_pk_bf16_f32 v57, v4, v5
    v_exp_f32 v3, v37
    v_mfma_f32_32x32x16_bf16 v[16:31], a[168:171], a[24:27], v[16:31]
    v_add_f32 v216, v216, v2
    v_exp_f32 v4, v38
    v_add_f32 v216, v216, v3
    v_cvt_pk_bf16_f32 v58, v2, v3
    v_mfma_f32_32x32x16_bf16 v[16:31], a[172:175], a[28:31], v[16:31]
    s_waitcnt lgkmcnt(8)
    ds_read_b128 a[144:147], v176 offset:16384
    ds_read_b128 a[148:151], v177 offset:16384
    v_exp_f32 v5, v39
    v_add_f32 v216, v216, v4
    v_mfma_f32_32x32x16_bf16 v[64:79], a[176:179], v[48:51], v[64:79]
    ds_read_b128 a[152:155], v178 offset:16384
    v_exp_f32 v2, v40
    v_add_f32 v216, v216, v5
    v_cvt_pk_bf16_f32 v59, v4, v5
    v_mfma_f32_32x32x16_bf16 v[80:95], a[180:183], v[48:51], v[80:95]
    ds_read_b128 a[156:159], v179 offset:16384
    v_exp_f32 v3, v41
    v_add_f32 v216, v216, v2
    v_exp_f32 v4, v42
    v_mfma_f32_32x32x16_bf16 v[96:111], a[184:187], v[48:51], v[96:111]
    ds_read_b128 a[160:163], v180 offset:16384
    ds_read_b128 a[164:167], v181 offset:16384
    v_add_f32 v216, v216, v3
    v_cvt_pk_bf16_f32 v60, v2, v3
    v_exp_f32 v5, v43
    v_mfma_f32_32x32x16_bf16 v[112:127], a[188:191], v[48:51], v[112:127]
    s_waitcnt lgkmcnt(6)
    ds_read_b128 a[168:171], v182 offset:16384
    v_add_f32 v216, v216, v4
    v_exp_f32 v2, v44
    v_mfma_f32_32x32x16_bf16 v[64:79], a[192:195], v[52:55], v[64:79]
    ds_read_b128 a[172:175], v183 offset:16384
    v_add_f32 v216, v216, v5
    v_cvt_pk_bf16_f32 v61, v4, v5
    v_exp_f32 v3, v45
    v_add_f32 v216, v216, v2
    v_mfma_f32_32x32x16_bf16 v[80:95], a[196:199], v[52:55], v[80:95]
    v_exp_f32 v4, v46
    v_add_f32 v216, v216, v3
    v_cvt_pk_bf16_f32 v62, v2, v3
    v_mfma_f32_32x32x16_bf16 v[96:111], a[200:203], v[52:55], v[96:111]
    v_exp_f32 v5, v47
    v_add_f32 v216, v216, v4
    v_add_f32 v216, v216, v5
    v_cvt_pk_bf16_f32 v63, v4, v5
    v_cmp_lt_f32 vcc, s56, v216
    v_mfma_f32_32x32x16_bf16 v[112:127], a[204:207], v[52:55], v[112:127]
    s_cbranch_vccnz L_stub13
L_back13:
    s_waitcnt lgkmcnt(4)
    ds_read_b128 a[208:211], v200
    ds_read_b128 a[212:215], v201
    v_mfma_f32_32x32x16_bf16 v[32:47], a[144:147], a[0:3], v[224:239]
    ds_read_b128 a[216:219], v202
    ds_read_b128 a[220:223], v203
    s_add_u32 s64, s3, 98304
    v_exp_f32 v2, v16
    s_waitcnt lgkmcnt(3)
    v_mfma_f32_16x16x32_bf16 v[160:163], a[208:211], a[64:67], v[172:175]
    ds_read_b128 a[208:211], v200 offset:4096
    v_mfma_f32_32x32x16_bf16 v[32:47], a[148:151], a[4:7], v[32:47]
    s_and_b32 s64, s64, 114688
    v_exp_f32 v3, v17
    v_add_f32 v213, v214, v2
    s_waitcnt lgkmcnt(3)
    v_mfma_f32_16x16x32_bf16 v[160:163], a[212:215], a[68:71], v[160:163]
    ds_read_b128 a[212:215], v201 offset:4096
    v_exp_f32 v4, v18
    v_mfma_f32_32x32x16_bf16 v[32:47], a[152:155], a[8:11], v[32:47]
    s_add_u32 m0, s54, 98304
    v_add_f32 v213, v213, v3
    v_cvt_pk_bf16_f32 v48, v2, v3
    s_waitcnt lgkmcnt(3)
    v_mfma_f32_16x16x32_bf16 v[160:163], a[216:219], a[72:75], v[160:163]
    ds_read_b128 a[216:219], v202 offset:4096
    v_exp_f32 v5, v19
    v_mfma_f32_32x32x16_bf16 v[32:47], a[156:159], a[12:15], v[32:47]
    buffer_load_dwordx4 v212, s[32:35], s64 offen nt lds
    v_add_f32 v213, v213, v4
    v_exp_f32 v2, v20
    s_waitcnt lgkmcnt(3)
    v_mfma_f32_16x16x32_bf16 v[160:163], a[220:223], a[76:79], v[160:163]
    ds_read_b128 a[220:223], v203 offset:4096
    v_mfma_f32_32x32x16_bf16 v[32:47], a[160:163], a[16:19], v[32:47]
    v_add_f32 v213, v213, v5
    v_cvt_pk_bf16_f32 v49, v4, v5
    v_exp_f32 v3, v21
    s_waitcnt lgkmcnt(3)
    v_mfma_f32_16x16x32_bf16 v[164:167], a[208:211], a[64:67], v[172:175]
    v_add_f32 v213, v213, v2
    v_mfma_f32_32x32x16_bf16 v[32:47], a[164:167], a[20:23], v[32:47]
    buffer_load_dwordx4 v212, s[32:35], s64 offen offset:1024 nt lds
    v_exp_f32 v4, v22
    v_add_f32 v213, v213, v3
    s_waitcnt lgkmcnt(2)
    v_mfma_f32_16x16x32_bf16 v[164:167], a[212:215], a[68:71], v[164:167]
    v_cvt_pk_bf16_f32 v50, v2, v3
    v_mfma_f32_32x32x16_bf16 v[32:47], a[168:171], a[24:27], v[32:47]
    v_exp_f32 v5, v23
    v_add_f32 v213, v213, v4
    s_waitcnt lgkmcnt(1)
    v_mfma_f32_16x16x32_bf16 v[164:167], a[216:219], a[72:75], v[164:167]
    v_exp_f32 v2, v24
    v_mfma_f32_32x32x16_bf16 v[32:47], a[172:175], a[28:31], v[32:47]
    buffer_load_dwordx4 v212, s[32:35], s64 offen offset:2048 nt lds
    v_add_f32 v213, v213, v5
    v_cvt_pk_bf16_f32 v51, v4, v5
    s_waitcnt lgkmcnt(0)
    v_mfma_f32_16x16x32_bf16 v[164:167], a[220:223], a[76:79], v[164:167]
    v_exp_f32 v3, v25
    v_mfma_f32_32x32x16_bf16 v[128:143], a[176:179], v[56:59], v[128:143]
    v_add_f32 v213, v213, v2
    v_exp_f32 v4, v26
    v_add_f32 v213, v213, v3
    v_mfma_f32_32x32x16_bf16 v[144:159], a[180:183], v[56:59], v[144:159]
    v_cvt_pk_bf16_f32 v52, v2, v3
    v_exp_f32 v5, v27
    v_exp_f32 v6, v160
    v_exp_f32 v7, v161
    v_mfma_f32_32x32x16_bf16 a[80:95], a[184:187], v[56:59], a[80:95]
    buffer_load_dwordx4 v212, s[32:35], s64 offen offset:3072 nt lds
    v_add_f32 v213, v213, v4
    v_exp_f32 v2, v28
    v_add_f32 v218, v217, v6
    v_mfma_f32_32x32x16_bf16 a[96:111], a[188:191], v[56:59], a[96:111]
    v_add_f32 v213, v213, v5
    v_cvt_pk_bf16_f32 v53, v4, v5
    v_exp_f32 v3, v29
    v_exp_f32 v8, v162
    v_add_f32 v218, v218, v7
    v_mfma_f32_32x32x16_bf16 v[128:143], a[192:195], v[60:63], v[128:143]
    v_add_f32 v213, v213, v2
    v_exp_f32 v4, v30
    v_cvt_pk_bf16_f32 v168, v6, v7
    v_exp_f32 v9, v163
    v_add_f32 v218, v218, v8
    v_mfma_f32_32x32x16_bf16 v[144:159], a[196:199], v[60:63], v[144:159]
    v_add_f32 v213, v213, v3
    v_cvt_pk_bf16_f32 v54, v2, v3
    v_exp_f32 v5, v31
    v_exp_f32 v6, v164
    v_add_f32 v218, v218, v9
    v_mfma_f32_32x32x16_bf16 a[80:95], a[200:203], v[60:63], a[80:95]
    v_add_f32 v213, v213, v4
    v_add_f32 v213, v213, v5
    v_cvt_pk_bf16_f32 v55, v4, v5
    v_cmp_lt_f32 vcc, s56, v213
    v_cvt_pk_bf16_f32 v169, v8, v9
    v_exp_f32 v7, v165
    v_mfma_f32_32x32x16_bf16 a[96:111], a[204:207], v[60:63], a[96:111]
    s_cbranch_vccnz L_stub14
L_back14:
    v_mfma_f32_32x32x16_bf16 v[16:31], a[144:147], a[32:35], v[240:255]
    ds_read_b64_tr_b16 a[176:177], v196
    ds_read_b64_tr_b16 a[178:179], v196 offset:2048
    ds_read_b64_tr_b16 a[180:181], v197
    s_add_u32 s64, s3, 114688
    v_exp_f32 v2, v32
    v_mfma_f32_32x32x16_bf16 v[16:31], a[148:151], a[36:39], v[16:31]
    ds_read_b64_tr_b16 a[182:183], v197 offset:2048
    ds_read_b64_tr_b16 a[184:185], v198
    ds_read_b64_tr_b16 a[186:187], v198 offset:2048
    s_and_b32 s64, s64, 114688
    v_exp_f32 v3, v33
    v_mfma_f32_32x32x16_bf16 v[16:31], a[152:155], a[40:43], v[16:31]
    ds_read_b64_tr_b16 a[188:189], v199
    ds_read_b64_tr_b16 a[190:191], v199 offset:2048
    s_add_u32 m0, s54, 49152
    v_add_f32 v214, v213, v2
    v_exp_f32 v4, v34
    v_add_f32 v214, v214, v3
    v_add_f32 v218, v218, v6
    v_mfma_f32_32x32x16_bf16 v[16:31], a[156:159], a[44:47], v[16:31]
    ds_read_b64_tr_b16 a[192:193], v196 offset:4096
    ds_read_b64_tr_b16 a[194:195], v196 offset:6144
    ds_read_b64_tr_b16 a[196:197], v197 offset:4096
    v_cvt_pk_bf16_f32 v56, v2, v3
    v_exp_f32 v5, v35
    v_mfma_f32_32x32x16_bf16 v[16:31], a[160:163], a[48:51], v[16:31]
    ds_read_b64_tr_b16 a[198:199], v197 offset:6144
    ds_read_b64_tr_b16 a[200:201], v198 offset:4096
    ds_read_b64_tr_b16 a[202:203], v198 offset:6144
    buffer_load_dwordx4 v208, s[28:31], s64 offen nt lds
    v_add_f32 v214, v214, v4
    v_mfma_f32_32x32x16_bf16 v[16:31], a[164:167], a[52:55], v[16:31]
    ds_read_b64_tr_b16 a[204:205], v199 offset:4096
    s_waitcnt lgkmcnt(14)
    ds_read_b64_tr_b16 a[206:207], v199 offset:6144
    v_exp_f32 v2, v36
    v_add_f32 v214, v214, v5
    v_cvt_pk_bf16_f32 v57, v4, v5
    v_mfma_f32_32x32x16_bf16 v[16:31], a[168:171], a[56:59], v[16:31]
    buffer_load_dwordx4 v209, s[28:31], s64 offen offset:1024 nt lds
    v_exp_f32 v3, v37
    v_add_f32 v214, v214, v2
    v_exp_f32 v4, v38
    v_mfma_f32_32x32x16_bf16 v[16:31], a[172:175], a[60:63], v[16:31]
    s_waitcnt lgkmcnt(8)
    ds_read_b128 a[144:147], v184 offset:16384
    ds_read_b128 a[148:151], v185 offset:16384
    v_add_f32 v214, v214, v3
    v_cvt_pk_bf16_f32 v58, v2, v3
    v_exp_f32 v5, v39
    v_mfma_f32_32x32x16_bf16 v[64:79], a[176:179], v[48:51], v[64:79]
    ds_read_b128 a[152:155], v186 offset:16384
    v_add_f32 v214, v214, v4
    v_exp_f32 v2, v40
    v_add_f32 v214, v214, v5
    v_exp_f32 v8, v166
    v_mfma_f32_32x32x16_bf16 v[80:95], a[180:183], v[48:51], v[80:95]
    ds_read_b128 a[156:159], v187 offset:16384
    buffer_load_dwordx4 v210, s[28:31], s64 offen offset:2048 nt lds
    v_cvt_pk_bf16_f32 v59, v4, v5
    v_exp_f32 v3, v41
    v_add_f32 v214, v214, v2
    v_mfma_f32_32x32x16_bf16 v[96:111], a[184:187], v[48:51], v[96:111]
    ds_read_b128 a[160:163], v188 offset:16384
    ds_read_b128 a[164:167], v189 offset:16384
    v_exp_f32 v4, v42
    v_add_f32 v214, v214, v3
    v_cvt_pk_bf16_f32 v60, v2, v3
    v_mfma_f32_32x32x16_bf16 v[112:127], a[188:191], v[48:51], v[112:127]
    s_waitcnt lgkmcnt(6)
    ds_read_b128 a[168:171], v190 offset:16384
    v_exp_f32 v5, v43
    v_add_f32 v214, v214, v4
    v_exp_f32 v2, v44
    v_mfma_f32_32x32x16_bf16 v[64:79], a[192:195], v[52:55], v[64:79]
    ds_read_b128 a[172:175], v191 offset:16384
    buffer_load_dwordx4 v211, s[28:31], s64 offen offset:3072 nt lds
    v_add_f32 v214, v214, v5
    v_cvt_pk_bf16_f32 v61, v4, v5
    v_add_f32 v218, v218, v7
    v_cvt_pk_bf16_f32 v170, v6, v7
    v_mfma_f32_32x32x16_bf16 v[80:95], a[196:199], v[52:55], v[80:95]
    v_exp_f32 v3, v45
    v_add_f32 v214, v214, v2
    v_exp_f32 v4, v46
    v_add_f32 v214, v214, v3
    v_cvt_pk_bf16_f32 v62, v2, v3
    v_mfma_f32_32x32x16_bf16 v[96:111], a[200:203], v[52:55], v[96:111]
    v_exp_f32 v5, v47
    v_add_f32 v214, v214, v4
    v_add_f32 v214, v214, v5
    v_cvt_pk_bf16_f32 v63, v4, v5
    v_cmp_lt_f32 vcc, s56, v214
    v_mfma_f32_32x32x16_bf16 v[112:127], a[204:207], v[52:55], v[112:127]
    s_cbranch_vccnz L_stub15
L_back15:
    s_waitcnt lgkmcnt(0)
    s_waitcnt vmcnt(8)
    s_barrier
    v_mfma_f32_32x32x16_bf16 v[32:47], a[144:147], a[0:3], v[224:239]
    ds_read_b64_tr_b16 a[176:177], v192 offset:16384
    ds_read_b64_tr_b16 a[178:179], v192 offset:18432
    ds_read_b64_tr_b16 a[180:181], v193 offset:16384
    s_add_u32 s71, s67, 2
    v_exp_f32 v2, v16
    v_exp_f32 v9, v167
    v_mfma_f32_32x32x16_bf16 v[32:47], a[148:151], a[4:7], v[32:47]
    ds_read_b64_tr_b16 a[182:183], v193 offset:18432
    ds_read_b64_tr_b16 a[184:185], v194 offset:16384
    ds_read_b64_tr_b16 a[186:187], v194 offset:18432
    s_and_b32 s71, s71, 7
    v_exp_f32 v3, v17
    v_add_f32 v215, v216, v2
    v_mfma_f32_32x32x16_bf16 v[32:47], a[152:155], a[8:11], v[32:47]
    ds_read_b64_tr_b16 a[188:189], v195 offset:16384
    ds_read_b64_tr_b16 a[190:191], v195 offset:18432
    s_lshl_b32 s71, s71, 17
    v_exp_f32 v4, v18
    v_add_f32 v215, v215, v3
    v_add_f32 v218, v218, v8
    v_mfma_f32_32x32x16_bf16 v[32:47], a[156:159], a[12:15], v[32:47]
    ds_read_b64_tr_b16 a[192:193], v192 offset:20480
    ds_read_b64_tr_b16 a[194:195], v192 offset:22528
    ds_read_b64_tr_b16 a[196:197], v193 offset:20480
    s_add_u32 m0, s54, 0
    v_cvt_pk_bf16_f32 v48, v2, v3
    v_exp_f32 v5, v19
    v_add_f32 v218, v218, v9
    v_mfma_f32_32x32x16_bf16 v[32:47], a[160:163], a[16:19], v[32:47]
    ds_read_b64_tr_b16 a[198:199], v193 offset:22528
    ds_read_b64_tr_b16 a[200:201], v194 offset:20480
    ds_read_b64_tr_b16 a[202:203], v194 offset:22528
    buffer_load_dwordx4 v221, s[20:23], s71 offen lds
    v_add_f32 v215, v215, v4
    v_cvt_pk_bf16_f32 v171, v8, v9
    v_mfma_f32_32x32x16_bf16 v[32:47], a[164:167], a[20:23], v[32:47]
    ds_read_b64_tr_b16 a[204:205], v195 offset:20480
    s_waitcnt lgkmcnt(14)
    ds_read_b64_tr_b16 a[206:207], v195 offset:22528
    v_exp_f32 v2, v20
    v_add_f32 v215, v215, v5
    v_cvt_pk_bf16_f32 v49, v4, v5
    v_cmp_lt_f32 vcc, s56, v218
    v_mfma_f32_32x32x16_bf16 v[32:47], a[168:171], a[24:27], v[32:47]
    s_add_u32 s71, s71, 7168
    v_exp_f32 v3, v21
    v_add_f32 v215, v215, v2
    v_exp_f32 v4, v22
    v_add_f32 v215, v215, v3
    v_mfma_f32_32x32x16_bf16 v[32:47], a[172:175], a[28:31], v[32:47]
    s_waitcnt lgkmcnt(8)
    s_cbranch_vccnz L_stub102
L_back102:
    v_mov_b32 v217, v218
    ds_read_b128 a[144:147], v176 offset:32768
    ds_read_b128 a[148:151], v177 offset:32768
    buffer_load_dwordx4 v221, s[20:23], s71 offen offset:1024 lds
    v_cvt_pk_bf16_f32 v50, v2, v3
    v_mfma_f32_32x32x16_bf16 v[64:79], a[176:179], v[56:59], v[64:79]
    ds_read_b128 a[152:155], v178 offset:32768
    v_exp_f32 v5, v23
    v_add_f32 v215, v215, v4
    v_exp_f32 v2, v24
    v_add_f32 v215, v215, v5
    v_mfma_f32_32x32x16_bf16 v[80:95], a[180:183], v[56:59], v[80:95]
    ds_read_b128 a[156:159], v179 offset:32768
    s_add_u32 s71, s71, 7168
    v_cvt_pk_bf16_f32 v51, v4, v5
    v_exp_f32 v3, v25
    v_add_f32 v215, v215, v2
    v_mfma_f32_32x32x16_bf16 v[96:111], a[184:187], v[56:59], v[96:111]
    ds_read_b128 a[160:163], v180 offset:32768
    ds_read_b128 a[164:167], v181 offset:32768
    buffer_load_dwordx4 v221, s[20:23], s71 offen offset:2048 lds
    v_exp_f32 v4, v26
    v_add_f32 v215, v215, v3
    v_mfma_f32_32x32x16_bf16 v[112:127], a[188:191], v[56:59], v[112:127]
    s_waitcnt lgkmcnt(6)
    ds_read_b128 a[168:171], v182 offset:32768
    v_cvt_pk_bf16_f32 v52, v2, v3
    v_exp_f32 v5, v27
    v_add_f32 v215, v215, v4
    v_exp_f32 v2, v28
    v_mfma_f32_32x32x16_bf16 v[64:79], a[192:195], v[60:63], v[64:79]
    ds_read_b128 a[172:175], v183 offset:32768
    s_add_u32 s71, s71, 7168
    v_add_f32 v215, v215, v5
    v_cvt_pk_bf16_f32 v53, v4, v5
    v_exp_f32 v3, v29
    v_mfma_f32_32x32x16_bf16 v[80:95], a[196:199], v[60:63], v[80:95]
    buffer_load_dwordx4 v221, s[20:23], s71 offen offset:3072 lds
    v_add_f32 v215, v215, v2
    v_exp_f32 v4, v30
    v_add_f32 v215, v215, v3
    v_mfma_f32_32x32x16_bf16 v[96:111], a[200:203], v[60:63], v[96:111]
    v_cvt_pk_bf16_f32 v54, v2, v3
    v_exp_f32 v5, v31
    v_add_f32 v215, v215, v4
    v_add_f32 v215, v215, v5
    v_cvt_pk_bf16_f32 v55, v4, v5
    v_cmp_lt_f32 vcc, s56, v215
    v_mfma_f32_32x32x16_bf16 v[112:127], a[204:207], v[60:63], v[112:127]
    s_cbranch_vccnz L_stub16
L_back16:
    s_waitcnt lgkmcnt(4)
    v_mfma_f32_32x32x16_bf16 v[16:31], a[144:147], a[0:3], v[224:239]
    s_add_u32 s64, s3, 114688
    v_exp_f32 v2, v32
    v_exp_f32 v3, v33
    v_mfma_f32_32x32x16_bf16 v[16:31], a[148:151], a[4:7], v[16:31]
    v_add_f32 v213, v214, v2
    v_exp_f32 v4, v34
    v_mfma_f32_32x32x16_bf16 v[16:31], a[152:155], a[8:11], v[16:31]
    s_and_b32 s64, s64, 114688
    v_add_f32 v213, v213, v3
    v_cvt_pk_bf16_f32 v56, v2, v3
    v_exp_f32 v5, v35
    v_mfma_f32_32x32x16_bf16 v[16:31], a[156:159], a[12:15], v[16:31]
    s_waitcnt lgkmcnt(0)
    ds_read_b64_tr_b16 a[208:209], v204
    ds_read_b64_tr_b16 a[210:211], v204 offset:4096
    v_add_f32 v213, v213, v4
    v_exp_f32 v2, v36
    v_mfma_f32_32x32x16_bf16 v[16:31], a[160:163], a[16:19], v[16:31]
    ds_read_b64_tr_b16 a[212:213], v204 offset:16
    ds_read_b64_tr_b16 a[214:215], v204 offset:4112
    s_add_u32 m0, s54, 114688
    v_add_f32 v213, v213, v5
    v_cvt_pk_bf16_f32 v57, v4, v5
    v_mfma_f32_32x32x16_bf16 v[16:31], a[164:167], a[20:23], v[16:31]
    ds_read_b64_tr_b16 a[216:217], v205
    ds_read_b64_tr_b16 a[218:219], v205 offset:4096
    v_exp_f32 v3, v37
    v_mfma_f32_32x32x16_bf16 v[16:31], a[168:171], a[24:27], v[16:31]
    ds_read_b64_tr_b16 a[220:221], v205 offset:16
    ds_read_b64_tr_b16 a[222:223], v205 offset:4112
    buffer_load_dwordx4 v212, s[32:35], s64 offen nt lds
    v_add_f32 v213, v213, v2
    v_mfma_f32_32x32x16_bf16 v[16:31], a[172:175], a[28:31], v[16:31]
    v_exp_f32 v4, v38
    v_add_f32 v213, v213, v3
    v_cvt_pk_bf16_f32 v58, v2, v3
    v_mfma_f32_32x32x16_bf16 v[128:143], a[176:179], v[48:51], v[128:143]
    v_exp_f32 v5, v39
    v_add_f32 v213, v213, v4
    v_exp_f32 v2, v40
    s_waitcnt lgkmcnt(6)
    v_mfma_f32_16x16x32_bf16 a[112:115], a[208:211], v[168:171], a[112:115]
    ds_read_b64_tr_b16 a[208:209], v206
    ds_read_b64_tr_b16 a[210:211], v206 offset:4096
    v_mfma_f32_32x32x16_bf16 v[144:159], a[180:183], v[48:51], v[144:159]
    buffer_load_dwordx4 v212, s[32:35], s64 offen offset:1024 nt lds
    v_add_f32 v213, v213, v5
    v_cvt_pk_bf16_f32 v59, v4, v5
    s_waitcnt lgkmcnt(6)
    v_mfma_f32_16x16x32_bf16 a[116:119], a[212:215], v[168:171], a[116:119]
    ds_read_b64_tr_b16 a[212:213], v206 offset:16
    ds_read_b64_tr_b16 a[214:215], v206 offset:4112
    v_mfma_f32_32x32x16_bf16 a[80:95], a[184:187], v[48:51], a[80:95]
    v_exp_f32 v3, v41
    v_add_f32 v213, v213, v2
    v_exp_f32 v4, v42
    s_waitcnt lgkmcnt(6)
    v_mfma_f32_16x16x32_bf16 a[120:123], a[216:219], v[168:171], a[120:123]
    ds_read_b64_tr_b16 a[216:217], v207
    ds_read_b64_tr_b16 a[218:219], v207 offset:4096
    v_mfma_f32_32x32x16_bf16 a[96:111], a[188:191], v[48:51], a[96:111]
    buffer_load_dwordx4 v212, s[32:35], s64 offen offset:2048 nt lds
    v_add_f32 v213, v213, v3
    v_cvt_pk_bf16_f32 v60, v2, v3
    s_waitcnt lgkmcnt(6)
    v_mfma_f32_16x16x32_bf16 a[124:127], a[220:223], v[168:171], a[124:127]
    ds_read_b64_tr_b16 a[220:221], v207 offset:16
    ds_read_b64_tr_b16 a[222:223], v207 offset:4112
    v_mfma_f32_32x32x16_bf16 v[128:143], a[192:195], v[52:55], v[128:143]
    v_exp_f32 v5, v43
    v_add_f32 v213, v213, v4
    v_exp_f32 v2, v44
    s_waitcnt lgkmcnt(6)
    v_mfma_f32_16x16x32_bf16 a[128:131], a[208:211], v[168:171], a[128:131]
    v_add_f32 v213, v213, v5
    v_mfma_f32_32x32x16_bf16 v[144:159], a[196:199], v[52:55], v[144:159]
    buffer_load_dwordx4 v212, s[32:35], s64 offen offset:3072 nt lds
    v_cvt_pk_bf16_f32 v61, v4, v5
    v_exp_f32 v3, v45
    s_waitcnt lgkmcnt(4)
    v_mfma_f32_16x16x32_bf16 a[132:135], a[212:215], v[168:171], a[132:135]
    v_add_f32 v213, v213, v2
    v_mfma_f32_32x32x16_bf16 a[80:95], a[200:203], v[52:55], a[80:95]
    v_exp_f32 v4, v46
    v_add_f32 v213, v213, v3
    v_cvt_pk_bf16_f32 v62, v2, v3
    s_waitcnt lgkmcnt(2)
    v_mfma_f32_16x16x32_bf16 a[136:139], a[216:219], v[168:171], a[136:139]
    v_exp_f32 v5, v47
    v_mfma_f32_32x32x16_bf16 a[96:111], a[204:207], v[52:55], a[96:111]
    v_add_f32 v213, v213, v4
    v_add_f32 v213, v213, v5
    v_cvt_pk_bf16_f32 v63, v4, v5
    v_cmp_lt_f32 vcc, s56, v213
    s_waitcnt lgkmcnt(0)
    v_mfma_f32_16x16x32_bf16 a[140:143], a[220:223], v[168:171], a[140:143]
    s_cbranch_vccnz L_stub17
L_back17:
    s_waitcnt vmcnt(8)
    s_barrier
    v_mfma_f32_32x32x16_bf16 v[32:47], a[144:147], a[32:35], v[240:255]
    ds_read_b64_tr_b16 a[176:177], v196 offset:16384
    ds_read_b64_tr_b16 a[178:179], v196 offset:18432
    ds_read_b64_tr_b16 a[180:181], v197 offset:16384
    s_add_u32 s71, s100, 0
    v_exp_f32 v2, v16
    v_mfma_f32_32x32x16_bf16 v[32:47], a[148:151], a[36:39], v[32:47]
    ds_read_b64_tr_b16 a[182:183], v197 offset:18432
    ds_read_b64_tr_b16 a[184:185], v198 offset:16384
    ds_read_b64_tr_b16 a[186:187], v198 offset:18432
    v_exp_f32 v3, v17
    v_add_f32 v214, v213, v2
    v_mfma_f32_32x32x16_bf16 v[32:47], a[152:155], a[40:43], v[32:47]
    ds_read_b64_tr_b16 a[188:189], v199 offset:16384
    ds_read_b64_tr_b16 a[190:191], v199 offset:18432
    v_exp_f32 v4, v18
    v_add_f32 v214, v214, v3
    v_cvt_pk_bf16_f32 v48, v2, v3
    v_mfma_f32_32x32x16_bf16 v[32:47], a[156:159], a[44:47], v[32:47]
    ds_read_b64_tr_b16 a[192:193], v196 offset:20480
    ds_read_b64_tr_b16 a[194:195], v196 offset:22528
    ds_read_b64_tr_b16 a[196:197], v197 offset:20480
    buffer_store_dwordx4 a[240:243], v222, s[8:11], s71 offen sc1
    v_mfma_f32_32x32x16_bf16 v[32:47], a[160:163], a[48:51], v[32:47]
    ds_read_b64_tr_b16 a[198:199], v197 offset:22528
    ds_read_b64_tr_b16 a[200:201], v198 offset:20480
    ds_read_b64_tr_b16 a[202:203], v198 offset:22528
    v_exp_f32 v5, v19
    v_add_f32 v214, v214, v4
    v_mfma_f32_32x32x16_bf16 v[32:47], a[164:167], a[52:55], v[32:47]
    ds_read_b64_tr_b16 a[204:205], v199 offset:20480
    s_waitcnt lgkmcnt(14)
    ds_read_b64_tr_b16 a[206:207], v199 offset:22528
    v_exp_f32 v2, v20
    v_add_f32 v214, v214, v5
    v_cvt_pk_bf16_f32 v49, v4, v5
    v_mfma_f32_32x32x16_bf16 v[32:47], a[168:171], a[56:59], v[32:47]
    v_exp_f32 v3, v21
    v_add_f32 v214, v214, v2
    v_exp_f32 v4, v22
    v_add_f32 v214, v214, v3
    v_mfma_f32_32x32x16_bf16 v[32:47], a[172:175], a[60:63], v[32:47]
    s_waitcnt lgkmcnt(8)
    ds_read_b128 a[144:147], v176 offset:49152
    ds_read_b128 a[148:151], v177 offset:49152
    v_cvt_pk_bf16_f32 v50, v2, v3
    v_exp_f32 v5, v23
    v_add_f32 v214, v214, v4
    v_mfma_f32_32x32x16_bf16 v[64:79], a[176:179], v[56:59], v[64:79]
    ds_read_b128 a[152:155], v178 offset:49152
    v_exp_f32 v2, v24
    v_add_f32 v214, v214, v5
    v_cvt_pk_bf16_f32 v51, v4, v5
    v_mfma_f32_32x32x16_bf16 v[80:95], a[180:183], v[56:59], v[80:95]
    ds_read_b128 a[156:159], v179 offset:49152
    buffer_store_dwordx4 a[240:243], v222, s[8:11], s71 offen offset:1024 sc1
    v_exp_f32 v3, v25
    v_add_f32 v214, v214, v2
    v_mfma_f32_32x32x16_bf16 v[96:111], a[184:187], v[56:59], v[96:111]
    ds_read_b128 a[160:163], v180 offset:49152
    ds_read_b128 a[164:167], v181 offset:49152
    v_exp_f32 v4, v26
    v_add_f32 v214, v214, v3
    v_cvt_pk_bf16_f32 v52, v2, v3
    v_mfma_f32_32x32x16_bf16 v[112:127], a[188:191], v[56:59], v[112:127]
    s_waitcnt lgkmcnt(6)
    ds_read_b128 a[168:171], v182 offset:49152
    v_exp_f32 v5, v27
    v_add_f32 v214, v214, v4
    v_exp_f32 v2, v28
    v_mfma_f32_32x32x16_bf16 v[64:79], a[192:195], v[60:63], v[64:79]
    ds_read_b128 a[172:175], v183 offset:49152
    v_add_f32 v214, v214, v5
    v_cvt_pk_bf16_f32 v53, v4, v5
    v_exp_f32 v3, v29
    v_mfma_f32_32x32x16_bf16 v[80:95], a[196:199], v[60:63], v[80:95]
    v_add_f32 v214, v214, v2
    v_exp_f32 v4, v30
    v_add_f32 v214, v214, v3
    v_cvt_pk_bf16_f32 v54, v2, v3
    v_mfma_f32_32x32x16_bf16 v[96:111], a[200:203], v[60:63], v[96:111]
    v_exp_f32 v5, v31
    v_add_f32 v214, v214, v4
    v_add_f32 v214, v214, v5
    v_cvt_pk_bf16_f32 v55, v4, v5
    v_cmp_lt_f32 vcc, s56, v214
    v_mfma_f32_32x32x16_bf16 v[112:127], a[204:207], v[60:63], v[112:127]
    s_cbranch_vccnz L_stub18
L_back18:
    s_waitcnt lgkmcnt(4)
    ds_read_b128 a[208:211], v200 offset:32768
    ds_read_b128 a[212:215], v201 offset:32768
    v_mfma_f32_32x32x16_bf16 v[16:31], a[144:147], a[0:3], v[224:239]
    ds_read_b64_tr_b16 a[176:177], v192 offset:32768
    ds_read_b64_tr_b16 a[178:179], v192 offset:34816
    ds_read_b128 a[216:219], v202 offset:32768
    ds_read_b128 a[220:223], v203 offset:32768
    s_add_u32 s71, s67, 3
    s_waitcnt lgkmcnt(5)
    v_mfma_f32_16x16x32_bf16 v[160:163], a[208:211], a[64:67], v[172:175]
    ds_read_b64_tr_b16 a[180:181], v193 offset:32768
    ds_read_b128 a[208:211], v200 offset:36864
    s_and_b32 s71, s71, 7
    v_exp_f32 v2, v32
    v_mfma_f32_32x32x16_bf16 v[16:31], a[148:151], a[4:7], v[16:31]
    ds_read_b64_tr_b16 a[182:183], v193 offset:34816
    s_lshl_b32 s71, s71, 17
    v_exp_f32 v3, v33
    s_waitcnt lgkmcnt(7)
    v_mfma_f32_16x16x32_bf16 v[160:163], a[212:215], a[68:71], v[160:163]
    ds_read_b64_tr_b16 a[184:185], v194 offset:32768
    ds_read_b128 a[212:215], v201 offset:36864
    s_add_u32 m0, s54, 16384
    v_add_f32 v216, v215, v2
    v_mfma_f32_32x32x16_bf16 v[16:31], a[152:155], a[8:11], v[16:31]
    ds_read_b64_tr_b16 a[186:187], v194 offset:34816
    buffer_load_dwordx4 v221, s[20:23], s71 offen lds
    v_exp_f32 v4, v34
    s_waitcnt lgkmcnt(7)
    v_mfma_f32_16x16x32_bf16 v[160:163], a[216:219], a[72:75], v[160:163]
    ds_read_b64_tr_b16 a[188:189], v195 offset:32768
    ds_read_b128 a[216:219], v202 offset:36864
    v_mfma_f32_32x32x16_bf16 v[16:31], a[156:159], a[12:15], v[16:31]
    ds_read_b64_tr_b16 a[190:191], v195 offset:34816
    s_add_u32 s71, s71, 7168
    v_add_f32 v216, v216, v3
    v_cvt_pk_bf16_f32 v56, v2, v3
    v_exp_f32 v5, v35
    s_waitcnt lgkmcnt(9)
    v_mfma_f32_16x16x32_bf16 v[160:163], a[220:223], a[76:79], v[160:163]
    ds_read_b64_tr_b16 a[192:193], v192 offset:36864
    ds_read_b64_tr_b16 a[194:195], v192 offset:38912
    ds_read_b128 a[220:223], v203 offset:36864
    v_mfma_f32_32x32x16_bf16 v[16:31], a[160:163], a[16:19], v[16:31]
    ds_read_b64_tr_b16 a[196:197], v193 offset:36864
    buffer_load_dwordx4 v221, s[20:23], s71 offen offset:1024 lds
    v_add_f32 v216, v216, v4
    v_exp_f32 v2, v36
    s_waitcnt lgkmcnt(11)
    v_mfma_f32_16x16x32_bf16 v[164:167], a[208:211], a[64:67], v[172:175]
    ds_read_b64_tr_b16 a[198:199], v193 offset:38912
    v_mfma_f32_32x32x16_bf16 v[16:31], a[164:167], a[20:23], v[16:31]
    ds_read_b64_tr_b16 a[200:201], v194 offset:36864
    s_add_u32 s71, s71, 7168
    v_add_f32 v216, v216, v5
    v_cvt_pk_bf16_f32 v57, v4, v5
    v_exp_f32 v3, v37
    s_waitcnt lgkmcnt(10)
    v_mfma_f32_16x16x32_bf16 v[164:167], a[212:215], a[68:71], v[164:167]
    ds_read_b64_tr_b16 a[202:203], v194 offset:38912
    buffer_load_dwordx4 v221, s[20:23], s71 offen offset:2048 lds
    v_mfma_f32_32x32x16_bf16 v[16:31], a[168:171], a[24:27], v[16:31]
    ds_read_b64_tr_b16 a[204:205], v195 offset:36864
    v_add_f32 v216, v216, v2
    v_exp_f32 v4, v38
    v_add_f32 v216, v216, v3
    s_waitcnt lgkmcnt(9)
    v_mfma_f32_16x16x32_bf16 v[164:167], a[216:219], a[72:75], v[164:167]
    ds_read_b64_tr_b16 a[206:207], v195 offset:38912
    s_add_u32 s71, s71, 7168
    v_mfma_f32_32x32x16_bf16 v[16:31], a[172:175], a[28:31], v[16:31]
    buffer_load_dwordx4 v221, s[20:23], s71 offen offset:3072 lds
    v_cvt_pk_bf16_f32 v58, v2, v3
    v_exp_f32 v5, v39
    s_waitcnt lgkmcnt(6)
    v_mfma_f32_16x16x32_bf16 v[164:167], a[220:223], a[76:79], v[164:167]
    v_add_f32 v216, v216, v4
    v_exp_f32 v2, v40
    v_mfma_f32_32x32x16_bf16 v[64:79], a[176:179], v[48:51], v[64:79]
    v_add_f32 v216, v216, v5
    v_cvt_pk_bf16_f32 v59, v4, v5
    v_exp_f32 v3, v41
    v_mfma_f32_32x32x16_bf16 v[80:95], a[180:183], v[48:51], v[80:95]
    s_add_u32 s71, s100, 8192
    v_add_f32 v216, v216, v2
    v_exp_f32 v4, v42
    v_add_f32 v216, v216, v3
    v_exp_f32 v6, v160
    v_exp_f32 v7, v161
    v_mfma_f32_32x32x16_bf16 v[96:111], a[184:187], v[48:51], v[96:111]
    buffer_store_dwordx4 a[240:243], v222, s[8:11], s71 offen sc1
    v_cvt_pk_bf16_f32 v60, v2, v3
    v_exp_f32 v5, v43
    v_add_f32 v218, v217, v6
    v_exp_f32 v8, v162
    v_mfma_f32_32x32x16_bf16 v[112:127], a[188:191], v[48:51], v[112:127]
    s_waitcnt lgkmcnt(0)
    v_add_f32 v216, v216, v4
    v_exp_f32 v2, v44
    v_add_f32 v216, v216, v5
    v_cvt_pk_bf16_f32 v61, v4, v5
    v_add_f32 v218, v218, v7
    v_cvt_pk_bf16_f32 v168, v6, v7
    v_mfma_f32_32x32x16_bf16 v[64:79], a[192:195], v[52:55], v[64:79]
    buffer_store_dwordx4 a[240:243], v222, s[8:11], s71 offen offset:1024 sc1
    v_exp_f32 v3, v45
    v_add_f32 v216, v216, v2
    v_exp_f32 v9, v163
    v_add_f32 v218, v218, v8
    v_mfma_f32_32x32x16_bf16 v[80:95], a[196:199], v[52:55], v[80:95]
    v_exp_f32 v4, v46
    v_add_f32 v216, v216, v3
    v_cvt_pk_bf16_f32 v62, v2, v3
    v_exp_f32 v5, v47
    v_mfma_f32_32x32x16_bf16 v[96:111], a[200:203], v[52:55], v[96:111]
    v_add_f32 v216, v216, v4
    v_add_f32 v216, v216, v5
    v_cvt_pk_bf16_f32 v63, v4, v5
    v_cmp_lt_f32 vcc, s56, v216
    v_exp_f32 v6, v164
    v_add_f32 v218, v218, v9
    v_cvt_pk_bf16_f32 v169, v8, v9
    v_exp_f32 v7, v165
    v_mfma_f32_32x32x16_bf16 v[112:127], a[204:207], v[52:55], v[112:127]
    s_cbranch_vccnz L_stub19
L_back19:
    v_mfma_f32_32x32x16_bf16 v[32:47], a[144:147], a[32:35], v[240:255]
    s_add_u32 s71, s100, 16384
    v_exp_f32 v2, v16
    v_exp_f32 v3, v17
    v_mfma_f32_32x32x16_bf16 v[32:47], a[148:151], a[36:39], v[32:47]
    v_add_f32 v213, v214, v2
    v_exp_f32 v4, v18
    v_add_f32 v213, v213, v3
    v_add_f32 v218, v218, v6
    v_mfma_f32_32x32x16_bf16 v[32:47], a[152:155], a[40:43], v[32:47]
    buffer_store_dwordx4 a[240:243], v222, s[8:11], s71 offen sc1
    v_cvt_pk_bf16_f32 v48, v2, v3
    v_exp_f32 v5, v19
    v_mfma_f32_32x32x16_bf16 v[32:47], a[156:159], a[44:47], v[32:47]
    v_add_f32 v213, v213, v4
    v_exp_f32 v2, v20
    v_add_f32 v213, v213, v5
    v_cvt_pk_bf16_f32 v49, v4, v5
    v_mfma_f32_32x32x16_bf16 v[32:47], a[160:163], a[48:51], v[32:47]
    v_exp_f32 v3, v21
    v_add_f32 v213, v213, v2
    v_exp_f32 v4, v22
    v_mfma_f32_32x32x16_bf16 v[32:47], a[164:167], a[52:55], v[32:47]
    v_add_f32 v213, v213, v3
    v_cvt_pk_bf16_f32 v50, v2, v3
    v_exp_f32 v5, v23
    v_exp_f32 v8, v166
    v_mfma_f32_32x32x16_bf16 v[32:47], a[168:171], a[56:59], v[32:47]
    buffer_store_dwordx4 a[240:243], v222, s[8:11], s71 offen offset:1024 sc1
    v_add_f32 v213, v213, v4
    v_exp_f32 v2, v24
    v_mfma_f32_32x32x16_bf16 v[32:47], a[172:175], a[60:63], v[32:47]
    ds_read_b128 a[144:147], v184 offset:32768
    ds_read_b128 a[148:151], v185 offset:32768
    v_add_f32 v213, v213, v5
    v_cvt_pk_bf16_f32 v51, v4, v5
    v_exp_f32 v3, v25
    v_mfma_f32_32x32x16_bf16 v[128:143], a[176:179], v[56:59], v[128:143]
    ds_read_b128 a[152:155], v186 offset:32768
    v_add_f32 v213, v213, v2
    v_exp_f32 v4, v26
    v_mfma_f32_32x32x16_bf16 v[144:159], a[180:183], v[56:59], v[144:159]
    ds_read_b128 a[156:159], v187 offset:32768
    v_add_f32 v213, v213, v3
    v_cvt_pk_bf16_f32 v52, v2, v3
    v_exp_f32 v5, v27
    v_mfma_f32_32x32x16_bf16 a[80:95], a[184:187], v[56:59], a[80:95]
    ds_read_b128 a[160:163], v188 offset:32768
    ds_read_b128 a[164:167], v189 offset:32768
    buffer_load_dword a244, v223, s[48:51], 0 offen
    v_add_f32 v213, v213, v4
    v_add_f32 v218, v218, v7
    v_mfma_f32_32x32x16_bf16 a[96:111], a[188:191], v[56:59], a[96:111]
    ds_read_b128 a[168:171], v190 offset:32768
    v_exp_f32 v2, v28
    v_add_f32 v213, v213, v5
    v_cvt_pk_bf16_f32 v53, v4, v5
    v_mfma_f32_32x32x16_bf16 v[128:143], a[192:195], v[60:63], v[128:143]
    ds_read_b128 a[172:175], v191 offset:32768
    v_exp_f32 v3, v29
    v_add_f32 v213, v213, v2
    v_mfma_f32_32x32x16_bf16 v[144:159], a[196:199], v[60:63], v[144:159]
    v_exp_f32 v4, v30
    v_add_f32 v213, v213, v3
    v_cvt_pk_bf16_f32 v54, v2, v3
    v_exp_f32 v5, v31
    v_mfma_f32_32x32x16_bf16 a[80:95], a[200:203], v[60:63], a[80:95]
    v_add_f32 v213, v213, v4
    v_add_f32 v213, v213, v5
    v_cvt_pk_bf16_f32 v55, v4, v5
    v_cmp_lt_f32 vcc, s56, v213
    v_cvt_pk_bf16_f32 v170, v6, v7
    v_mfma_f32_32x32x16_bf16 a[96:111], a[204:207], v[60:63], a[96:111]
    s_cbranch_vccnz L_stub20
L_back20:
    s_waitcnt lgkmcnt(0)
    s_waitcnt vmcnt(11)
    s_barrier
    v_mfma_f32_32x32x16_bf16 v[16:31], a[144:147], a[0:3], v[224:239]
    ds_read_b64_tr_b16 a[176:177], v192 offset:49152
    ds_read_b64_tr_b16 a[178:179], v192 offset:51200
    ds_read_b64_tr_b16 a[180:181], v193 offset:49152
    v_exp_f32 v2, v32
    v_exp_f32 v9, v167
    v_mfma_f32_32x32x16_bf16 v[16:31], a[148:151], a[4:7], v[16:31]
    ds_read_b64_tr_b16 a[182:183], v193 offset:51200
    ds_read_b64_tr_b16 a[184:185], v194 offset:49152
    ds_read_b64_tr_b16 a[186:187], v194 offset:51200
    v_exp_f32 v3, v33
    v_add_f32 v215, v216, v2
    v_add_f32 v218, v218, v8
    v_mfma_f32_32x32x16_bf16 v[16:31], a[152:155], a[8:11], v[16:31]
    ds_read_b64_tr_b16 a[188:189], v195 offset:49152
    ds_read_b64_tr_b16 a[190:191], v195 offset:51200
    v_exp_f32 v4, v34
    v_add_f32 v215, v215, v3
    v_cvt_pk_bf16_f32 v56, v2, v3
    v_mfma_f32_32x32x16_bf16 v[16:31], a[156:159], a[12:15], v[16:31]
    ds_read_b64_tr_b16 a[192:193], v192 offset:53248
    ds_read_b64_tr_b16 a[194:195], v192 offset:55296
    ds_read_b64_tr_b16 a[196:197], v193 offset:53248
    v_exp_f32 v5, v35
    v_add_f32 v218, v218, v9
    v_cvt_pk_bf16_f32 v171, v8, v9
    v_mfma_f32_32x32x16_bf16 v[16:31], a[160:163], a[16:19], v[16:31]
    ds_read_b64_tr_b16 a[198:199], v193 offset:55296
    ds_read_b64_tr_b16 a[200:201], v194 offset:53248
    ds_read_b64_tr_b16 a[202:203], v194 offset:55296
    v_add_f32 v215, v215, v4
    v_exp_f32 v2, v36
    v_cmp_lt_f32 vcc, s56, v218
    v_mfma_f32_32x32x16_bf16 v[16:31], a[164:167], a[20:23], v[16:31]
    ds_read_b64_tr_b16 a[204:205], v195 offset:53248
    s_waitcnt lgkmcnt(14)
    ds_read_b64_tr_b16 a[206:207], v195 offset:55296
    v_add_f32 v215, v215, v5
    v_cvt_pk_bf16_f32 v57, v4, v5
    v_exp_f32 v3, v37
    v_mfma_f32_32x32x16_bf16 v[16:31], a[168:171], a[24:27], v[16:31]
    v_add_f32 v215, v215, v2
    v_exp_f32 v4, v38
    v_add_f32 v215, v215, v3
    v_cvt_pk_bf16_f32 v58, v2, v3
    v_mfma_f32_32x32x16_bf16 v[16:31], a[172:175], a[28:31], v[16:31]
    s_waitcnt lgkmcnt(8)
    s_cbranch_vccnz L_stub103
L_back103:
    v_mov_b32 v217, v218
    ds_read_b128 a[144:147], v184 offset:49152
    ds_read_b128 a[148:151], v185 offset:49152
    v_exp_f32 v5, v39
    v_add_f32 v215, v215, v4
    v_mfma_f32_32x32x16_bf16 v[64:79], a[176:179], v[48:51], v[64:79]
    ds_read_b128 a[152:155], v186 offset:49152
    v_exp_f32 v2, v40
    v_add_f32 v215, v215, v5
    v_cvt_pk_bf16_f32 v59, v4, v5
    v_mfma_f32_32x32x16_bf16 v[80:95], a[180:183], v[48:51], v[80:95]
    ds_read_b128 a[156:159], v187 offset:49152
    v_exp_f32 v3, v41
    v_add_f32 v215, v215, v2
    v_exp_f32 v4, v42
    v_mfma_f32_32x32x16_bf16 v[96:111], a[184:187], v[48:51], v[96:111]
    ds_read_b128 a[160:163], v188 offset:49152
    ds_read_b128 a[164:167], v189 offset:49152
    v_add_f32 v215, v215, v3
    v_cvt_pk_bf16_f32 v60, v2, v3
    v_exp_f32 v5, v43
    v_mfma_f32_32x32x16_bf16 v[112:127], a[188:191], v[48:51], v[112:127]
    s_waitcnt lgkmcnt(6)
    ds_read_b128 a[168:171], v190 offset:49152
    v_add_f32 v215, v215, v4
    v_exp_f32 v2, v44
    v_mfma_f32_32x32x16_bf16 v[64:79], a[192:195], v[52:55], v[64:79]
    ds_read_b128 a[172:175], v191 offset:49152
    v_add_f32 v215, v215, v5
    v_cvt_pk_bf16_f32 v61, v4, v5
    v_exp_f32 v3, v45
    v_add_f32 v215, v215, v2
    v_mfma_f32_32x32x16_bf16 v[80:95], a[196:199], v[52:55], v[80:95]
    v_exp_f32 v4, v46
    v_add_f32 v215, v215, v3
    v_cvt_pk_bf16_f32 v62, v2, v3
    v_mfma_f32_32x32x16_bf16 v[96:111], a[200:203], v[52:55], v[96:111]
    v_exp_f32 v5, v47
    v_add_f32 v215, v215, v4
    v_add_f32 v215, v215, v5
    v_cvt_pk_bf16_f32 v63, v4, v5
    v_cmp_lt_f32 vcc, s56, v215
    v_mfma_f32_32x32x16_bf16 v[112:127], a[204:207], v[52:55], v[112:127]
    s_cbranch_vccnz L_stub21
L_back21:
    s_waitcnt lgkmcnt(0)
    s_barrier
    v_mfma_f32_32x32x16_bf16 v[32:47], a[144:147], a[0:3], v[224:239]
    v_exp_f32 v2, v16
    v_exp_f32 v3, v17
    v_lshlrev_b32 v8, 4, v1
    s_add_u32 s44, s70, 32768
    v_mfma_f32_32x32x16_bf16 v[32:47], a[148:151], a[4:7], v[32:47]
    v_add_f32 v214, v213, v2
    v_exp_f32 v4, v18
    v_add_f32 v214, v214, v3
    v_add_u32 v184, s44, v8
    s_lshl_b32 s45, s42, 10
    s_add_u32 s45, s45, 90112
    v_mfma_f32_32x32x16_bf16 v[32:47], a[152:155], a[8:11], v[32:47]
    v_cvt_pk_bf16_f32 v48, v2, v3
    v_exp_f32 v5, v19
    v_add_f32 v214, v214, v4
    v_add_u32 v185, s45, v8
    v_mov_b32 v188, v240
    v_mfma_f32_32x32x16_bf16 v[32:47], a[156:159], a[12:15], v[32:47]
    ds_read_b64_tr_b16 a[208:209], v204 offset:32768
    ds_read_b64_tr_b16 a[210:211], v204 offset:36864
    v_exp_f32 v2, v20
    v_add_f32 v214, v214, v5
    v_mov_b32 v189, v215
    v_mfma_f32_32x32x16_bf16 v[32:47], a[160:163], a[16:19], v[32:47]
    ds_read_b64_tr_b16 a[212:213], v204 offset:32784
    ds_read_b64_tr_b16 a[214:215], v204 offset:36880
    v_cvt_pk_bf16_f32 v49, v4, v5
    v_exp_f32 v3, v21
    v_mov_b32 v190, v172
    v_mov_b32 v191, v217
    v_mfma_f32_32x32x16_bf16 v[32:47], a[164:167], a[20:23], v[32:47]
    ds_read_b64_tr_b16 a[216:217], v205 offset:32768
    ds_read_b64_tr_b16 a[218:219], v205 offset:36864
    v_add_f32 v214, v214, v2
    v_exp_f32 v4, v22
    v_mov_b32 v178, v240
    v_mfma_f32_32x32x16_bf16 v[32:47], a[168:171], a[24:27], v[32:47]
    ds_read_b64_tr_b16 a[220:221], v205 offset:32784
    ds_read_b64_tr_b16 a[222:223], v205 offset:36880
    v_add_f32 v214, v214, v3
    v_cvt_pk_bf16_f32 v50, v2, v3
    s_xor_b32 s46, s42, 1
    s_mul_i32 s46, s46, 6144
    v_mfma_f32_32x32x16_bf16 v[32:47], a[172:175], a[28:31], v[32:47]
    ds_read_b64_tr_b16 a[144:145], v196 offset:32768
    ds_read_b64_tr_b16 a[146:147], v196 offset:34816
    v_exp_f32 v5, v23
    v_add_f32 v214, v214, v4
    s_add_u32 s46, s46, 65536
    v_add_u32 v200, s46, v8
    v_mfma_f32_32x32x16_bf16 v[128:143], a[176:179], v[56:59], v[128:143]
    ds_read_b64_tr_b16 a[148:149], v197 offset:32768
    v_exp_f32 v2, v24
    v_add_f32 v214, v214, v5
    s_xor_b32 s46, s42, 2
    s_mul_i32 s46, s46, 6144
    s_waitcnt lgkmcnt(9)
    v_mfma_f32_16x16x32_bf16 a[112:115], a[208:211], v[168:171], a[112:115]
    ds_read_b64_tr_b16 a[150:151], v197 offset:34816
    ds_read_b64_tr_b16 a[208:209], v206 offset:32768
    ds_read_b64_tr_b16 a[210:211], v206 offset:36864
    v_cvt_pk_bf16_f32 v51, v4, v5
    v_mfma_f32_32x32x16_bf16 v[144:159], a[180:183], v[56:59], v[144:159]
    ds_read_b64_tr_b16 a[152:153], v198 offset:32768
    v_exp_f32 v3, v25
    v_add_f32 v214, v214, v2
    s_add_u32 s46, s46, 67584
    v_add_u32 v201, s46, v8
    s_waitcnt lgkmcnt(11)
    v_mfma_f32_16x16x32_bf16 a[116:119], a[212:215], v[168:171], a[116:119]
    ds_read_b64_tr_b16 a[154:155], v198 offset:34816
    ds_read_b64_tr_b16 a[212:213], v206 offset:32784
    ds_read_b64_tr_b16 a[214:215], v206 offset:36880
    s_xor_b32 s46, s42, 3
    v_mfma_f32_32x32x16_bf16 a[80:95], a[184:187], v[56:59], a[80:95]
    ds_read_b64_tr_b16 a[156:157], v199 offset:32768
    v_exp_f32 v4, v26
    v_add_f32 v214, v214, v3
    v_cvt_pk_bf16_f32 v52, v2, v3
    s_mul_i32 s46, s46, 6144
    s_waitcnt lgkmcnt(13)
    v_mfma_f32_16x16x32_bf16 a[120:123], a[216:219], v[168:171], a[120:123]
    ds_read_b64_tr_b16 a[158:159], v199 offset:34816
    ds_read_b64_tr_b16 a[216:217], v207 offset:32768
    s_waitcnt lgkmcnt(14)
    ds_read_b64_tr_b16 a[218:219], v207 offset:36864
    v_mfma_f32_32x32x16_bf16 a[96:111], a[188:191], v[56:59], a[96:111]
    s_waitcnt lgkmcnt(14)
    ds_read_b64_tr_b16 a[160:161], v196 offset:36864
    s_waitcnt lgkmcnt(14)
    ds_read_b64_tr_b16 a[162:163], v196 offset:38912
    v_exp_f32 v5, v27
    s_add_u32 s46, s46, 69632
    v_add_u32 v202, s46, v8
    v_bfe_u32 v179, v1, 4, 1
    v_mfma_f32_16x16x32_bf16 a[124:127], a[220:223], v[168:171], a[124:127]
    s_waitcnt lgkmcnt(14)
    ds_read_b64_tr_b16 a[164:165], v197 offset:36864
    s_waitcnt lgkmcnt(14)
    ds_read_b64_tr_b16 a[220:221], v207 offset:32784
    s_waitcnt lgkmcnt(14)
    ds_read_b64_tr_b16 a[222:223], v207 offset:36880
    v_add_f32 v214, v214, v4
    v_mfma_f32_32x32x16_bf16 v[128:143], a[192:195], v[60:63], v[128:143]
    s_waitcnt lgkmcnt(14)
    ds_read_b64_tr_b16 a[166:167], v197 offset:38912
    v_exp_f32 v2, v28
    v_add_f32 v214, v214, v5
    v_lshlrev_b32 v176, 15, v179
    v_lshrrev_b32 v179, 5, v1
    s_waitcnt lgkmcnt(14)
    v_mfma_f32_16x16x32_bf16 a[128:131], a[208:211], v[168:171], a[128:131]
    ds_read_b64_tr_b16 a[168:169], v198 offset:36864
    v_cvt_pk_bf16_f32 v53, v4, v5
    v_mfma_f32_32x32x16_bf16 v[144:159], a[196:199], v[60:63], v[144:159]
    s_waitcnt lgkmcnt(14)
    ds_read_b64_tr_b16 a[170:171], v198 offset:38912
    v_exp_f32 v3, v29
    v_add_f32 v214, v214, v2
    v_lshl_add_u32 v176, v179, 8, v176
    v_and_b32 v179, 15, v1
    v_lshl_add_u32 v176, v179, 4, v176
    s_waitcnt lgkmcnt(12)
    v_mfma_f32_16x16x32_bf16 a[132:135], a[212:215], v[168:171], a[132:135]
    ds_read_b64_tr_b16 a[172:173], v199 offset:36864
    v_exp_f32 v4, v30
    v_mfma_f32_32x32x16_bf16 a[80:95], a[200:203], v[60:63], a[80:95]
    ds_read_b64_tr_b16 a[174:175], v199 offset:38912
    v_add_f32 v214, v214, v3
    v_cvt_pk_bf16_f32 v54, v2, v3
    s_lshr_b32 s44, s42, 1
    s_add_u32 s44, s44, 4
    s_lshl_b32 s44, s44, 16
    s_waitcnt lgkmcnt(10)
    v_mfma_f32_16x16x32_bf16 a[136:139], a[216:219], v[168:171], a[136:139]
    v_exp_f32 v5, v31
    v_add_u32 v177, s44, v176
    v_mfma_f32_32x32x16_bf16 a[96:111], a[204:207], v[60:63], a[96:111]
    v_add_f32 v214, v214, v4
    v_add_f32 v214, v214, v5
    v_cvt_pk_bf16_f32 v55, v4, v5
    v_cmp_lt_f32 vcc, s56, v214
    s_lshl_b32 s44, s42, 16
    v_add_u32 v176, s44, v176
    s_waitcnt lgkmcnt(5)
    v_mfma_f32_16x16x32_bf16 a[140:143], a[220:223], v[168:171], a[140:143]
    s_cbranch_vccnz L_stub22
L_back22:
    v_mfma_f32_32x32x16_bf16 v[64:79], a[144:147], v[48:51], v[64:79]
    ds_read_b64_tr_b16 a[176:177], v196 offset:49152
    ds_read_b64_tr_b16 a[178:179], v196 offset:51200
    ds_read_b64_tr_b16 a[180:181], v196 offset:53248
    ds_read_b64_tr_b16 a[182:183], v196 offset:55296
    v_exp_f32 v2, v32
    v_exp_f32 v3, v33
    v_add_f32 v213, v214, v2
    v_exp_f32 v4, v34
    v_add_f32 v213, v213, v3
    v_cvt_pk_bf16_f32 v56, v2, v3
    v_exp_f32 v5, v35
    v_add_f32 v213, v213, v4
    v_exp_f32 v2, v36
    v_mfma_f32_32x32x16_bf16 v[80:95], a[148:151], v[48:51], v[80:95]
    ds_read_b64_tr_b16 a[184:185], v197 offset:49152
    ds_read_b64_tr_b16 a[186:187], v197 offset:51200
    ds_read_b64_tr_b16 a[188:189], v197 offset:53248
    ds_read_b64_tr_b16 a[190:191], v197 offset:55296
    ds_write_b128 v185, v[188:191]
    ds_write_b128 v184, a[80:83]
    s_waitcnt lgkmcnt(14)
    ds_write_b128 v184, a[84:87] offset:1024
    v_add_f32 v213, v213, v5
    v_mfma_f32_32x32x16_bf16 v[96:111], a[152:155], v[48:51], v[96:111]
    s_waitcnt lgkmcnt(14)
    ds_read_b64_tr_b16 a[192:193], v198 offset:49152
    s_waitcnt lgkmcnt(14)
    ds_read_b64_tr_b16 a[194:195], v198 offset:51200
    s_waitcnt lgkmcnt(14)
    ds_read_b64_tr_b16 a[196:197], v198 offset:53248
    s_waitcnt lgkmcnt(14)
    ds_read_b64_tr_b16 a[198:199], v198 offset:55296
    s_waitcnt lgkmcnt(14)
    ds_write_b128 v184, a[88:91] offset:2048
    s_waitcnt lgkmcnt(14)
    ds_write_b128 v184, a[92:95] offset:3072
    v_cvt_pk_bf16_f32 v57, v4, v5
    v_mfma_f32_32x32x16_bf16 v[112:127], a[156:159], v[48:51], v[112:127]
    s_waitcnt lgkmcnt(14)
    ds_read_b64_tr_b16 a[200:201], v199 offset:49152
    s_waitcnt lgkmcnt(14)
    ds_read_b64_tr_b16 a[202:203], v199 offset:51200
    s_waitcnt lgkmcnt(14)
    ds_read_b64_tr_b16 a[204:205], v199 offset:53248
    s_waitcnt lgkmcnt(14)
    ds_read_b64_tr_b16 a[206:207], v199 offset:55296
    s_waitcnt lgkmcnt(14)
    ds_write_b128 v184, a[96:99] offset:4096
    s_waitcnt lgkmcnt(14)
    ds_write_b128 v184, a[100:103] offset:5120
    v_exp_f32 v3, v37
    v_mfma_f32_32x32x16_bf16 v[64:79], a[160:163], v[52:55], v[64:79]
    s_waitcnt lgkmcnt(14)
    ds_write_b128 v184, a[104:107] offset:6144
    s_waitcnt lgkmcnt(14)
    ds_write_b128 v184, a[108:111] offset:7168
    v_add_f32 v213, v213, v2
    v_exp_f32 v4, v38
    v_add_f32 v213, v213, v3
    v_cvt_pk_bf16_f32 v58, v2, v3
    v_exp_f32 v5, v39
    v_add_f32 v213, v213, v4
    v_exp_f32 v2, v40
    v_add_f32 v213, v213, v5
    v_cvt_pk_bf16_f32 v59, v4, v5
    v_mfma_f32_32x32x16_bf16 v[80:95], a[164:167], v[52:55], v[80:95]
    s_waitcnt lgkmcnt(14)
    ds_write_b128 v200, a[120:123]
    s_waitcnt lgkmcnt(14)
    ds_write_b128 v200, a[124:127] offset:1024
    v_exp_f32 v3, v41
    v_add_f32 v213, v213, v2
    v_exp_f32 v4, v42
    v_add_f32 v213, v213, v3
    v_cvt_pk_bf16_f32 v60, v2, v3
    v_exp_f32 v5, v43
    v_add_f32 v213, v213, v4
    v_exp_f32 v2, v44
    v_add_f32 v213, v213, v5
    v_cvt_pk_bf16_f32 v61, v4, v5
    v_mfma_f32_32x32x16_bf16 v[96:111], a[168:171], v[52:55], v[96:111]
    s_waitcnt lgkmcnt(14)
    ds_write_b128 v201, a[128:131]
    s_waitcnt lgkmcnt(14)
    ds_write_b128 v201, a[132:135] offset:1024
    v_exp_f32 v3, v45
    v_add_f32 v213, v213, v2
    v_exp_f32 v4, v46
    v_add_f32 v213, v213, v3
    v_cvt_pk_bf16_f32 v62, v2, v3
    v_exp_f32 v5, v47
    v_add_f32 v213, v213, v4
    v_add_f32 v213, v213, v5
    v_cvt_pk_bf16_f32 v63, v4, v5
    v_cmp_lt_f32 vcc, s56, v213
    v_mfma_f32_32x32x16_bf16 v[112:127], a[172:175], v[52:55], v[112:127]
    s_waitcnt lgkmcnt(14)
    ds_write_b128 v202, a[136:139]
    s_waitcnt lgkmcnt(14)
    ds_write_b128 v202, a[140:143] offset:1024
    s_cbranch_vccnz L_stub23
L_back23:
    s_waitcnt lgkmcnt(0)
    s_barrier
    v_xor_b32 v184, 8192, v184
    v_xor_b32 v200, 1024, v185
    v_xor_b32 v201, 2048, v185
    v_xor_b32 v202, 3072, v185
    s_mul_i32 s46, s42, 6144
    s_add_u32 s46, s46, 65536
    v_add_u32 v186, s46, v8
    v_mfma_f32_32x32x16_bf16 v[64:79], a[176:179], v[56:59], v[64:79]
    ds_read_b128 v[40:43], v200
    ds_read_b128 v[44:47], v201
    ds_read_b128 v[48:51], v202
    ds_read_b128 v[224:227], v184
    v_mfma_f32_32x32x16_bf16 v[64:79], a[180:183], v[60:63], v[64:79]
    ds_read_b128 v[228:231], v184 offset:1024
    ds_read_b128 v[232:235], v184 offset:2048
    ds_read_b128 v[236:239], v184 offset:3072
    v_mov_b32 v14, v213
    v_mov_b32 v15, v14
    v_mfma_f32_32x32x16_bf16 v[80:95], a[184:187], v[56:59], v[80:95]
    ds_read_b128 v[240:243], v184 offset:4096
    ds_read_b128 v[244:247], v184 offset:5120
    ds_read_b128 v[248:251], v184 offset:6144
    ds_read_b128 v[252:255], v184 offset:7168
    v_permlane32_swap_b32 v14, v15
    v_add_f32 v14, v14, v15
    v_mfma_f32_32x32x16_bf16 v[80:95], a[188:191], v[60:63], v[80:95]
    ds_read_b128 v[16:19], v186
    ds_read_b128 v[20:23], v186 offset:1024
    ds_read_b128 v[24:27], v186 offset:2048
    v_rcp_f32 v14, v14
    v_mfma_f32_32x32x16_bf16 v[96:111], a[192:195], v[56:59], v[96:111]
    ds_read_b128 v[28:31], v186 offset:3072
    s_waitcnt lgkmcnt(14)
    ds_read_b128 v[32:35], v186 offset:4096
    s_waitcnt lgkmcnt(14)
    ds_read_b128 v[36:39], v186 offset:5120
    v_min_f32 v2, v178, v40
    v_sub_f32 v3, v2, v178
    v_mfma_f32_32x32x16_bf16 v[96:111], a[196:199], v[60:63], v[96:111]
    v_exp_f32 v3, v3
    v_sub_f32 v4, v2, v40
    v_exp_f32 v4, v4
    v_mfma_f32_32x32x16_bf16 v[112:127], a[200:203], v[56:59], v[112:127]
    v_mul_f32 v5, v3, v215
    v_fma_f32 v5, v4, v41, v5
    v_mov_b32 v15, v5
    s_nop 1
    v_permlane32_swap_b32 v5, v15
    v_add_f32 v5, v5, v15
    v_mfma_f32_32x32x16_bf16 v[112:127], a[204:207], v[60:63], v[112:127]
    v_rcp_f32 v5, v5
    s_nop 0
    v_mul_f32 v3, v3, v5
    v_mul_f32 v4, v4, v5
    v_pk_mul_f32 v[128:129], v[128:129], v[2:3] op_sel:[0,1] op_sel_hi:[1,1]
    s_waitcnt lgkmcnt(13)
    v_pk_fma_f32 v[128:129], v[224:225], v[4:5], v[128:129] op_sel_hi:[1,0,1]
    v_pk_mul_f32 v[130:131], v[130:131], v[2:3] op_sel:[0,1] op_sel_hi:[1,1]
    v_pk_fma_f32 v[130:131], v[226:227], v[4:5], v[130:131] op_sel_hi:[1,0,1]
    v_pk_mul_f32 v[132:133], v[132:133], v[2:3] op_sel:[0,1] op_sel_hi:[1,1]
    s_waitcnt lgkmcnt(12)
    v_pk_fma_f32 v[132:133], v[228:229], v[4:5], v[132:133] op_sel_hi:[1,0,1]
    v_pk_mul_f32 v[134:135], v[134:135], v[2:3] op_sel:[0,1] op_sel_hi:[1,1]
    v_pk_fma_f32 v[134:135], v[230:231], v[4:5], v[134:135] op_sel_hi:[1,0,1]
    v_cvt_pk_bf16_f32 v128, v128, v129
    v_cvt_pk_bf16_f32 v129, v130, v131
    v_cvt_pk_bf16_f32 v130, v132, v133
    v_cvt_pk_bf16_f32 v131, v134, v135
    buffer_store_dwordx4 v[128:131], v177, s[36:39], s60 offen sc1
    v_pk_mul_f32 v[136:137], v[136:137], v[2:3] op_sel:[0,1] op_sel_hi:[1,1]
    s_waitcnt lgkmcnt(11)
    v_pk_fma_f32 v[136:137], v[232:233], v[4:5], v[136:137] op_sel_hi:[1,0,1]
    v_pk_mul_f32 v[138:139], v[138:139], v[2:3] op_sel:[0,1] op_sel_hi:[1,1]
    v_pk_fma_f32 v[138:139], v[234:235], v[4:5], v[138:139] op_sel_hi:[1,0,1]
    v_pk_mul_f32 v[140:141], v[140:141], v[2:3] op_sel:[0,1] op_sel_hi:[1,1]
    s_waitcnt lgkmcnt(10)
    v_pk_fma_f32 v[140:141], v[236:237], v[4:5], v[140:141] op_sel_hi:[1,0,1]
    v_pk_mul_f32 v[142:143], v[142:143], v[2:3] op_sel:[0,1] op_sel_hi:[1,1]
    v_pk_fma_f32 v[142:143], v[238:239], v[4:5], v[142:143] op_sel_hi:[1,0,1]
    v_cvt_pk_bf16_f32 v136, v136, v137
    v_cvt_pk_bf16_f32 v137, v138, v139
    v_cvt_pk_bf16_f32 v138, v140, v141
    v_cvt_pk_bf16_f32 v139, v142, v143
    buffer_store_dwordx4 v[136:139], v177, s[36:39], s60 offen offset:512 sc1
    v_pk_mul_f32 v[144:145], v[144:145], v[2:3] op_sel:[0,1] op_sel_hi:[1,1]
    s_waitcnt lgkmcnt(9)
    v_pk_fma_f32 v[144:145], v[240:241], v[4:5], v[144:145] op_sel_hi:[1,0,1]
    v_pk_mul_f32 v[146:147], v[146:147], v[2:3] op_sel:[0,1] op_sel_hi:[1,1]
    v_pk_fma_f32 v[146:147], v[242:243], v[4:5], v[146:147] op_sel_hi:[1,0,1]
    v_pk_mul_f32 v[148:149], v[148:149], v[2:3] op_sel:[0,1] op_sel_hi:[1,1]
    s_waitcnt lgkmcnt(8)
    v_pk_fma_f32 v[148:149], v[244:245], v[4:5], v[148:149] op_sel_hi:[1,0,1]
    v_pk_mul_f32 v[150:151], v[150:151], v[2:3] op_sel:[0,1] op_sel_hi:[1,1]
    v_pk_fma_f32 v[150:151], v[246:247], v[4:5], v[150:151] op_sel_hi:[1,0,1]
    v_cvt_pk_bf16_f32 v144, v144, v145
    v_cvt_pk_bf16_f32 v145, v146, v147
    v_cvt_pk_bf16_f32 v146, v148, v149
    v_cvt_pk_bf16_f32 v147, v150, v151
    buffer_store_dwordx4 v[144:147], v177, s[36:39], s60 offen offset:1024 sc1
    v_pk_mul_f32 v[152:153], v[152:153], v[2:3] op_sel:[0,1] op_sel_hi:[1,1]
    s_waitcnt lgkmcnt(7)
    v_pk_fma_f32 v[152:153], v[248:249], v[4:5], v[152:153] op_sel_hi:[1,0,1]
    v_pk_mul_f32 v[154:155], v[154:155], v[2:3] op_sel:[0,1] op_sel_hi:[1,1]
    v_pk_fma_f32 v[154:155], v[250:251], v[4:5], v[154:155] op_sel_hi:[1,0,1]
    v_pk_mul_f32 v[156:157], v[156:157], v[2:3] op_sel:[0,1] op_sel_hi:[1,1]
    s_waitcnt lgkmcnt(6)
    v_pk_fma_f32 v[156:157], v[252:253], v[4:5], v[156:157] op_sel_hi:[1,0,1]
    v_pk_mul_f32 v[158:159], v[158:159], v[2:3] op_sel:[0,1] op_sel_hi:[1,1]
    v_pk_fma_f32 v[158:159], v[254:255], v[4:5], v[158:159] op_sel_hi:[1,0,1]
    v_cvt_pk_bf16_f32 v152, v152, v153
    v_cvt_pk_bf16_f32 v153, v154, v155
    v_cvt_pk_bf16_f32 v154, v156, v157
    v_cvt_pk_bf16_f32 v155, v158, v159
    buffer_store_dwordx4 v[152:155], v177, s[36:39], s60 offen offset:1536 sc1
    v_pk_mul_f32 v[64:65], v[64:65], v[14:15] op_sel_hi:[1,0]
    v_cvt_pk_bf16_f32 v64, v64, v65
    v_pk_mul_f32 v[66:67], v[66:67], v[14:15] op_sel_hi:[1,0]
    v_cvt_pk_bf16_f32 v65, v66, v67
    v_pk_mul_f32 v[68:69], v[68:69], v[14:15] op_sel_hi:[1,0]
    v_cvt_pk_bf16_f32 v66, v68, v69
    v_pk_mul_f32 v[70:71], v[70:71], v[14:15] op_sel_hi:[1,0]
    v_cvt_pk_bf16_f32 v67, v70, v71
    buffer_store_dwordx4 v[64:67], v176, s[36:39], s60 offen sc1
    v_pk_mul_f32 v[72:73], v[72:73], v[14:15] op_sel_hi:[1,0]
    v_cvt_pk_bf16_f32 v72, v72, v73
    v_pk_mul_f32 v[74:75], v[74:75], v[14:15] op_sel_hi:[1,0]
    v_cvt_pk_bf16_f32 v73, v74, v75
    v_pk_mul_f32 v[76:77], v[76:77], v[14:15] op_sel_hi:[1,0]
    v_cvt_pk_bf16_f32 v74, v76, v77
    v_pk_mul_f32 v[78:79], v[78:79], v[14:15] op_sel_hi:[1,0]
    v_cvt_pk_bf16_f32 v75, v78, v79
    buffer_store_dwordx4 v[72:75], v176, s[36:39], s60 offen offset:512 sc1
    v_pk_mul_f32 v[80:81], v[80:81], v[14:15] op_sel_hi:[1,0]
    v_cvt_pk_bf16_f32 v80, v80, v81
    v_pk_mul_f32 v[82:83], v[82:83], v[14:15] op_sel_hi:[1,0]
    v_cvt_pk_bf16_f32 v81, v82, v83
    v_pk_mul_f32 v[84:85], v[84:85], v[14:15] op_sel_hi:[1,0]
    v_cvt_pk_bf16_f32 v82, v84, v85
    v_pk_mul_f32 v[86:87], v[86:87], v[14:15] op_sel_hi:[1,0]
    v_cvt_pk_bf16_f32 v83, v86, v87
    buffer_store_dwordx4 v[80:83], v176, s[36:39], s60 offen offset:1024 sc1
    v_pk_mul_f32 v[88:89], v[88:89], v[14:15] op_sel_hi:[1,0]
    v_cvt_pk_bf16_f32 v88, v88, v89
    v_pk_mul_f32 v[90:91], v[90:91], v[14:15] op_sel_hi:[1,0]
    v_cvt_pk_bf16_f32 v89, v90, v91
    v_pk_mul_f32 v[92:93], v[92:93], v[14:15] op_sel_hi:[1,0]
    v_cvt_pk_bf16_f32 v90, v92, v93
    v_pk_mul_f32 v[94:95], v[94:95], v[14:15] op_sel_hi:[1,0]
    v_cvt_pk_bf16_f32 v91, v94, v95
    buffer_store_dwordx4 v[88:91], v176, s[36:39], s60 offen offset:1536 sc1
    v_pk_mul_f32 v[96:97], v[96:97], v[14:15] op_sel_hi:[1,0]
    v_cvt_pk_bf16_f32 v96, v96, v97
    v_pk_mul_f32 v[98:99], v[98:99], v[14:15] op_sel_hi:[1,0]
    v_cvt_pk_bf16_f32 v97, v98, v99
    v_pk_mul_f32 v[100:101], v[100:101], v[14:15] op_sel_hi:[1,0]
    v_cvt_pk_bf16_f32 v98, v100, v101
    v_pk_mul_f32 v[102:103], v[102:103], v[14:15] op_sel_hi:[1,0]
    v_cvt_pk_bf16_f32 v99, v102, v103
    buffer_store_dwordx4 v[96:99], v176, s[36:39], s61 offen sc1
    v_pk_mul_f32 v[104:105], v[104:105], v[14:15] op_sel_hi:[1,0]
    v_cvt_pk_bf16_f32 v104, v104, v105
    v_pk_mul_f32 v[106:107], v[106:107], v[14:15] op_sel_hi:[1,0]
    v_cvt_pk_bf16_f32 v105, v106, v107
    v_pk_mul_f32 v[108:109], v[108:109], v[14:15] op_sel_hi:[1,0]
    v_cvt_pk_bf16_f32 v106, v108, v109
    v_pk_mul_f32 v[110:111], v[110:111], v[14:15] op_sel_hi:[1,0]
    v_cvt_pk_bf16_f32 v107, v110, v111
    buffer_store_dwordx4 v[104:107], v176, s[36:39], s61 offen offset:512 sc1
    v_pk_mul_f32 v[112:113], v[112:113], v[14:15] op_sel_hi:[1,0]
    v_cvt_pk_bf16_f32 v112, v112, v113
    v_pk_mul_f32 v[114:115], v[114:115], v[14:15] op_sel_hi:[1,0]
    v_cvt_pk_bf16_f32 v113, v114, v115
    v_pk_mul_f32 v[116:117], v[116:117], v[14:15] op_sel_hi:[1,0]
    v_cvt_pk_bf16_f32 v114, v116, v117
    v_pk_mul_f32 v[118:119], v[118:119], v[14:15] op_sel_hi:[1,0]
    v_cvt_pk_bf16_f32 v115, v118, v119
    buffer_store_dwordx4 v[112:115], v176, s[36:39], s61 offen offset:1024 sc1
    v_pk_mul_f32 v[120:121], v[120:121], v[14:15] op_sel_hi:[1,0]
    v_cvt_pk_bf16_f32 v120, v120, v121
    v_pk_mul_f32 v[122:123], v[122:123], v[14:15] op_sel_hi:[1,0]
    v_cvt_pk_bf16_f32 v121, v122, v123
    v_pk_mul_f32 v[124:125], v[124:125], v[14:15] op_sel_hi:[1,0]
    v_cvt_pk_bf16_f32 v122, v124, v125
    v_pk_mul_f32 v[126:127], v[126:127], v[14:15] op_sel_hi:[1,0]
    v_cvt_pk_bf16_f32 v123, v126, v127
    buffer_store_dwordx4 v[120:123], v176, s[36:39], s61 offen offset:1536 sc1
    v_min3_f32 v2, v172, v42, v46
    v_min_f32 v2, v2, v50
    v_sub_f32 v6, v2, v172
    v_exp_f32 v6, v6
    v_sub_f32 v7, v2, v42
    v_exp_f32 v7, v7
    v_sub_f32 v218, v2, v46
    v_exp_f32 v218, v218
    v_sub_f32 v216, v2, v50
    v_exp_f32 v216, v216
    v_mul_f32 v5, v6, v217
    v_fma_f32 v5, v7, v43, v5
    v_fma_f32 v5, v218, v47, v5
    v_fma_f32 v5, v216, v51, v5
    ds_bpermute_b32 v15, v219, v5
    s_waitcnt lgkmcnt(0)
    v_add_f32 v5, v5, v15
    v_mov_b32 v15, v5
    s_nop 1
    v_permlane32_swap_b32 v5, v15
    v_add_f32 v5, v5, v15
    v_rcp_f32 v5, v5
    s_nop 0
    v_mul_f32 v6, v6, v5
    v_mul_f32 v7, v7, v5
    v_mul_f32 v218, v218, v5
    v_mul_f32 v216, v216, v5
    v_accvgpr_read_b32 v160, a112
    v_accvgpr_read_b32 v161, a113
    v_accvgpr_read_b32 v162, a114
    v_accvgpr_read_b32 v163, a115
    v_accvgpr_read_b32 v164, a116
    v_accvgpr_read_b32 v165, a117
    v_accvgpr_read_b32 v166, a118
    v_accvgpr_read_b32 v167, a119
    v_mul_f32 v160, v6, v160
    v_fma_f32 v160, v7, v16, v160
    v_fma_f32 v160, v218, v24, v160
    v_fma_f32 v160, v216, v32, v160
    v_mul_f32 v161, v6, v161
    v_fma_f32 v161, v7, v17, v161
    v_fma_f32 v161, v218, v25, v161
    v_fma_f32 v161, v216, v33, v161
    v_mul_f32 v162, v6, v162
    v_fma_f32 v162, v7, v18, v162
    v_fma_f32 v162, v218, v26, v162
    v_fma_f32 v162, v216, v34, v162
    v_mul_f32 v163, v6, v163
    v_fma_f32 v163, v7, v19, v163
    v_fma_f32 v163, v218, v27, v163
    v_fma_f32 v163, v216, v35, v163
    v_mul_f32 v164, v6, v164
    v_fma_f32 v164, v7, v20, v164
    v_fma_f32 v164, v218, v28, v164
    v_fma_f32 v164, v216, v36, v164
    v_mul_f32 v165, v6, v165
    v_fma_f32 v165, v7, v21, v165
    v_fma_f32 v165, v218, v29, v165
    v_fma_f32 v165, v216, v37, v165
    v_mul_f32 v166, v6, v166
    v_fma_f32 v166, v7, v22, v166
    v_fma_f32 v166, v218, v30, v166
    v_fma_f32 v166, v216, v38, v166
    v_mul_f32 v167, v6, v167
    v_fma_f32 v167, v7, v23, v167
    v_fma_f32 v167, v218, v31, v167
    v_fma_f32 v167, v216, v39, v167
    v_cvt_pk_bf16_f32 v160, v160, v161
    v_cvt_pk_bf16_f32 v161, v162, v163
    v_cvt_pk_bf16_f32 v162, v164, v165
    v_cvt_pk_bf16_f32 v163, v166, v167
    s_lshl_b32 s44, s42, 10
    s_add_u32 s44, s44, 393216
    buffer_store_dwordx4 v[160:163], v8, s[36:39], s44 offen sc1
    v_mov_b32 v10, 0
    s_lshl_b32 s44, s40, 4
    buffer_load_dwordx4 v[152:155], v10, s[4:7], s44 offen sc1
    v_lshrrev_b32 v9, 4, v1
    v_bfe_u32 v10, v1, 2, 2
    v_and_b32 v11, 3, v1
    v_lshrrev_b32 v12, 1, v9
    v_lshlrev_b32 v12, 4, v12
    v_and_b32 v13, 1, v9
    v_lshl_add_u32 v12, v13, 2, v12
    v_add_u32 v12, v12, v10
    v_bfe_u32 v13, v12, 1, 2
    v_xor_b32 v13, s66, v13
    v_lshlrev_b32 v12, 7, v12
    v_lshl_add_u32 v12, v11, 3, v12
    v_add_u32 v12, s54, v12
    v_xor_b32 v14, 0, v13
    v_lshl_add_u32 v128, v14, 5, v12
    v_xor_b32 v14, 1, v13
    v_lshl_add_u32 v129, v14, 5, v12
    v_xor_b32 v14, 2, v13
    v_lshl_add_u32 v130, v14, 5, v12
    v_xor_b32 v14, 3, v13
    v_lshl_add_u32 v131, v14, 5, v12
    v_xor_b32 v132, 4096, v128
    v_xor_b32 v133, 4096, v129
    v_xor_b32 v134, 4096, v130
    v_xor_b32 v135, 4096, v131
    v_xor_b32 v136, 8192, v128
    v_xor_b32 v137, 8192, v129
    v_xor_b32 v138, 8192, v130
    v_xor_b32 v139, 8192, v131
    v_xor_b32 v140, 12288, v128
    v_xor_b32 v141, 12288, v129
    v_xor_b32 v142, 12288, v130
    v_xor_b32 v143, 12288, v131
    s_xor_b32 s48, s42, 0
    s_lshl_b32 s48, s48, 10
    s_xor_b32 s49, s42, 1
    s_lshl_b32 s49, s49, 10
    s_xor_b32 s50, s42, 2
    s_lshl_b32 s50, s50, 10
    s_xor_b32 s51, s42, 3
    s_lshl_b32 s51, s51, 10
    s_mul_i32 s44, s42, 98304
    v_add_u32 v144, s44, v8
    v_add_u32 v145, 32768, v144
    v_add_u32 v146, 65536, v144
    v_add_u32 v147, 393216, v8
    s_getreg_b32 s52, hwreg(HW_REG_XCC_ID)
    s_and_b32 s52, s52, 15
    s_lshl_b32 s52, s52, 8
    s_mov_b32 s28, s14
    s_and_b32 s29, s15, 0xffff
    s_mov_b32 s30, 1703936
    s_mov_b32 s31, 0x20000
    s_add_u32 s32, s18, 20971520
    s_addc_u32 s33, s19, 0
    s_and_b32 s33, s33, 0xffff
    s_mov_b32 s34, 6291456
    s_mov_b32 s35, 0x20000
    s_lshl_b32 s44, s42, 11
    v_add_u32 v156, s44, v8
    v_add_u32 v112, 131072, v128
    v_add_u32 v113, 131072, v129
    v_add_u32 v114, 131072, v130
    v_add_u32 v115, 131072, v131
    v_add_u32 v116, 131072, v132
    v_add_u32 v117, 131072, v133
    v_add_u32 v118, 131072, v134
    v_add_u32 v119, 131072, v135
    v_add_u32 v120, 131072, v136
    v_add_u32 v121, 131072, v137
    v_add_u32 v122, 131072, v138
    v_add_u32 v123, 131072, v139
    v_add_u32 v124, 131072, v140
    v_add_u32 v125, 131072, v141
    v_add_u32 v126, 131072, v142
    v_add_u32 v127, 131072, v143
    s_mov_b32 s53, 0
    s_add_u32 s45, s68, 1
    s_and_b32 s45, s45, 3
    s_or_b32 s45, s45, s52
    v_mov_b32 v9, s45
    v_lshlrev_b32 v10, 24, v0
    s_lshl_b32 s44, s65, 8
    s_waitcnt vmcnt(0)
    s_barrier
    buffer_store_dword v9, v10, s[8:11], s44 offen sc1
    s_add_u32 s69, s67, 0
    s_and_b32 s69, s69, 7
    s_lshl_b32 s69, s69, 12
    s_add_u32 s69, s69, s53
    s_add_u32 s64, s69, s48
    buffer_load_dwordx4 a[0:3], v144, s[24:27], s64 offen sc1
    buffer_load_dwordx4 a[4:7], v145, s[24:27], s64 offen sc1
    buffer_load_dwordx4 a[8:11], v146, s[24:27], s64 offen sc1
    buffer_load_dwordx4 a[12:15], v147, s[24:27], s64 offen sc1
    s_add_u32 s64, s69, s49
    buffer_load_dwordx4 a[16:19], v144, s[24:27], s64 offen sc1
    buffer_load_dwordx4 a[20:23], v145, s[24:27], s64 offen sc1
    buffer_load_dwordx4 a[24:27], v146, s[24:27], s64 offen sc1
    s_add_u32 s64, s69, s50
    buffer_load_dwordx4 a[32:35], v144, s[24:27], s64 offen sc1
    buffer_load_dwordx4 a[36:39], v145, s[24:27], s64 offen sc1
    buffer_load_dwordx4 a[40:43], v146, s[24:27], s64 offen sc1
    s_add_u32 s64, s69, s51
    buffer_load_dwordx4 a[48:51], v144, s[24:27], s64 offen sc1
    buffer_load_dwordx4 a[52:55], v145, s[24:27], s64 offen sc1
    buffer_load_dwordx4 a[56:59], v146, s[24:27], s64 offen sc1
    ds_read_b64_tr_b16 v[80:81], v112
    ds_read_b64_tr_b16 v[82:83], v112 offset:1024
    ds_read_b64_tr_b16 v[84:85], v113
    ds_read_b64_tr_b16 v[86:87], v113 offset:1024
    ds_read_b64_tr_b16 v[88:89], v114
    ds_read_b64_tr_b16 v[90:91], v114 offset:1024
    ds_read_b64_tr_b16 v[92:93], v115
    ds_read_b64_tr_b16 v[94:95], v115 offset:1024
    s_add_u32 s71, s67, 4
    s_and_b32 s71, s71, 7
    s_lshl_b32 s71, s71, 17
    s_add_u32 m0, s54, 32768
    s_nop 0
    buffer_load_dwordx4 v221, s[20:23], s71 offen lds
    s_add_u32 s71, s71, 7168
    buffer_load_dwordx4 v221, s[20:23], s71 offen offset:1024 lds
    s_add_u32 s71, s71, 7168
    buffer_load_dwordx4 v221, s[20:23], s71 offen offset:2048 lds
    s_add_u32 s71, s71, 7168
    buffer_load_dwordx4 v221, s[20:23], s71 offen offset:3072 lds
    s_add_u32 s71, s67, 5
    s_and_b32 s71, s71, 7
    s_lshl_b32 s71, s71, 17
    s_add_u32 m0, s54, 49152
    s_nop 0
    buffer_load_dwordx4 v221, s[20:23], s71 offen lds
    s_add_u32 s71, s71, 7168
    buffer_load_dwordx4 v221, s[20:23], s71 offen offset:1024 lds
    s_add_u32 s71, s71, 7168
    buffer_load_dwordx4 v221, s[20:23], s71 offen offset:2048 lds
    s_add_u32 s71, s71, 7168
    buffer_load_dwordx4 v221, s[20:23], s71 offen offset:3072 lds
    s_add_u32 s71, s67, 6
    s_and_b32 s71, s71, 7
    s_lshl_b32 s71, s71, 17
    s_add_u32 m0, s54, 65536
    s_nop 0
    buffer_load_dwordx4 v221, s[20:23], s71 offen lds
    s_add_u32 s71, s71, 7168
    buffer_load_dwordx4 v221, s[20:23], s71 offen offset:1024 lds
    s_add_u32 s71, s71, 7168
    buffer_load_dwordx4 v221, s[20:23], s71 offen offset:2048 lds
    s_add_u32 s71, s71, 7168
    buffer_load_dwordx4 v221, s[20:23], s71 offen offset:3072 lds
    s_add_u32 s71, s67, 7
    s_and_b32 s71, s71, 7
    s_lshl_b32 s71, s71, 17
    s_add_u32 m0, s54, 81920
    s_nop 0
    buffer_load_dwordx4 v221, s[20:23], s71 offen lds
    s_add_u32 s71, s71, 7168
    buffer_load_dwordx4 v221, s[20:23], s71 offen offset:1024 lds
    s_add_u32 s71, s71, 7168
    buffer_load_dwordx4 v221, s[20:23], s71 offen offset:2048 lds
    s_add_u32 s71, s71, 7168
    buffer_load_dwordx4 v221, s[20:23], s71 offen offset:3072 lds
    s_lshl_b32 s47, s67, 2
    s_mov_b32 s45, 0
    v_mov_b32 v10, 0
    s_lshl_b32 s44, s40, 4
L_dbg:
    v_readfirstlane_b32 s60, v152
    v_readfirstlane_b32 s61, v153
    v_readfirstlane_b32 s62, v154
    v_readfirstlane_b32 s63, v155
    s_nop 1
    s_and_b32 s46, s60, s61
    s_and_b32 s71, s62, s63
    s_and_b32 s46, s46, s71
    s_and_b32 s46, s46, 0x88888888
    s_cmp_eq_u32 s46, 0x88888888
    s_cbranch_scc1 L_dbgok
    s_sleep 16
    buffer_load_dwordx4 v[152:155], v10, s[4:7], s44 offen sc1
    s_waitcnt vmcnt(0)
    s_add_u32 s45, s45, 1
    s_cmp_lt_u32 s45, 20000
    s_cbranch_scc1 L_dbg
L_dbgok:
    s_cmp_eq_u32 s66, 1
    s_cselect_b32 s44, s61, s60
    s_cmp_eq_u32 s66, 2
    s_cselect_b32 s44, s62, s44
    s_cmp_eq_u32 s66, 3
    s_cselect_b32 s44, s63, s44
    v_and_b32 v9, 7, v1
    v_lshlrev_b32 v11, 2, v9
    v_lshrrev_b32 v148, v11, s44
    s_andn2_b32 s45, s65, 7
    v_add_u32 v9, s45, v9
    v_lshlrev_b32 v149, 8, v9
    v_and_b32 v9, 3, v1
    v_cmp_eq_u32 vcc, 1, v9
    s_nop 1
    v_cndmask_b32 v11, v152, v153, vcc
    v_cmp_eq_u32 vcc, 2, v9
    s_nop 1
    v_cndmask_b32 v11, v11, v154, vcc
    v_cmp_eq_u32 vcc, 3, v9
    s_nop 1
    v_cndmask_b32 v11, v11, v155, vcc
    v_lshrrev_b32 v150, s47, v11
    s_lshl_b32 s45, s40, 5
    s_add_u32 s45, s45, s67
    v_lshl_add_u32 v9, v9, 3, s45
    v_lshlrev_b32 v151, 8, v9
    s_waitcnt vmcnt(28) lgkmcnt(6)
    v_mfma_f32_16x16x32_bf16 v[16:19], v[80:83], a[0:3], 0
    s_waitcnt vmcnt(27)
    v_mfma_f32_16x16x32_bf16 v[20:23], v[80:83], a[4:7], 0
    s_waitcnt vmcnt(26)
    v_mfma_f32_16x16x32_bf16 v[24:27], v[80:83], a[8:11], 0
    s_waitcnt vmcnt(25)
    v_mfma_f32_16x16x32_bf16 v[64:67], v[80:83], a[12:15], 0
    ds_read_b64_tr_b16 v[96:97], v116
    s_waitcnt lgkmcnt(5)
    v_mfma_f32_16x16x32_bf16 v[28:31], v[84:87], a[0:3], 0
    ds_read_b64_tr_b16 v[98:99], v116 offset:1024
    v_mfma_f32_16x16x32_bf16 v[32:35], v[84:87], a[4:7], 0
    v_mfma_f32_16x16x32_bf16 v[36:39], v[84:87], a[8:11], 0
    ds_read_b64_tr_b16 v[100:101], v117
    v_mfma_f32_16x16x32_bf16 v[68:71], v[84:87], a[12:15], 0
    ds_read_b64_tr_b16 v[102:103], v117 offset:1024
    s_waitcnt lgkmcnt(6)
    v_mfma_f32_16x16x32_bf16 v[40:43], v[88:91], a[0:3], 0
    v_mfma_f32_16x16x32_bf16 v[44:47], v[88:91], a[4:7], 0
    ds_read_b64_tr_b16 v[104:105], v118
    v_mfma_f32_16x16x32_bf16 v[48:51], v[88:91], a[8:11], 0
    ds_read_b64_tr_b16 v[106:107], v118 offset:1024
    v_mfma_f32_16x16x32_bf16 v[72:75], v[88:91], a[12:15], 0
    s_waitcnt lgkmcnt(6)
    v_mfma_f32_16x16x32_bf16 v[52:55], v[92:95], a[0:3], 0
    ds_read_b64_tr_b16 v[108:109], v119
    v_mfma_f32_16x16x32_bf16 v[56:59], v[92:95], a[4:7], 0
    ds_read_b64_tr_b16 v[110:111], v119 offset:1024
    v_mfma_f32_16x16x32_bf16 v[60:63], v[92:95], a[8:11], 0
    v_mfma_f32_16x16x32_bf16 v[76:79], v[92:95], a[12:15], 0
    s_waitcnt vmcnt(24) lgkmcnt(6)
    v_mfma_f32_16x16x32_bf16 v[16:19], v[96:99], a[16:19], v[16:19]
    s_waitcnt vmcnt(23)
    v_mfma_f32_16x16x32_bf16 v[20:23], v[96:99], a[20:23], v[20:23]
    s_waitcnt vmcnt(22)
    v_mfma_f32_16x16x32_bf16 v[24:27], v[96:99], a[24:27], v[24:27]
    s_waitcnt lgkmcnt(4)
    v_mfma_f32_16x16x32_bf16 v[28:31], v[100:103], a[16:19], v[28:31]
    ds_read_b64_tr_b16 v[80:81], v120
    v_mfma_f32_16x16x32_bf16 v[32:35], v[100:103], a[20:23], v[32:35]
    ds_read_b64_tr_b16 v[82:83], v120 offset:1024
    v_mfma_f32_16x16x32_bf16 v[36:39], v[100:103], a[24:27], v[36:39]
    ds_read_b64_tr_b16 v[84:85], v121
    s_waitcnt lgkmcnt(5)
    v_mfma_f32_16x16x32_bf16 v[40:43], v[104:107], a[16:19], v[40:43]
    ds_read_b64_tr_b16 v[86:87], v121 offset:1024
    v_mfma_f32_16x16x32_bf16 v[44:47], v[104:107], a[20:23], v[44:47]
    ds_read_b64_tr_b16 v[88:89], v122
    v_mfma_f32_16x16x32_bf16 v[48:51], v[104:107], a[24:27], v[48:51]
    ds_read_b64_tr_b16 v[90:91], v122 offset:1024
    s_waitcnt lgkmcnt(6)
    v_mfma_f32_16x16x32_bf16 v[52:55], v[108:111], a[16:19], v[52:55]
    ds_read_b64_tr_b16 v[92:93], v123
    v_mfma_f32_16x16x32_bf16 v[56:59], v[108:111], a[20:23], v[56:59]
    ds_read_b64_tr_b16 v[94:95], v123 offset:1024
    v_mfma_f32_16x16x32_bf16 v[60:63], v[108:111], a[24:27], v[60:63]
    v_mov_b32 v12, 98304
    s_cmp_lg_u32 s42, 0
    s_cbranch_scc1 L_skip1
    s_mov_b32 s45, 0
L_poll1:
    buffer_load_dword v9, v149, s[8:11], 0 offen sc1
    s_waitcnt vmcnt(0)
    v_sub_u32 v11, v9, v148
    v_and_b32 v11, 3, v11
    v_cmp_ne_u32 vcc, 0, v11
    s_add_u32 s45, s45, 1
    s_nop 3
    s_cmp_eq_u64 vcc, -1
    s_cbranch_scc1 L_ready1
    s_sleep 4
    s_cmp_lt_u32 s45, 20000
    s_cbranch_scc1 L_poll1
L_ready1:
    v_and_b32 v11, 0xf00, v9
    v_cmp_eq_u32 vcc, s52, v11
    s_nop 3
    s_cmp_eq_u64 vcc, -1
    s_cselect_b32 s53, s53, 0
    v_mov_b32 v11, s53
    ds_write_b32 v12, v11
    s_waitcnt lgkmcnt(0)
L_skip1:
    s_barrier
    ds_read_b32 v11, v12
    s_waitcnt lgkmcnt(0)
    v_readfirstlane_b32 s53, v11
    s_add_u32 s69, s67, 1
    s_and_b32 s69, s69, 7
    s_lshl_b32 s69, s69, 12
    s_add_u32 s69, s69, s53
    s_add_u32 s64, s69, s48
    buffer_load_dwordx4 a[64:67], v144, s[24:27], s64 offen sc1
    buffer_load_dwordx4 a[68:71], v145, s[24:27], s64 offen sc1
    buffer_load_dwordx4 a[72:75], v146, s[24:27], s64 offen sc1
    buffer_load_dwordx4 a[76:79], v147, s[24:27], s64 offen sc1
    s_add_u32 s64, s69, s49
    buffer_load_dwordx4 a[80:83], v144, s[24:27], s64 offen sc1
    buffer_load_dwordx4 a[84:87], v145, s[24:27], s64 offen sc1
    buffer_load_dwordx4 a[88:91], v146, s[24:27], s64 offen sc1
    s_add_u32 s64, s69, s50
    buffer_load_dwordx4 a[0:3], v144, s[24:27], s64 offen sc1
    buffer_load_dwordx4 a[4:7], v145, s[24:27], s64 offen sc1
    buffer_load_dwordx4 a[8:11], v146, s[24:27], s64 offen sc1
    s_waitcnt vmcnt(31)
    v_mfma_f32_16x16x32_bf16 v[16:19], v[80:83], a[32:35], v[16:19]
    s_add_u32 s64, s69, s51
    buffer_load_dwordx4 a[16:19], v144, s[24:27], s64 offen sc1
    s_waitcnt vmcnt(31)
    v_mfma_f32_16x16x32_bf16 v[20:23], v[80:83], a[36:39], v[20:23]
    buffer_load_dwordx4 a[20:23], v145, s[24:27], s64 offen sc1
    s_waitcnt vmcnt(31)
    v_mfma_f32_16x16x32_bf16 v[24:27], v[80:83], a[40:43], v[24:27]
    buffer_load_dwordx4 a[24:27], v146, s[24:27], s64 offen sc1
    v_mfma_f32_16x16x32_bf16 v[28:31], v[84:87], a[32:35], v[28:31]
    ds_read_b64_tr_b16 v[96:97], v124
    v_mfma_f32_16x16x32_bf16 v[32:35], v[84:87], a[36:39], v[32:35]
    ds_read_b64_tr_b16 v[98:99], v124 offset:1024
    v_mfma_f32_16x16x32_bf16 v[36:39], v[84:87], a[40:43], v[36:39]
    ds_read_b64_tr_b16 v[100:101], v125
    v_mfma_f32_16x16x32_bf16 v[40:43], v[88:91], a[32:35], v[40:43]
    ds_read_b64_tr_b16 v[102:103], v125 offset:1024
    v_mfma_f32_16x16x32_bf16 v[44:47], v[88:91], a[36:39], v[44:47]
    ds_read_b64_tr_b16 v[104:105], v126
    v_mfma_f32_16x16x32_bf16 v[48:51], v[88:91], a[40:43], v[48:51]
    ds_read_b64_tr_b16 v[106:107], v126 offset:1024
    v_mfma_f32_16x16x32_bf16 v[52:55], v[92:95], a[32:35], v[52:55]
    ds_read_b64_tr_b16 v[108:109], v127
    v_mfma_f32_16x16x32_bf16 v[56:59], v[92:95], a[36:39], v[56:59]
    ds_read_b64_tr_b16 v[110:111], v127 offset:1024
    v_mfma_f32_16x16x32_bf16 v[60:63], v[92:95], a[40:43], v[60:63]
    s_waitcnt vmcnt(31) lgkmcnt(6)
    v_mfma_f32_16x16x32_bf16 v[16:19], v[96:99], a[48:51], v[16:19]
    s_add_u32 s69, s67, 2
    s_and_b32 s69, s69, 7
    s_lshl_b32 s69, s69, 12
    s_add_u32 s69, s69, s53
    s_waitcnt vmcnt(30)
    v_mfma_f32_16x16x32_bf16 v[20:23], v[96:99], a[52:55], v[20:23]
    s_add_u32 s64, s69, s48
    buffer_load_dwordx4 a[32:35], v144, s[24:27], s64 offen sc1
    s_waitcnt vmcnt(30)
    v_mfma_f32_16x16x32_bf16 v[24:27], v[96:99], a[56:59], v[24:27]
    buffer_load_dwordx4 a[36:39], v145, s[24:27], s64 offen sc1
    buffer_load_dwordx4 a[40:43], v146, s[24:27], s64 offen sc1
    s_waitcnt lgkmcnt(4)
    v_mfma_f32_16x16x32_bf16 v[28:31], v[100:103], a[48:51], v[28:31]
    buffer_load_dwordx4 a[44:47], v147, s[24:27], s64 offen sc1
    ds_read_b64_tr_b16 v[80:81], v112 offset:16384
    v_mfma_f32_16x16x32_bf16 v[32:35], v[100:103], a[52:55], v[32:35]
    ds_read_b64_tr_b16 v[82:83], v112 offset:17408
    v_mfma_f32_16x16x32_bf16 v[36:39], v[100:103], a[56:59], v[36:39]
    ds_read_b64_tr_b16 v[84:85], v113 offset:16384
    s_waitcnt lgkmcnt(5)
    v_mfma_f32_16x16x32_bf16 v[40:43], v[104:107], a[48:51], v[40:43]
    ds_read_b64_tr_b16 v[86:87], v113 offset:17408
    v_mfma_f32_16x16x32_bf16 v[44:47], v[104:107], a[52:55], v[44:47]
    ds_read_b64_tr_b16 v[88:89], v114 offset:16384
    v_mfma_f32_16x16x32_bf16 v[48:51], v[104:107], a[56:59], v[48:51]
    ds_read_b64_tr_b16 v[90:91], v114 offset:17408
    s_waitcnt lgkmcnt(6)
    v_mfma_f32_16x16x32_bf16 v[52:55], v[108:111], a[48:51], v[52:55]
    ds_read_b64_tr_b16 v[92:93], v115 offset:16384
    v_mfma_f32_16x16x32_bf16 v[56:59], v[108:111], a[52:55], v[56:59]
    ds_read_b64_tr_b16 v[94:95], v115 offset:17408
    v_mfma_f32_16x16x32_bf16 v[60:63], v[108:111], a[56:59], v[60:63]
    s_waitcnt vmcnt(16) lgkmcnt(6)
    v_mfma_f32_16x16x32_bf16 v[16:19], v[80:83], a[64:67], v[16:19]
    s_add_u32 s64, s69, s49
    buffer_load_dwordx4 a[48:51], v144, s[24:27], s64 offen sc1
    s_waitcnt vmcnt(16)
    v_mfma_f32_16x16x32_bf16 v[20:23], v[80:83], a[68:71], v[20:23]
    buffer_load_dwordx4 a[52:55], v145, s[24:27], s64 offen sc1
    s_waitcnt vmcnt(16)
    v_mfma_f32_16x16x32_bf16 v[24:27], v[80:83], a[72:75], v[24:27]
    buffer_load_dwordx4 a[56:59], v146, s[24:27], s64 offen sc1
    s_waitcnt vmcnt(16)
    v_mfma_f32_16x16x32_bf16 v[64:67], v[80:83], a[76:79], v[64:67]
    ds_read_b64_tr_b16 v[96:97], v116 offset:16384
    s_waitcnt lgkmcnt(5)
    v_mfma_f32_16x16x32_bf16 v[28:31], v[84:87], a[64:67], v[28:31]
    ds_read_b64_tr_b16 v[98:99], v116 offset:17408
    v_mfma_f32_16x16x32_bf16 v[32:35], v[84:87], a[68:71], v[32:35]
    v_mfma_f32_16x16x32_bf16 v[36:39], v[84:87], a[72:75], v[36:39]
    ds_read_b64_tr_b16 v[100:101], v117 offset:16384
    v_mfma_f32_16x16x32_bf16 v[68:71], v[84:87], a[76:79], v[68:71]
    ds_read_b64_tr_b16 v[102:103], v117 offset:17408
    s_waitcnt lgkmcnt(6)
    v_mfma_f32_16x16x32_bf16 v[40:43], v[88:91], a[64:67], v[40:43]
    v_mfma_f32_16x16x32_bf16 v[44:47], v[88:91], a[68:71], v[44:47]
    ds_read_b64_tr_b16 v[104:105], v118 offset:16384
    v_mfma_f32_16x16x32_bf16 v[48:51], v[88:91], a[72:75], v[48:51]
    ds_read_b64_tr_b16 v[106:107], v118 offset:17408
    v_mfma_f32_16x16x32_bf16 v[72:75], v[88:91], a[76:79], v[72:75]
    s_waitcnt lgkmcnt(6)
    v_mfma_f32_16x16x32_bf16 v[52:55], v[92:95], a[64:67], v[52:55]
    ds_read_b64_tr_b16 v[108:109], v119 offset:16384
    v_mfma_f32_16x16x32_bf16 v[56:59], v[92:95], a[68:71], v[56:59]
    ds_read_b64_tr_b16 v[110:111], v119 offset:17408
    v_mfma_f32_16x16x32_bf16 v[60:63], v[92:95], a[72:75], v[60:63]
    v_mfma_f32_16x16x32_bf16 v[76:79], v[92:95], a[76:79], v[76:79]
    s_waitcnt vmcnt(15) lgkmcnt(6)
    v_mfma_f32_16x16x32_bf16 v[16:19], v[96:99], a[80:83], v[16:19]
    s_add_u32 s64, s69, s50
    buffer_load_dwordx4 a[64:67], v144, s[24:27], s64 offen sc1
    s_waitcnt vmcnt(15)
    v_mfma_f32_16x16x32_bf16 v[20:23], v[96:99], a[84:87], v[20:23]
    buffer_load_dwordx4 a[68:71], v145, s[24:27], s64 offen sc1
    s_waitcnt vmcnt(15)
    v_mfma_f32_16x16x32_bf16 v[24:27], v[96:99], a[88:91], v[24:27]
    buffer_load_dwordx4 a[72:75], v146, s[24:27], s64 offen sc1
    s_waitcnt lgkmcnt(4)
    v_mfma_f32_16x16x32_bf16 v[28:31], v[100:103], a[80:83], v[28:31]
    ds_read_b64_tr_b16 v[80:81], v120 offset:16384
    v_mfma_f32_16x16x32_bf16 v[32:35], v[100:103], a[84:87], v[32:35]
    ds_read_b64_tr_b16 v[82:83], v120 offset:17408
    v_mfma_f32_16x16x32_bf16 v[36:39], v[100:103], a[88:91], v[36:39]
    ds_read_b64_tr_b16 v[84:85], v121 offset:16384
    s_waitcnt lgkmcnt(5)
    v_mfma_f32_16x16x32_bf16 v[40:43], v[104:107], a[80:83], v[40:43]
    ds_read_b64_tr_b16 v[86:87], v121 offset:17408
    v_mfma_f32_16x16x32_bf16 v[44:47], v[104:107], a[84:87], v[44:47]
    ds_read_b64_tr_b16 v[88:89], v122 offset:16384
    v_mfma_f32_16x16x32_bf16 v[48:51], v[104:107], a[88:91], v[48:51]
    ds_read_b64_tr_b16 v[90:91], v122 offset:17408
    s_waitcnt lgkmcnt(6)
    v_mfma_f32_16x16x32_bf16 v[52:55], v[108:111], a[80:83], v[52:55]
    ds_read_b64_tr_b16 v[92:93], v123 offset:16384
    v_mfma_f32_16x16x32_bf16 v[56:59], v[108:111], a[84:87], v[56:59]
    ds_read_b64_tr_b16 v[94:95], v123 offset:17408
    v_mfma_f32_16x16x32_bf16 v[60:63], v[108:111], a[88:91], v[60:63]
    s_waitcnt vmcnt(15) lgkmcnt(6)
    v_mfma_f32_16x16x32_bf16 v[16:19], v[80:83], a[0:3], v[16:19]
    s_add_u32 s64, s69, s51
    buffer_load_dwordx4 a[80:83], v144, s[24:27], s64 offen sc1
    s_waitcnt vmcnt(15)
    v_mfma_f32_16x16x32_bf16 v[20:23], v[80:83], a[4:7], v[20:23]
    buffer_load_dwordx4 a[84:87], v145, s[24:27], s64 offen sc1
    s_waitcnt vmcnt(15)
    v_mfma_f32_16x16x32_bf16 v[24:27], v[80:83], a[8:11], v[24:27]
    buffer_load_dwordx4 a[88:91], v146, s[24:27], s64 offen sc1
    s_waitcnt lgkmcnt(4)
    v_mfma_f32_16x16x32_bf16 v[28:31], v[84:87], a[0:3], v[28:31]
    ds_read_b64_tr_b16 v[96:97], v124 offset:16384
    v_mfma_f32_16x16x32_bf16 v[32:35], v[84:87], a[4:7], v[32:35]
    ds_read_b64_tr_b16 v[98:99], v124 offset:17408
    v_mfma_f32_16x16x32_bf16 v[36:39], v[84:87], a[8:11], v[36:39]
    ds_read_b64_tr_b16 v[100:101], v125 offset:16384
    s_waitcnt lgkmcnt(5)
    v_mfma_f32_16x16x32_bf16 v[40:43], v[88:91], a[0:3], v[40:43]
    ds_read_b64_tr_b16 v[102:103], v125 offset:17408
    v_mfma_f32_16x16x32_bf16 v[44:47], v[88:91], a[4:7], v[44:47]
    ds_read_b64_tr_b16 v[104:105], v126 offset:16384
    v_mfma_f32_16x16x32_bf16 v[48:51], v[88:91], a[8:11], v[48:51]
    ds_read_b64_tr_b16 v[106:107], v126 offset:17408
    s_waitcnt lgkmcnt(6)
    v_mfma_f32_16x16x32_bf16 v[52:55], v[92:95], a[0:3], v[52:55]
    ds_read_b64_tr_b16 v[108:109], v127 offset:16384
    v_mfma_f32_16x16x32_bf16 v[56:59], v[92:95], a[4:7], v[56:59]
    ds_read_b64_tr_b16 v[110:111], v127 offset:17408
    v_mfma_f32_16x16x32_bf16 v[60:63], v[92:95], a[8:11], v[60:63]
    v_add_u32 v112, 0, v128
    v_add_u32 v113, 0, v129
    v_add_u32 v114, 0, v130
    v_add_u32 v115, 0, v131
    v_add_u32 v116, 0, v132
    v_add_u32 v117, 0, v133
    v_add_u32 v118, 0, v134
    v_add_u32 v119, 0, v135
    v_add_u32 v120, 0, v136
    v_add_u32 v121, 0, v137
    v_add_u32 v122, 0, v138
    v_add_u32 v123, 0, v139
    v_add_u32 v124, 0, v140
    v_add_u32 v125, 0, v141
    v_add_u32 v126, 0, v142
    v_add_u32 v127, 0, v143
    s_waitcnt vmcnt(15) lgkmcnt(6)
    v_mfma_f32_16x16x32_bf16 v[16:19], v[96:99], a[16:19], v[16:19]
    s_add_u32 s69, s67, 3
    s_and_b32 s69, s69, 7
    s_lshl_b32 s69, s69, 12
    s_add_u32 s69, s69, s53
    s_waitcnt vmcnt(14)
    v_mfma_f32_16x16x32_bf16 v[20:23], v[96:99], a[20:23], v[20:23]
    s_add_u32 s64, s69, s48
    buffer_load_dwordx4 a[0:3], v144, s[24:27], s64 offen sc1
    s_waitcnt vmcnt(14)
    v_mfma_f32_16x16x32_bf16 v[24:27], v[96:99], a[24:27], v[24:27]
    buffer_load_dwordx4 a[4:7], v145, s[24:27], s64 offen sc1
    buffer_load_dwordx4 a[8:11], v146, s[24:27], s64 offen sc1
    s_waitcnt lgkmcnt(4)
    v_mfma_f32_16x16x32_bf16 v[28:31], v[100:103], a[16:19], v[28:31]
    buffer_load_dwordx4 a[12:15], v147, s[24:27], s64 offen sc1
    ds_read_b64_tr_b16 v[80:81], v112
    v_mfma_f32_16x16x32_bf16 v[32:35], v[100:103], a[20:23], v[32:35]
    ds_read_b64_tr_b16 v[82:83], v112 offset:1024
    v_mfma_f32_16x16x32_bf16 v[36:39], v[100:103], a[24:27], v[36:39]
    ds_read_b64_tr_b16 v[84:85], v113
    s_waitcnt lgkmcnt(5)
    v_mfma_f32_16x16x32_bf16 v[40:43], v[104:107], a[16:19], v[40:43]
    ds_read_b64_tr_b16 v[86:87], v113 offset:1024
    v_mfma_f32_16x16x32_bf16 v[44:47], v[104:107], a[20:23], v[44:47]
    ds_read_b64_tr_b16 v[88:89], v114
    v_mfma_f32_16x16x32_bf16 v[48:51], v[104:107], a[24:27], v[48:51]
    ds_read_b64_tr_b16 v[90:91], v114 offset:1024
    s_waitcnt lgkmcnt(6)
    v_mfma_f32_16x16x32_bf16 v[52:55], v[108:111], a[16:19], v[52:55]
    ds_read_b64_tr_b16 v[92:93], v115
    v_mfma_f32_16x16x32_bf16 v[56:59], v[108:111], a[20:23], v[56:59]
    ds_read_b64_tr_b16 v[94:95], v115 offset:1024
    v_mfma_f32_16x16x32_bf16 v[60:63], v[108:111], a[24:27], v[60:63]
    s_waitcnt vmcnt(16) lgkmcnt(6)
    v_mfma_f32_16x16x32_bf16 v[16:19], v[80:83], a[32:35], v[16:19]
    s_add_u32 s64, s69, s49
    buffer_load_dwordx4 a[16:19], v144, s[24:27], s64 offen sc1
    s_waitcnt vmcnt(16)
    v_mfma_f32_16x16x32_bf16 v[20:23], v[80:83], a[36:39], v[20:23]
    buffer_load_dwordx4 a[20:23], v145, s[24:27], s64 offen sc1
    s_waitcnt vmcnt(16)
    v_mfma_f32_16x16x32_bf16 v[24:27], v[80:83], a[40:43], v[24:27]
    buffer_load_dwordx4 a[24:27], v146, s[24:27], s64 offen sc1
    s_waitcnt vmcnt(16)
    v_mfma_f32_16x16x32_bf16 v[64:67], v[80:83], a[44:47], v[64:67]
    ds_read_b64_tr_b16 v[96:97], v116
    s_waitcnt lgkmcnt(5)
    v_mfma_f32_16x16x32_bf16 v[28:31], v[84:87], a[32:35], v[28:31]
    ds_read_b64_tr_b16 v[98:99], v116 offset:1024
    v_mfma_f32_16x16x32_bf16 v[32:35], v[84:87], a[36:39], v[32:35]
    v_mfma_f32_16x16x32_bf16 v[36:39], v[84:87], a[40:43], v[36:39]
    ds_read_b64_tr_b16 v[100:101], v117
    v_mfma_f32_16x16x32_bf16 v[68:71], v[84:87], a[44:47], v[68:71]
    ds_read_b64_tr_b16 v[102:103], v117 offset:1024
    s_waitcnt lgkmcnt(6)
    v_mfma_f32_16x16x32_bf16 v[40:43], v[88:91], a[32:35], v[40:43]
    v_mfma_f32_16x16x32_bf16 v[44:47], v[88:91], a[36:39], v[44:47]
    ds_read_b64_tr_b16 v[104:105], v118
    v_mfma_f32_16x16x32_bf16 v[48:51], v[88:91], a[40:43], v[48:51]
    ds_read_b64_tr_b16 v[106:107], v118 offset:1024
    v_mfma_f32_16x16x32_bf16 v[72:75], v[88:91], a[44:47], v[72:75]
    s_waitcnt lgkmcnt(6)
    v_mfma_f32_16x16x32_bf16 v[52:55], v[92:95], a[32:35], v[52:55]
    ds_read_b64_tr_b16 v[108:109], v119
    v_mfma_f32_16x16x32_bf16 v[56:59], v[92:95], a[36:39], v[56:59]
    ds_read_b64_tr_b16 v[110:111], v119 offset:1024
    v_mfma_f32_16x16x32_bf16 v[60:63], v[92:95], a[40:43], v[60:63]
    v_mfma_f32_16x16x32_bf16 v[76:79], v[92:95], a[44:47], v[76:79]
    s_waitcnt vmcnt(15) lgkmcnt(6)
    v_mfma_f32_16x16x32_bf16 v[16:19], v[96:99], a[48:51], v[16:19]
    s_add_u32 s64, s69, s50
    buffer_load_dwordx4 a[32:35], v144, s[24:27], s64 offen sc1
    s_waitcnt vmcnt(15)
    v_mfma_f32_16x16x32_bf16 v[20:23], v[96:99], a[52:55], v[20:23]
    buffer_load_dwordx4 a[36:39], v145, s[24:27], s64 offen sc1
    s_waitcnt vmcnt(15)
    v_mfma_f32_16x16x32_bf16 v[24:27], v[96:99], a[56:59], v[24:27]
    buffer_load_dwordx4 a[40:43], v146, s[24:27], s64 offen sc1
    s_waitcnt lgkmcnt(4)
    v_mfma_f32_16x16x32_bf16 v[28:31], v[100:103], a[48:51], v[28:31]
    ds_read_b64_tr_b16 v[80:81], v120
    v_mfma_f32_16x16x32_bf16 v[32:35], v[100:103], a[52:55], v[32:35]
    ds_read_b64_tr_b16 v[82:83], v120 offset:1024
    v_mfma_f32_16x16x32_bf16 v[36:39], v[100:103], a[56:59], v[36:39]
    ds_read_b64_tr_b16 v[84:85], v121
    s_waitcnt lgkmcnt(5)
    v_mfma_f32_16x16x32_bf16 v[40:43], v[104:107], a[48:51], v[40:43]
    ds_read_b64_tr_b16 v[86:87], v121 offset:1024
    v_mfma_f32_16x16x32_bf16 v[44:47], v[104:107], a[52:55], v[44:47]
    ds_read_b64_tr_b16 v[88:89], v122
    v_mfma_f32_16x16x32_bf16 v[48:51], v[104:107], a[56:59], v[48:51]
    ds_read_b64_tr_b16 v[90:91], v122 offset:1024
    s_waitcnt lgkmcnt(6)
    v_mfma_f32_16x16x32_bf16 v[52:55], v[108:111], a[48:51], v[52:55]
    ds_read_b64_tr_b16 v[92:93], v123
    v_mfma_f32_16x16x32_bf16 v[56:59], v[108:111], a[52:55], v[56:59]
    ds_read_b64_tr_b16 v[94:95], v123 offset:1024
    v_mfma_f32_16x16x32_bf16 v[60:63], v[108:111], a[56:59], v[60:63]
    s_waitcnt vmcnt(15) lgkmcnt(6)
    v_mfma_f32_16x16x32_bf16 v[16:19], v[80:83], a[64:67], v[16:19]
    s_add_u32 s64, s69, s51
    buffer_load_dwordx4 a[48:51], v144, s[24:27], s64 offen sc1
    s_waitcnt vmcnt(15)
    v_mfma_f32_16x16x32_bf16 v[20:23], v[80:83], a[68:71], v[20:23]
    buffer_load_dwordx4 a[52:55], v145, s[24:27], s64 offen sc1
    s_waitcnt vmcnt(15)
    v_mfma_f32_16x16x32_bf16 v[24:27], v[80:83], a[72:75], v[24:27]
    buffer_load_dwordx4 a[56:59], v146, s[24:27], s64 offen sc1
    s_waitcnt lgkmcnt(4)
    v_mfma_f32_16x16x32_bf16 v[28:31], v[84:87], a[64:67], v[28:31]
    ds_read_b64_tr_b16 v[96:97], v124
    v_mfma_f32_16x16x32_bf16 v[32:35], v[84:87], a[68:71], v[32:35]
    ds_read_b64_tr_b16 v[98:99], v124 offset:1024
    v_mfma_f32_16x16x32_bf16 v[36:39], v[84:87], a[72:75], v[36:39]
    ds_read_b64_tr_b16 v[100:101], v125
    s_waitcnt lgkmcnt(5)
    v_mfma_f32_16x16x32_bf16 v[40:43], v[88:91], a[64:67], v[40:43]
    ds_read_b64_tr_b16 v[102:103], v125 offset:1024
    v_mfma_f32_16x16x32_bf16 v[44:47], v[88:91], a[68:71], v[44:47]
    ds_read_b64_tr_b16 v[104:105], v126
    v_mfma_f32_16x16x32_bf16 v[48:51], v[88:91], a[72:75], v[48:51]
    ds_read_b64_tr_b16 v[106:107], v126 offset:1024
    s_waitcnt lgkmcnt(6)
    v_mfma_f32_16x16x32_bf16 v[52:55], v[92:95], a[64:67], v[52:55]
    ds_read_b64_tr_b16 v[108:109], v127
    v_mfma_f32_16x16x32_bf16 v[56:59], v[92:95], a[68:71], v[56:59]
    ds_read_b64_tr_b16 v[110:111], v127 offset:1024
    v_mfma_f32_16x16x32_bf16 v[60:63], v[92:95], a[72:75], v[60:63]
    s_waitcnt vmcnt(15) lgkmcnt(6)
    v_mfma_f32_16x16x32_bf16 v[16:19], v[96:99], a[80:83], v[16:19]
    s_add_u32 s69, s67, 4
    s_and_b32 s69, s69, 7
    s_lshl_b32 s69, s69, 12
    s_add_u32 s69, s69, s53
    s_waitcnt vmcnt(14)
    v_mfma_f32_16x16x32_bf16 v[20:23], v[96:99], a[84:87], v[20:23]
    s_add_u32 s64, s69, s48
    buffer_load_dwordx4 a[64:67], v144, s[24:27], s64 offen sc1
    s_waitcnt vmcnt(14)
    v_mfma_f32_16x16x32_bf16 v[24:27], v[96:99], a[88:91], v[24:27]
    buffer_load_dwordx4 a[68:71], v145, s[24:27], s64 offen sc1
    buffer_load_dwordx4 a[72:75], v146, s[24:27], s64 offen sc1
    s_waitcnt lgkmcnt(4)
    v_mfma_f32_16x16x32_bf16 v[28:31], v[100:103], a[80:83], v[28:31]
    buffer_load_dwordx4 a[76:79], v147, s[24:27], s64 offen sc1
    ds_read_b64_tr_b16 v[80:81], v112 offset:16384
    v_mfma_f32_16x16x32_bf16 v[32:35], v[100:103], a[84:87], v[32:35]
    ds_read_b64_tr_b16 v[82:83], v112 offset:17408
    v_mfma_f32_16x16x32_bf16 v[36:39], v[100:103], a[88:91], v[36:39]
    ds_read_b64_tr_b16 v[84:85], v113 offset:16384
    s_waitcnt lgkmcnt(5)
    v_mfma_f32_16x16x32_bf16 v[40:43], v[104:107], a[80:83], v[40:43]
    ds_read_b64_tr_b16 v[86:87], v113 offset:17408
    v_mfma_f32_16x16x32_bf16 v[44:47], v[104:107], a[84:87], v[44:47]
    ds_read_b64_tr_b16 v[88:89], v114 offset:16384
    v_mfma_f32_16x16x32_bf16 v[48:51], v[104:107], a[88:91], v[48:51]
    ds_read_b64_tr_b16 v[90:91], v114 offset:17408
    s_waitcnt lgkmcnt(6)
    v_mfma_f32_16x16x32_bf16 v[52:55], v[108:111], a[80:83], v[52:55]
    ds_read_b64_tr_b16 v[92:93], v115 offset:16384
    v_mfma_f32_16x16x32_bf16 v[56:59], v[108:111], a[84:87], v[56:59]
    ds_read_b64_tr_b16 v[94:95], v115 offset:17408
    v_mfma_f32_16x16x32_bf16 v[60:63], v[108:111], a[88:91], v[60:63]
    s_waitcnt vmcnt(16) lgkmcnt(6)
    v_mfma_f32_16x16x32_bf16 v[16:19], v[80:83], a[0:3], v[16:19]
    s_add_u32 s64, s69, s49
    buffer_load_dwordx4 a[80:83], v144, s[24:27], s64 offen sc1
    s_waitcnt vmcnt(16)
    v_mfma_f32_16x16x32_bf16 v[20:23], v[80:83], a[4:7], v[20:23]
    buffer_load_dwordx4 a[84:87], v145, s[24:27], s64 offen sc1
    s_waitcnt vmcnt(16)
    v_mfma_f32_16x16x32_bf16 v[24:27], v[80:83], a[8:11], v[24:27]
    buffer_load_dwordx4 a[88:91], v146, s[24:27], s64 offen sc1
    s_waitcnt vmcnt(16)
    v_mfma_f32_16x16x32_bf16 v[64:67], v[80:83], a[12:15], v[64:67]
    ds_read_b64_tr_b16 v[96:97], v116 offset:16384
    s_waitcnt lgkmcnt(5)
    v_mfma_f32_16x16x32_bf16 v[28:31], v[84:87], a[0:3], v[28:31]
    ds_read_b64_tr_b16 v[98:99], v116 offset:17408
    v_mfma_f32_16x16x32_bf16 v[32:35], v[84:87], a[4:7], v[32:35]
    v_mfma_f32_16x16x32_bf16 v[36:39], v[84:87], a[8:11], v[36:39]
    ds_read_b64_tr_b16 v[100:101], v117 offset:16384
    v_mfma_f32_16x16x32_bf16 v[68:71], v[84:87], a[12:15], v[68:71]
    ds_read_b64_tr_b16 v[102:103], v117 offset:17408
    s_waitcnt lgkmcnt(6)
    v_mfma_f32_16x16x32_bf16 v[40:43], v[88:91], a[0:3], v[40:43]
    v_mfma_f32_16x16x32_bf16 v[44:47], v[88:91], a[4:7], v[44:47]
    ds_read_b64_tr_b16 v[104:105], v118 offset:16384
    v_mfma_f32_16x16x32_bf16 v[48:51], v[88:91], a[8:11], v[48:51]
    ds_read_b64_tr_b16 v[106:107], v118 offset:17408
    v_mfma_f32_16x16x32_bf16 v[72:75], v[88:91], a[12:15], v[72:75]
    s_waitcnt lgkmcnt(6)
    v_mfma_f32_16x16x32_bf16 v[52:55], v[92:95], a[0:3], v[52:55]
    ds_read_b64_tr_b16 v[108:109], v119 offset:16384
    v_mfma_f32_16x16x32_bf16 v[56:59], v[92:95], a[4:7], v[56:59]
    ds_read_b64_tr_b16 v[110:111], v119 offset:17408
    v_mfma_f32_16x16x32_bf16 v[60:63], v[92:95], a[8:11], v[60:63]
    v_mfma_f32_16x16x32_bf16 v[76:79], v[92:95], a[12:15], v[76:79]
    s_waitcnt vmcnt(15) lgkmcnt(6)
    v_mfma_f32_16x16x32_bf16 v[16:19], v[96:99], a[16:19], v[16:19]
    s_add_u32 s64, s69, s50
    buffer_load_dwordx4 a[0:3], v144, s[24:27], s64 offen sc1
    s_waitcnt vmcnt(15)
    v_mfma_f32_16x16x32_bf16 v[20:23], v[96:99], a[20:23], v[20:23]
    buffer_load_dwordx4 a[4:7], v145, s[24:27], s64 offen sc1
    s_waitcnt vmcnt(15)
    v_mfma_f32_16x16x32_bf16 v[24:27], v[96:99], a[24:27], v[24:27]
    buffer_load_dwordx4 a[8:11], v146, s[24:27], s64 offen sc1
    s_waitcnt lgkmcnt(4)
    v_mfma_f32_16x16x32_bf16 v[28:31], v[100:103], a[16:19], v[28:31]
    ds_read_b64_tr_b16 v[80:81], v120 offset:16384
    v_mfma_f32_16x16x32_bf16 v[32:35], v[100:103], a[20:23], v[32:35]
    ds_read_b64_tr_b16 v[82:83], v120 offset:17408
    v_mfma_f32_16x16x32_bf16 v[36:39], v[100:103], a[24:27], v[36:39]
    ds_read_b64_tr_b16 v[84:85], v121 offset:16384
    s_waitcnt lgkmcnt(5)
    v_mfma_f32_16x16x32_bf16 v[40:43], v[104:107], a[16:19], v[40:43]
    ds_read_b64_tr_b16 v[86:87], v121 offset:17408
    v_mfma_f32_16x16x32_bf16 v[44:47], v[104:107], a[20:23], v[44:47]
    ds_read_b64_tr_b16 v[88:89], v122 offset:16384
    v_mfma_f32_16x16x32_bf16 v[48:51], v[104:107], a[24:27], v[48:51]
    ds_read_b64_tr_b16 v[90:91], v122 offset:17408
    s_waitcnt lgkmcnt(6)
    v_mfma_f32_16x16x32_bf16 v[52:55], v[108:111], a[16:19], v[52:55]
    ds_read_b64_tr_b16 v[92:93], v123 offset:16384
    v_mfma_f32_16x16x32_bf16 v[56:59], v[108:111], a[20:23], v[56:59]
    ds_read_b64_tr_b16 v[94:95], v123 offset:17408
    v_mfma_f32_16x16x32_bf16 v[60:63], v[108:111], a[24:27], v[60:63]
    s_barrier
    s_waitcnt vmcnt(15) lgkmcnt(6)
    v_mfma_f32_16x16x32_bf16 v[16:19], v[80:83], a[32:35], v[16:19]
    s_add_u32 s64, s69, s51
    buffer_load_dwordx4 a[16:19], v144, s[24:27], s64 offen sc1
    s_waitcnt vmcnt(15)
    v_mfma_f32_16x16x32_bf16 v[20:23], v[80:83], a[36:39], v[20:23]
    buffer_load_dwordx4 a[20:23], v145, s[24:27], s64 offen sc1
    s_waitcnt vmcnt(15)
    v_mfma_f32_16x16x32_bf16 v[24:27], v[80:83], a[40:43], v[24:27]
    buffer_load_dwordx4 a[24:27], v146, s[24:27], s64 offen sc1
    s_waitcnt lgkmcnt(4)
    v_mfma_f32_16x16x32_bf16 v[28:31], v[84:87], a[32:35], v[28:31]
    ds_read_b64_tr_b16 v[96:97], v124 offset:16384
    v_mfma_f32_16x16x32_bf16 v[32:35], v[84:87], a[36:39], v[32:35]
    ds_read_b64_tr_b16 v[98:99], v124 offset:17408
    v_mfma_f32_16x16x32_bf16 v[36:39], v[84:87], a[40:43], v[36:39]
    ds_read_b64_tr_b16 v[100:101], v125 offset:16384
    s_waitcnt lgkmcnt(5)
    v_mfma_f32_16x16x32_bf16 v[40:43], v[88:91], a[32:35], v[40:43]
    ds_read_b64_tr_b16 v[102:103], v125 offset:17408
    v_mfma_f32_16x16x32_bf16 v[44:47], v[88:91], a[36:39], v[44:47]
    ds_read_b64_tr_b16 v[104:105], v126 offset:16384
    v_mfma_f32_16x16x32_bf16 v[48:51], v[88:91], a[40:43], v[48:51]
    ds_read_b64_tr_b16 v[106:107], v126 offset:17408
    s_waitcnt lgkmcnt(6)
    v_mfma_f32_16x16x32_bf16 v[52:55], v[92:95], a[32:35], v[52:55]
    ds_read_b64_tr_b16 v[108:109], v127 offset:16384
    v_mfma_f32_16x16x32_bf16 v[56:59], v[92:95], a[36:39], v[56:59]
    ds_read_b64_tr_b16 v[110:111], v127 offset:17408
    v_mfma_f32_16x16x32_bf16 v[60:63], v[92:95], a[40:43], v[60:63]
    s_waitcnt vmcnt(15) lgkmcnt(6)
    v_mfma_f32_16x16x32_bf16 v[16:19], v[96:99], a[48:51], v[16:19]
    s_add_u32 s69, s67, 5
    s_and_b32 s69, s69, 7
    s_lshl_b32 s69, s69, 12
    s_add_u32 s69, s69, s53
    s_waitcnt vmcnt(14)
    v_mfma_f32_16x16x32_bf16 v[20:23], v[96:99], a[52:55], v[20:23]
    s_add_u32 s64, s69, s48
    buffer_load_dwordx4 a[32:35], v144, s[24:27], s64 offen sc1
    s_waitcnt vmcnt(14)
    v_mfma_f32_16x16x32_bf16 v[24:27], v[96:99], a[56:59], v[24:27]
    buffer_load_dwordx4 a[36:39], v145, s[24:27], s64 offen sc1
    buffer_load_dwordx4 a[40:43], v146, s[24:27], s64 offen sc1
    s_waitcnt lgkmcnt(4)
    v_mfma_f32_16x16x32_bf16 v[28:31], v[100:103], a[48:51], v[28:31]
    buffer_load_dwordx4 a[44:47], v147, s[24:27], s64 offen sc1
    ds_read_b64_tr_b16 v[80:81], v112 offset:32768
    v_mfma_f32_16x16x32_bf16 v[32:35], v[100:103], a[52:55], v[32:35]
    ds_read_b64_tr_b16 v[82:83], v112 offset:33792
    v_mfma_f32_16x16x32_bf16 v[36:39], v[100:103], a[56:59], v[36:39]
    ds_read_b64_tr_b16 v[84:85], v113 offset:32768
    s_waitcnt lgkmcnt(5)
    v_mfma_f32_16x16x32_bf16 v[40:43], v[104:107], a[48:51], v[40:43]
    ds_read_b64_tr_b16 v[86:87], v113 offset:33792
    v_mfma_f32_16x16x32_bf16 v[44:47], v[104:107], a[52:55], v[44:47]
    ds_read_b64_tr_b16 v[88:89], v114 offset:32768
    v_mfma_f32_16x16x32_bf16 v[48:51], v[104:107], a[56:59], v[48:51]
    ds_read_b64_tr_b16 v[90:91], v114 offset:33792
    s_waitcnt lgkmcnt(6)
    v_mfma_f32_16x16x32_bf16 v[52:55], v[108:111], a[48:51], v[52:55]
    ds_read_b64_tr_b16 v[92:93], v115 offset:32768
    v_mfma_f32_16x16x32_bf16 v[56:59], v[108:111], a[52:55], v[56:59]
    ds_read_b64_tr_b16 v[94:95], v115 offset:33792
    v_mfma_f32_16x16x32_bf16 v[60:63], v[108:111], a[56:59], v[60:63]
    s_waitcnt vmcnt(16) lgkmcnt(6)
    v_mfma_f32_16x16x32_bf16 v[16:19], v[80:83], a[64:67], v[16:19]
    s_add_u32 s64, s69, s49
    buffer_load_dwordx4 a[48:51], v144, s[24:27], s64 offen sc1
    s_waitcnt vmcnt(16)
    v_mfma_f32_16x16x32_bf16 v[20:23], v[80:83], a[68:71], v[20:23]
    buffer_load_dwordx4 a[52:55], v145, s[24:27], s64 offen sc1
    s_waitcnt vmcnt(16)
    v_mfma_f32_16x16x32_bf16 v[24:27], v[80:83], a[72:75], v[24:27]
    buffer_load_dwordx4 a[56:59], v146, s[24:27], s64 offen sc1
    s_waitcnt vmcnt(16)
    v_mfma_f32_16x16x32_bf16 v[64:67], v[80:83], a[76:79], v[64:67]
    ds_read_b64_tr_b16 v[96:97], v116 offset:32768
    s_waitcnt lgkmcnt(5)
    v_mfma_f32_16x16x32_bf16 v[28:31], v[84:87], a[64:67], v[28:31]
    ds_read_b64_tr_b16 v[98:99], v116 offset:33792
    v_mfma_f32_16x16x32_bf16 v[32:35], v[84:87], a[68:71], v[32:35]
    v_mfma_f32_16x16x32_bf16 v[36:39], v[84:87], a[72:75], v[36:39]
    ds_read_b64_tr_b16 v[100:101], v117 offset:32768
    v_mfma_f32_16x16x32_bf16 v[68:71], v[84:87], a[76:79], v[68:71]
    ds_read_b64_tr_b16 v[102:103], v117 offset:33792
    s_waitcnt lgkmcnt(6)
    v_mfma_f32_16x16x32_bf16 v[40:43], v[88:91], a[64:67], v[40:43]
    v_mfma_f32_16x16x32_bf16 v[44:47], v[88:91], a[68:71], v[44:47]
    ds_read_b64_tr_b16 v[104:105], v118 offset:32768
    v_mfma_f32_16x16x32_bf16 v[48:51], v[88:91], a[72:75], v[48:51]
    ds_read_b64_tr_b16 v[106:107], v118 offset:33792
    v_mfma_f32_16x16x32_bf16 v[72:75], v[88:91], a[76:79], v[72:75]
    s_waitcnt lgkmcnt(6)
    v_mfma_f32_16x16x32_bf16 v[52:55], v[92:95], a[64:67], v[52:55]
    ds_read_b64_tr_b16 v[108:109], v119 offset:32768
    v_mfma_f32_16x16x32_bf16 v[56:59], v[92:95], a[68:71], v[56:59]
    ds_read_b64_tr_b16 v[110:111], v119 offset:33792
    v_mfma_f32_16x16x32_bf16 v[60:63], v[92:95], a[72:75], v[60:63]
    v_mfma_f32_16x16x32_bf16 v[76:79], v[92:95], a[76:79], v[76:79]
    s_waitcnt vmcnt(15) lgkmcnt(6)
    v_mfma_f32_16x16x32_bf16 v[16:19], v[96:99], a[80:83], v[16:19]
    s_add_u32 s64, s69, s50
    buffer_load_dwordx4 a[64:67], v144, s[24:27], s64 offen sc1
    s_waitcnt vmcnt(15)
    v_mfma_f32_16x16x32_bf16 v[20:23], v[96:99], a[84:87], v[20:23]
    buffer_load_dwordx4 a[68:71], v145, s[24:27], s64 offen sc1
    s_waitcnt vmcnt(15)
    v_mfma_f32_16x16x32_bf16 v[24:27], v[96:99], a[88:91], v[24:27]
    buffer_load_dwordx4 a[72:75], v146, s[24:27], s64 offen sc1
    s_waitcnt lgkmcnt(4)
    v_mfma_f32_16x16x32_bf16 v[28:31], v[100:103], a[80:83], v[28:31]
    ds_read_b64_tr_b16 v[80:81], v120 offset:32768
    v_mfma_f32_16x16x32_bf16 v[32:35], v[100:103], a[84:87], v[32:35]
    ds_read_b64_tr_b16 v[82:83], v120 offset:33792
    v_mfma_f32_16x16x32_bf16 v[36:39], v[100:103], a[88:91], v[36:39]
    ds_read_b64_tr_b16 v[84:85], v121 offset:32768
    s_waitcnt lgkmcnt(5)
    v_mfma_f32_16x16x32_bf16 v[40:43], v[104:107], a[80:83], v[40:43]
    ds_read_b64_tr_b16 v[86:87], v121 offset:33792
    v_mfma_f32_16x16x32_bf16 v[44:47], v[104:107], a[84:87], v[44:47]
    ds_read_b64_tr_b16 v[88:89], v122 offset:32768
    v_mfma_f32_16x16x32_bf16 v[48:51], v[104:107], a[88:91], v[48:51]
    ds_read_b64_tr_b16 v[90:91], v122 offset:33792
    s_waitcnt lgkmcnt(6)
    v_mfma_f32_16x16x32_bf16 v[52:55], v[108:111], a[80:83], v[52:55]
    ds_read_b64_tr_b16 v[92:93], v123 offset:32768
    v_mfma_f32_16x16x32_bf16 v[56:59], v[108:111], a[84:87], v[56:59]
    ds_read_b64_tr_b16 v[94:95], v123 offset:33792
    v_mfma_f32_16x16x32_bf16 v[60:63], v[108:111], a[88:91], v[60:63]
    s_waitcnt vmcnt(15) lgkmcnt(6)
    v_mfma_f32_16x16x32_bf16 v[16:19], v[80:83], a[0:3], v[16:19]
    s_add_u32 s64, s69, s51
    buffer_load_dwordx4 a[80:83], v144, s[24:27], s64 offen sc1
    s_waitcnt vmcnt(15)
    v_mfma_f32_16x16x32_bf16 v[20:23], v[80:83], a[4:7], v[20:23]
    buffer_load_dwordx4 a[84:87], v145, s[24:27], s64 offen sc1
    s_waitcnt vmcnt(15)
    v_mfma_f32_16x16x32_bf16 v[24:27], v[80:83], a[8:11], v[24:27]
    buffer_load_dwordx4 a[88:91], v146, s[24:27], s64 offen sc1
    s_waitcnt lgkmcnt(4)
    v_mfma_f32_16x16x32_bf16 v[28:31], v[84:87], a[0:3], v[28:31]
    ds_read_b64_tr_b16 v[96:97], v124 offset:32768
    v_mfma_f32_16x16x32_bf16 v[32:35], v[84:87], a[4:7], v[32:35]
    ds_read_b64_tr_b16 v[98:99], v124 offset:33792
    v_mfma_f32_16x16x32_bf16 v[36:39], v[84:87], a[8:11], v[36:39]
    ds_read_b64_tr_b16 v[100:101], v125 offset:32768
    s_waitcnt lgkmcnt(5)
    v_mfma_f32_16x16x32_bf16 v[40:43], v[88:91], a[0:3], v[40:43]
    ds_read_b64_tr_b16 v[102:103], v125 offset:33792
    v_mfma_f32_16x16x32_bf16 v[44:47], v[88:91], a[4:7], v[44:47]
    ds_read_b64_tr_b16 v[104:105], v126 offset:32768
    v_mfma_f32_16x16x32_bf16 v[48:51], v[88:91], a[8:11], v[48:51]
    ds_read_b64_tr_b16 v[106:107], v126 offset:33792
    s_waitcnt lgkmcnt(6)
    v_mfma_f32_16x16x32_bf16 v[52:55], v[92:95], a[0:3], v[52:55]
    ds_read_b64_tr_b16 v[108:109], v127 offset:32768
    v_mfma_f32_16x16x32_bf16 v[56:59], v[92:95], a[4:7], v[56:59]
    ds_read_b64_tr_b16 v[110:111], v127 offset:33792
    v_mfma_f32_16x16x32_bf16 v[60:63], v[92:95], a[8:11], v[60:63]
    s_waitcnt vmcnt(15) lgkmcnt(6)
    v_mfma_f32_16x16x32_bf16 v[16:19], v[96:99], a[16:19], v[16:19]
    s_add_u32 s69, s67, 6
    s_and_b32 s69, s69, 7
    s_lshl_b32 s69, s69, 12
    s_add_u32 s69, s69, s53
    s_waitcnt vmcnt(14)
    v_mfma_f32_16x16x32_bf16 v[20:23], v[96:99], a[20:23], v[20:23]
    s_add_u32 s64, s69, s48
    buffer_load_dwordx4 a[0:3], v144, s[24:27], s64 offen sc1
    s_waitcnt vmcnt(14)
    v_mfma_f32_16x16x32_bf16 v[24:27], v[96:99], a[24:27], v[24:27]
    buffer_load_dwordx4 a[4:7], v145, s[24:27], s64 offen sc1
    buffer_load_dwordx4 a[8:11], v146, s[24:27], s64 offen sc1
    s_waitcnt lgkmcnt(4)
    v_mfma_f32_16x16x32_bf16 v[28:31], v[100:103], a[16:19], v[28:31]
    buffer_load_dwordx4 a[12:15], v147, s[24:27], s64 offen sc1
    ds_read_b64_tr_b16 v[80:81], v112 offset:49152
    v_mfma_f32_16x16x32_bf16 v[32:35], v[100:103], a[20:23], v[32:35]
    ds_read_b64_tr_b16 v[82:83], v112 offset:50176
    v_mfma_f32_16x16x32_bf16 v[36:39], v[100:103], a[24:27], v[36:39]
    ds_read_b64_tr_b16 v[84:85], v113 offset:49152
    s_waitcnt lgkmcnt(5)
    v_mfma_f32_16x16x32_bf16 v[40:43], v[104:107], a[16:19], v[40:43]
    ds_read_b64_tr_b16 v[86:87], v113 offset:50176
    v_mfma_f32_16x16x32_bf16 v[44:47], v[104:107], a[20:23], v[44:47]
    ds_read_b64_tr_b16 v[88:89], v114 offset:49152
    v_mfma_f32_16x16x32_bf16 v[48:51], v[104:107], a[24:27], v[48:51]
    ds_read_b64_tr_b16 v[90:91], v114 offset:50176
    s_waitcnt lgkmcnt(6)
    v_mfma_f32_16x16x32_bf16 v[52:55], v[108:111], a[16:19], v[52:55]
    ds_read_b64_tr_b16 v[92:93], v115 offset:49152
    v_mfma_f32_16x16x32_bf16 v[56:59], v[108:111], a[20:23], v[56:59]
    ds_read_b64_tr_b16 v[94:95], v115 offset:50176
    v_mfma_f32_16x16x32_bf16 v[60:63], v[108:111], a[24:27], v[60:63]
    s_waitcnt vmcnt(16) lgkmcnt(6)
    v_mfma_f32_16x16x32_bf16 v[16:19], v[80:83], a[32:35], v[16:19]
    s_add_u32 s64, s69, s49
    buffer_load_dwordx4 a[16:19], v144, s[24:27], s64 offen sc1
    s_waitcnt vmcnt(16)
    v_mfma_f32_16x16x32_bf16 v[20:23], v[80:83], a[36:39], v[20:23]
    buffer_load_dwordx4 a[20:23], v145, s[24:27], s64 offen sc1
    s_waitcnt vmcnt(16)
    v_mfma_f32_16x16x32_bf16 v[24:27], v[80:83], a[40:43], v[24:27]
    buffer_load_dwordx4 a[24:27], v146, s[24:27], s64 offen sc1
    s_waitcnt vmcnt(16)
    v_mfma_f32_16x16x32_bf16 v[64:67], v[80:83], a[44:47], v[64:67]
    ds_read_b64_tr_b16 v[96:97], v116 offset:49152
    s_waitcnt lgkmcnt(5)
    v_mfma_f32_16x16x32_bf16 v[28:31], v[84:87], a[32:35], v[28:31]
    ds_read_b64_tr_b16 v[98:99], v116 offset:50176
    v_mfma_f32_16x16x32_bf16 v[32:35], v[84:87], a[36:39], v[32:35]
    v_mfma_f32_16x16x32_bf16 v[36:39], v[84:87], a[40:43], v[36:39]
    ds_read_b64_tr_b16 v[100:101], v117 offset:49152
    v_mfma_f32_16x16x32_bf16 v[68:71], v[84:87], a[44:47], v[68:71]
    ds_read_b64_tr_b16 v[102:103], v117 offset:50176
    s_waitcnt lgkmcnt(6)
    v_mfma_f32_16x16x32_bf16 v[40:43], v[88:91], a[32:35], v[40:43]
    v_mfma_f32_16x16x32_bf16 v[44:47], v[88:91], a[36:39], v[44:47]
    ds_read_b64_tr_b16 v[104:105], v118 offset:49152
    v_mfma_f32_16x16x32_bf16 v[48:51], v[88:91], a[40:43], v[48:51]
    ds_read_b64_tr_b16 v[106:107], v118 offset:50176
    v_mfma_f32_16x16x32_bf16 v[72:75], v[88:91], a[44:47], v[72:75]
    s_waitcnt lgkmcnt(6)
    v_mfma_f32_16x16x32_bf16 v[52:55], v[92:95], a[32:35], v[52:55]
    ds_read_b64_tr_b16 v[108:109], v119 offset:49152
    v_mfma_f32_16x16x32_bf16 v[56:59], v[92:95], a[36:39], v[56:59]
    ds_read_b64_tr_b16 v[110:111], v119 offset:50176
    v_mfma_f32_16x16x32_bf16 v[60:63], v[92:95], a[40:43], v[60:63]
    v_mfma_f32_16x16x32_bf16 v[76:79], v[92:95], a[44:47], v[76:79]
    s_waitcnt vmcnt(15) lgkmcnt(6)
    v_mfma_f32_16x16x32_bf16 v[16:19], v[96:99], a[48:51], v[16:19]
    s_add_u32 s64, s69, s50
    buffer_load_dwordx4 a[32:35], v144, s[24:27], s64 offen sc1
    s_waitcnt vmcnt(15)
    v_mfma_f32_16x16x32_bf16 v[20:23], v[96:99], a[52:55], v[20:23]
    buffer_load_dwordx4 a[36:39], v145, s[24:27], s64 offen sc1
    s_waitcnt vmcnt(15)
    v_mfma_f32_16x16x32_bf16 v[24:27], v[96:99], a[56:59], v[24:27]
    buffer_load_dwordx4 a[40:43], v146, s[24:27], s64 offen sc1
    s_waitcnt lgkmcnt(4)
    v_mfma_f32_16x16x32_bf16 v[28:31], v[100:103], a[48:51], v[28:31]
    ds_read_b64_tr_b16 v[80:81], v120 offset:49152
    v_mfma_f32_16x16x32_bf16 v[32:35], v[100:103], a[52:55], v[32:35]
    ds_read_b64_tr_b16 v[82:83], v120 offset:50176
    v_mfma_f32_16x16x32_bf16 v[36:39], v[100:103], a[56:59], v[36:39]
    ds_read_b64_tr_b16 v[84:85], v121 offset:49152
    s_waitcnt lgkmcnt(5)
    v_mfma_f32_16x16x32_bf16 v[40:43], v[104:107], a[48:51], v[40:43]
    ds_read_b64_tr_b16 v[86:87], v121 offset:50176
    v_mfma_f32_16x16x32_bf16 v[44:47], v[104:107], a[52:55], v[44:47]
    ds_read_b64_tr_b16 v[88:89], v122 offset:49152
    v_mfma_f32_16x16x32_bf16 v[48:51], v[104:107], a[56:59], v[48:51]
    ds_read_b64_tr_b16 v[90:91], v122 offset:50176
    s_waitcnt lgkmcnt(6)
    v_mfma_f32_16x16x32_bf16 v[52:55], v[108:111], a[48:51], v[52:55]
    ds_read_b64_tr_b16 v[92:93], v123 offset:49152
    v_mfma_f32_16x16x32_bf16 v[56:59], v[108:111], a[52:55], v[56:59]
    ds_read_b64_tr_b16 v[94:95], v123 offset:50176
    v_mfma_f32_16x16x32_bf16 v[60:63], v[108:111], a[56:59], v[60:63]
    s_waitcnt vmcnt(15) lgkmcnt(6)
    v_mfma_f32_16x16x32_bf16 v[16:19], v[80:83], a[64:67], v[16:19]
    s_add_u32 s64, s69, s51
    buffer_load_dwordx4 a[48:51], v144, s[24:27], s64 offen sc1
    s_waitcnt vmcnt(15)
    v_mfma_f32_16x16x32_bf16 v[20:23], v[80:83], a[68:71], v[20:23]
    buffer_load_dwordx4 a[52:55], v145, s[24:27], s64 offen sc1
    s_waitcnt vmcnt(15)
    v_mfma_f32_16x16x32_bf16 v[24:27], v[80:83], a[72:75], v[24:27]
    buffer_load_dwordx4 a[56:59], v146, s[24:27], s64 offen sc1
    s_waitcnt lgkmcnt(4)
    v_mfma_f32_16x16x32_bf16 v[28:31], v[84:87], a[64:67], v[28:31]
    ds_read_b64_tr_b16 v[96:97], v124 offset:49152
    v_mfma_f32_16x16x32_bf16 v[32:35], v[84:87], a[68:71], v[32:35]
    ds_read_b64_tr_b16 v[98:99], v124 offset:50176
    v_mfma_f32_16x16x32_bf16 v[36:39], v[84:87], a[72:75], v[36:39]
    ds_read_b64_tr_b16 v[100:101], v125 offset:49152
    s_waitcnt lgkmcnt(5)
    v_mfma_f32_16x16x32_bf16 v[40:43], v[88:91], a[64:67], v[40:43]
    ds_read_b64_tr_b16 v[102:103], v125 offset:50176
    v_mfma_f32_16x16x32_bf16 v[44:47], v[88:91], a[68:71], v[44:47]
    ds_read_b64_tr_b16 v[104:105], v126 offset:49152
    v_mfma_f32_16x16x32_bf16 v[48:51], v[88:91], a[72:75], v[48:51]
    ds_read_b64_tr_b16 v[106:107], v126 offset:50176
    s_waitcnt lgkmcnt(6)
    v_mfma_f32_16x16x32_bf16 v[52:55], v[92:95], a[64:67], v[52:55]
    ds_read_b64_tr_b16 v[108:109], v127 offset:49152
    v_mfma_f32_16x16x32_bf16 v[56:59], v[92:95], a[68:71], v[56:59]
    ds_read_b64_tr_b16 v[110:111], v127 offset:50176
    v_mfma_f32_16x16x32_bf16 v[60:63], v[92:95], a[72:75], v[60:63]
    v_add_u32 v112, 65536, v128
    v_add_u32 v113, 65536, v129
    v_add_u32 v114, 65536, v130
    v_add_u32 v115, 65536, v131
    v_add_u32 v116, 65536, v132
    v_add_u32 v117, 65536, v133
    v_add_u32 v118, 65536, v134
    v_add_u32 v119, 65536, v135
    v_add_u32 v120, 65536, v136
    v_add_u32 v121, 65536, v137
    v_add_u32 v122, 65536, v138
    v_add_u32 v123, 65536, v139
    v_add_u32 v124, 65536, v140
    v_add_u32 v125, 65536, v141
    v_add_u32 v126, 65536, v142
    v_add_u32 v127, 65536, v143
    s_waitcnt vmcnt(15) lgkmcnt(6)
    v_mfma_f32_16x16x32_bf16 v[16:19], v[96:99], a[80:83], v[16:19]
    s_add_u32 s69, s67, 7
    s_and_b32 s69, s69, 7
    s_lshl_b32 s69, s69, 12
    s_add_u32 s69, s69, s53
    s_waitcnt vmcnt(14)
    v_mfma_f32_16x16x32_bf16 v[20:23], v[96:99], a[84:87], v[20:23]
    s_add_u32 s64, s69, s48
    buffer_load_dwordx4 a[64:67], v144, s[24:27], s64 offen sc1
    s_waitcnt vmcnt(14)
    v_mfma_f32_16x16x32_bf16 v[24:27], v[96:99], a[88:91], v[24:27]
    buffer_load_dwordx4 a[68:71], v145, s[24:27], s64 offen sc1
    buffer_load_dwordx4 a[72:75], v146, s[24:27], s64 offen sc1
    s_waitcnt lgkmcnt(4)
    v_mfma_f32_16x16x32_bf16 v[28:31], v[100:103], a[80:83], v[28:31]
    buffer_load_dwordx4 a[76:79], v147, s[24:27], s64 offen sc1
    ds_read_b64_tr_b16 v[80:81], v112
    v_mfma_f32_16x16x32_bf16 v[32:35], v[100:103], a[84:87], v[32:35]
    ds_read_b64_tr_b16 v[82:83], v112 offset:1024
    v_mfma_f32_16x16x32_bf16 v[36:39], v[100:103], a[88:91], v[36:39]
    ds_read_b64_tr_b16 v[84:85], v113
    s_waitcnt lgkmcnt(5)
    v_mfma_f32_16x16x32_bf16 v[40:43], v[104:107], a[80:83], v[40:43]
    ds_read_b64_tr_b16 v[86:87], v113 offset:1024
    v_mfma_f32_16x16x32_bf16 v[44:47], v[104:107], a[84:87], v[44:47]
    ds_read_b64_tr_b16 v[88:89], v114
    v_mfma_f32_16x16x32_bf16 v[48:51], v[104:107], a[88:91], v[48:51]
    ds_read_b64_tr_b16 v[90:91], v114 offset:1024
    s_waitcnt lgkmcnt(6)
    v_mfma_f32_16x16x32_bf16 v[52:55], v[108:111], a[80:83], v[52:55]
    ds_read_b64_tr_b16 v[92:93], v115
    v_mfma_f32_16x16x32_bf16 v[56:59], v[108:111], a[84:87], v[56:59]
    ds_read_b64_tr_b16 v[94:95], v115 offset:1024
    v_mfma_f32_16x16x32_bf16 v[60:63], v[108:111], a[88:91], v[60:63]
    s_waitcnt vmcnt(16) lgkmcnt(6)
    v_mfma_f32_16x16x32_bf16 v[16:19], v[80:83], a[0:3], v[16:19]
    s_add_u32 s64, s69, s49
    buffer_load_dwordx4 a[80:83], v144, s[24:27], s64 offen sc1
    s_waitcnt vmcnt(16)
    v_mfma_f32_16x16x32_bf16 v[20:23], v[80:83], a[4:7], v[20:23]
    buffer_load_dwordx4 a[84:87], v145, s[24:27], s64 offen sc1
    s_waitcnt vmcnt(16)
    v_mfma_f32_16x16x32_bf16 v[24:27], v[80:83], a[8:11], v[24:27]
    buffer_load_dwordx4 a[88:91], v146, s[24:27], s64 offen sc1
    s_waitcnt vmcnt(16)
    v_mfma_f32_16x16x32_bf16 v[64:67], v[80:83], a[12:15], v[64:67]
    ds_read_b64_tr_b16 v[96:97], v116
    s_waitcnt lgkmcnt(5)
    v_mfma_f32_16x16x32_bf16 v[28:31], v[84:87], a[0:3], v[28:31]
    ds_read_b64_tr_b16 v[98:99], v116 offset:1024
    v_mfma_f32_16x16x32_bf16 v[32:35], v[84:87], a[4:7], v[32:35]
    v_mfma_f32_16x16x32_bf16 v[36:39], v[84:87], a[8:11], v[36:39]
    ds_read_b64_tr_b16 v[100:101], v117
    v_mfma_f32_16x16x32_bf16 v[68:71], v[84:87], a[12:15], v[68:71]
    ds_read_b64_tr_b16 v[102:103], v117 offset:1024
    s_waitcnt lgkmcnt(6)
    v_mfma_f32_16x16x32_bf16 v[40:43], v[88:91], a[0:3], v[40:43]
    v_mfma_f32_16x16x32_bf16 v[44:47], v[88:91], a[4:7], v[44:47]
    ds_read_b64_tr_b16 v[104:105], v118
    v_mfma_f32_16x16x32_bf16 v[48:51], v[88:91], a[8:11], v[48:51]
    ds_read_b64_tr_b16 v[106:107], v118 offset:1024
    v_mfma_f32_16x16x32_bf16 v[72:75], v[88:91], a[12:15], v[72:75]
    s_waitcnt lgkmcnt(6)
    v_mfma_f32_16x16x32_bf16 v[52:55], v[92:95], a[0:3], v[52:55]
    ds_read_b64_tr_b16 v[108:109], v119
    v_mfma_f32_16x16x32_bf16 v[56:59], v[92:95], a[4:7], v[56:59]
    ds_read_b64_tr_b16 v[110:111], v119 offset:1024
    v_mfma_f32_16x16x32_bf16 v[60:63], v[92:95], a[8:11], v[60:63]
    v_mfma_f32_16x16x32_bf16 v[76:79], v[92:95], a[12:15], v[76:79]
    s_waitcnt vmcnt(15) lgkmcnt(6)
    v_mfma_f32_16x16x32_bf16 v[16:19], v[96:99], a[16:19], v[16:19]
    s_add_u32 s64, s69, s50
    buffer_load_dwordx4 a[0:3], v144, s[24:27], s64 offen sc1
    s_waitcnt vmcnt(15)
    v_mfma_f32_16x16x32_bf16 v[20:23], v[96:99], a[20:23], v[20:23]
    buffer_load_dwordx4 a[4:7], v145, s[24:27], s64 offen sc1
    s_waitcnt vmcnt(15)
    v_mfma_f32_16x16x32_bf16 v[24:27], v[96:99], a[24:27], v[24:27]
    buffer_load_dwordx4 a[8:11], v146, s[24:27], s64 offen sc1
    s_waitcnt lgkmcnt(4)
    v_mfma_f32_16x16x32_bf16 v[28:31], v[100:103], a[16:19], v[28:31]
    ds_read_b64_tr_b16 v[80:81], v120
    v_mfma_f32_16x16x32_bf16 v[32:35], v[100:103], a[20:23], v[32:35]
    ds_read_b64_tr_b16 v[82:83], v120 offset:1024
    v_mfma_f32_16x16x32_bf16 v[36:39], v[100:103], a[24:27], v[36:39]
    ds_read_b64_tr_b16 v[84:85], v121
    s_waitcnt lgkmcnt(5)
    v_mfma_f32_16x16x32_bf16 v[40:43], v[104:107], a[16:19], v[40:43]
    ds_read_b64_tr_b16 v[86:87], v121 offset:1024
    v_mfma_f32_16x16x32_bf16 v[44:47], v[104:107], a[20:23], v[44:47]
    ds_read_b64_tr_b16 v[88:89], v122
    v_mfma_f32_16x16x32_bf16 v[48:51], v[104:107], a[24:27], v[48:51]
    ds_read_b64_tr_b16 v[90:91], v122 offset:1024
    s_waitcnt lgkmcnt(6)
    v_mfma_f32_16x16x32_bf16 v[52:55], v[108:111], a[16:19], v[52:55]
    ds_read_b64_tr_b16 v[92:93], v123
    v_mfma_f32_16x16x32_bf16 v[56:59], v[108:111], a[20:23], v[56:59]
    ds_read_b64_tr_b16 v[94:95], v123 offset:1024
    v_mfma_f32_16x16x32_bf16 v[60:63], v[108:111], a[24:27], v[60:63]
    s_waitcnt vmcnt(15) lgkmcnt(6)
    v_mfma_f32_16x16x32_bf16 v[16:19], v[80:83], a[32:35], v[16:19]
    s_add_u32 s64, s69, s51
    buffer_load_dwordx4 a[16:19], v144, s[24:27], s64 offen sc1
    s_waitcnt vmcnt(15)
    v_mfma_f32_16x16x32_bf16 v[20:23], v[80:83], a[36:39], v[20:23]
    buffer_load_dwordx4 a[20:23], v145, s[24:27], s64 offen sc1
    s_waitcnt vmcnt(15)
    v_mfma_f32_16x16x32_bf16 v[24:27], v[80:83], a[40:43], v[24:27]
    buffer_load_dwordx4 a[24:27], v146, s[24:27], s64 offen sc1
    s_waitcnt lgkmcnt(4)
    v_mfma_f32_16x16x32_bf16 v[28:31], v[84:87], a[32:35], v[28:31]
    ds_read_b64_tr_b16 v[96:97], v124
    v_mfma_f32_16x16x32_bf16 v[32:35], v[84:87], a[36:39], v[32:35]
    ds_read_b64_tr_b16 v[98:99], v124 offset:1024
    buffer_load_dword v157, v151, s[8:11], 0 offen sc1
    v_mfma_f32_16x16x32_bf16 v[36:39], v[84:87], a[40:43], v[36:39]
    ds_read_b64_tr_b16 v[100:101], v125
    s_waitcnt lgkmcnt(5)
    v_mfma_f32_16x16x32_bf16 v[40:43], v[88:91], a[32:35], v[40:43]
    ds_read_b64_tr_b16 v[102:103], v125 offset:1024
    v_mfma_f32_16x16x32_bf16 v[44:47], v[88:91], a[36:39], v[44:47]
    ds_read_b64_tr_b16 v[104:105], v126
    v_mfma_f32_16x16x32_bf16 v[48:51], v[88:91], a[40:43], v[48:51]
    ds_read_b64_tr_b16 v[106:107], v126 offset:1024
    s_waitcnt lgkmcnt(6)
    v_mfma_f32_16x16x32_bf16 v[52:55], v[92:95], a[32:35], v[52:55]
    ds_read_b64_tr_b16 v[108:109], v127
    v_mfma_f32_16x16x32_bf16 v[56:59], v[92:95], a[36:39], v[56:59]
    ds_read_b64_tr_b16 v[110:111], v127 offset:1024
    v_mfma_f32_16x16x32_bf16 v[60:63], v[92:95], a[40:43], v[60:63]
    s_waitcnt vmcnt(16) lgkmcnt(6)
    v_mfma_f32_16x16x32_bf16 v[16:19], v[96:99], a[48:51], v[16:19]
    s_waitcnt vmcnt(15)
    v_mfma_f32_16x16x32_bf16 v[20:23], v[96:99], a[52:55], v[20:23]
    s_waitcnt vmcnt(14)
    v_mfma_f32_16x16x32_bf16 v[24:27], v[96:99], a[56:59], v[24:27]
    s_waitcnt lgkmcnt(4)
    v_mfma_f32_16x16x32_bf16 v[28:31], v[100:103], a[48:51], v[28:31]
    ds_read_b64_tr_b16 v[80:81], v112 offset:16384
    v_mfma_f32_16x16x32_bf16 v[32:35], v[100:103], a[52:55], v[32:35]
    ds_read_b64_tr_b16 v[82:83], v112 offset:17408
    v_mfma_f32_16x16x32_bf16 v[36:39], v[100:103], a[56:59], v[36:39]
    ds_read_b64_tr_b16 v[84:85], v113 offset:16384
    s_waitcnt lgkmcnt(5)
    v_mfma_f32_16x16x32_bf16 v[40:43], v[104:107], a[48:51], v[40:43]
    ds_read_b64_tr_b16 v[86:87], v113 offset:17408
    v_mfma_f32_16x16x32_bf16 v[44:47], v[104:107], a[52:55], v[44:47]
    ds_read_b64_tr_b16 v[88:89], v114 offset:16384
    v_mfma_f32_16x16x32_bf16 v[48:51], v[104:107], a[56:59], v[48:51]
    ds_read_b64_tr_b16 v[90:91], v114 offset:17408
    s_waitcnt lgkmcnt(6)
    v_mfma_f32_16x16x32_bf16 v[52:55], v[108:111], a[48:51], v[52:55]
    ds_read_b64_tr_b16 v[92:93], v115 offset:16384
    v_mfma_f32_16x16x32_bf16 v[56:59], v[108:111], a[52:55], v[56:59]
    ds_read_b64_tr_b16 v[94:95], v115 offset:17408
    v_mfma_f32_16x16x32_bf16 v[60:63], v[108:111], a[56:59], v[60:63]
    s_waitcnt vmcnt(13) lgkmcnt(6)
    v_mfma_f32_16x16x32_bf16 v[16:19], v[80:83], a[64:67], v[16:19]
    s_waitcnt vmcnt(12)
    v_mfma_f32_16x16x32_bf16 v[20:23], v[80:83], a[68:71], v[20:23]
    s_waitcnt vmcnt(11)
    v_mfma_f32_16x16x32_bf16 v[24:27], v[80:83], a[72:75], v[24:27]
    s_waitcnt vmcnt(10)
    v_mfma_f32_16x16x32_bf16 v[64:67], v[80:83], a[76:79], v[64:67]
    ds_read_b64_tr_b16 v[96:97], v116 offset:16384
    s_waitcnt lgkmcnt(5)
    v_mfma_f32_16x16x32_bf16 v[28:31], v[84:87], a[64:67], v[28:31]
    ds_read_b64_tr_b16 v[98:99], v116 offset:17408
    v_mfma_f32_16x16x32_bf16 v[32:35], v[84:87], a[68:71], v[32:35]
    v_mfma_f32_16x16x32_bf16 v[36:39], v[84:87], a[72:75], v[36:39]
    ds_read_b64_tr_b16 v[100:101], v117 offset:16384
    v_mfma_f32_16x16x32_bf16 v[68:71], v[84:87], a[76:79], v[68:71]
    ds_read_b64_tr_b16 v[102:103], v117 offset:17408
    s_waitcnt lgkmcnt(6)
    v_mfma_f32_16x16x32_bf16 v[40:43], v[88:91], a[64:67], v[40:43]
    v_mfma_f32_16x16x32_bf16 v[44:47], v[88:91], a[68:71], v[44:47]
    ds_read_b64_tr_b16 v[104:105], v118 offset:16384
    v_mfma_f32_16x16x32_bf16 v[48:51], v[88:91], a[72:75], v[48:51]
    ds_read_b64_tr_b16 v[106:107], v118 offset:17408
    v_mfma_f32_16x16x32_bf16 v[72:75], v[88:91], a[76:79], v[72:75]
    s_waitcnt lgkmcnt(6)
    v_mfma_f32_16x16x32_bf16 v[52:55], v[92:95], a[64:67], v[52:55]
    ds_read_b64_tr_b16 v[108:109], v119 offset:16384
    v_mfma_f32_16x16x32_bf16 v[56:59], v[92:95], a[68:71], v[56:59]
    ds_read_b64_tr_b16 v[110:111], v119 offset:17408
    v_mfma_f32_16x16x32_bf16 v[60:63], v[92:95], a[72:75], v[60:63]
    v_mfma_f32_16x16x32_bf16 v[76:79], v[92:95], a[76:79], v[76:79]
    s_waitcnt vmcnt(9) lgkmcnt(6)
    v_mfma_f32_16x16x32_bf16 v[16:19], v[96:99], a[80:83], v[16:19]
    s_waitcnt vmcnt(8)
    v_mfma_f32_16x16x32_bf16 v[20:23], v[96:99], a[84:87], v[20:23]
    s_waitcnt vmcnt(7)
    v_mfma_f32_16x16x32_bf16 v[24:27], v[96:99], a[88:91], v[24:27]
    s_waitcnt lgkmcnt(4)
    v_mfma_f32_16x16x32_bf16 v[28:31], v[100:103], a[80:83], v[28:31]
    ds_read_b64_tr_b16 v[80:81], v120 offset:16384
    v_mfma_f32_16x16x32_bf16 v[32:35], v[100:103], a[84:87], v[32:35]
    ds_read_b64_tr_b16 v[82:83], v120 offset:17408
    v_mfma_f32_16x16x32_bf16 v[36:39], v[100:103], a[88:91], v[36:39]
    ds_read_b64_tr_b16 v[84:85], v121 offset:16384
    s_waitcnt lgkmcnt(5)
    v_mfma_f32_16x16x32_bf16 v[40:43], v[104:107], a[80:83], v[40:43]
    ds_read_b64_tr_b16 v[86:87], v121 offset:17408
    v_mfma_f32_16x16x32_bf16 v[44:47], v[104:107], a[84:87], v[44:47]
    ds_read_b64_tr_b16 v[88:89], v122 offset:16384
    v_mfma_f32_16x16x32_bf16 v[48:51], v[104:107], a[88:91], v[48:51]
    ds_read_b64_tr_b16 v[90:91], v122 offset:17408
    s_waitcnt lgkmcnt(6)
    v_mfma_f32_16x16x32_bf16 v[52:55], v[108:111], a[80:83], v[52:55]
    ds_read_b64_tr_b16 v[92:93], v123 offset:16384
    v_mfma_f32_16x16x32_bf16 v[56:59], v[108:111], a[84:87], v[56:59]
    ds_read_b64_tr_b16 v[94:95], v123 offset:17408
    v_mfma_f32_16x16x32_bf16 v[60:63], v[108:111], a[88:91], v[60:63]
    s_waitcnt vmcnt(6) lgkmcnt(6)
    v_mfma_f32_16x16x32_bf16 v[16:19], v[80:83], a[0:3], v[16:19]
    s_waitcnt vmcnt(5)
    v_mfma_f32_16x16x32_bf16 v[20:23], v[80:83], a[4:7], v[20:23]
    s_waitcnt vmcnt(4)
    v_mfma_f32_16x16x32_bf16 v[24:27], v[80:83], a[8:11], v[24:27]
    s_waitcnt lgkmcnt(4)
    v_mfma_f32_16x16x32_bf16 v[28:31], v[84:87], a[0:3], v[28:31]
    ds_read_b64_tr_b16 v[96:97], v124 offset:16384
    v_mfma_f32_16x16x32_bf16 v[32:35], v[84:87], a[4:7], v[32:35]
    ds_read_b64_tr_b16 v[98:99], v124 offset:17408
    v_mfma_f32_16x16x32_bf16 v[36:39], v[84:87], a[8:11], v[36:39]
    ds_read_b64_tr_b16 v[100:101], v125 offset:16384
    s_waitcnt lgkmcnt(5)
    v_mfma_f32_16x16x32_bf16 v[40:43], v[88:91], a[0:3], v[40:43]
    ds_read_b64_tr_b16 v[102:103], v125 offset:17408
    v_mfma_f32_16x16x32_bf16 v[44:47], v[88:91], a[4:7], v[44:47]
    ds_read_b64_tr_b16 v[104:105], v126 offset:16384
    v_mfma_f32_16x16x32_bf16 v[48:51], v[88:91], a[8:11], v[48:51]
    ds_read_b64_tr_b16 v[106:107], v126 offset:17408
    s_waitcnt lgkmcnt(6)
    v_mfma_f32_16x16x32_bf16 v[52:55], v[92:95], a[0:3], v[52:55]
    ds_read_b64_tr_b16 v[108:109], v127 offset:16384
    v_mfma_f32_16x16x32_bf16 v[56:59], v[92:95], a[4:7], v[56:59]
    ds_read_b64_tr_b16 v[110:111], v127 offset:17408
    v_mfma_f32_16x16x32_bf16 v[60:63], v[92:95], a[8:11], v[60:63]
    s_waitcnt vmcnt(3) lgkmcnt(6)
    v_mfma_f32_16x16x32_bf16 v[16:19], v[96:99], a[16:19], v[16:19]
    s_waitcnt vmcnt(2)
    v_mfma_f32_16x16x32_bf16 v[20:23], v[96:99], a[20:23], v[20:23]
    s_waitcnt vmcnt(1)
    v_mfma_f32_16x16x32_bf16 v[24:27], v[96:99], a[24:27], v[24:27]
    s_waitcnt lgkmcnt(4)
    v_mfma_f32_16x16x32_bf16 v[28:31], v[100:103], a[16:19], v[28:31]
    v_mfma_f32_16x16x32_bf16 v[32:35], v[100:103], a[20:23], v[32:35]
    v_mfma_f32_16x16x32_bf16 v[36:39], v[100:103], a[24:27], v[36:39]
    s_waitcnt lgkmcnt(2)
    v_mfma_f32_16x16x32_bf16 v[40:43], v[104:107], a[16:19], v[40:43]
    v_mfma_f32_16x16x32_bf16 v[44:47], v[104:107], a[20:23], v[44:47]
    v_mfma_f32_16x16x32_bf16 v[48:51], v[104:107], a[24:27], v[48:51]
    s_waitcnt lgkmcnt(0)
    v_mfma_f32_16x16x32_bf16 v[52:55], v[108:111], a[16:19], v[52:55]
    v_mfma_f32_16x16x32_bf16 v[56:59], v[108:111], a[20:23], v[56:59]
    v_mfma_f32_16x16x32_bf16 v[60:63], v[108:111], a[24:27], v[60:63]
    s_waitcnt vmcnt(0)
    s_mov_b32 s45, 0
L_part:
    v_sub_u32 v11, v157, v150
    v_and_b32 v11, 3, v11
    v_cmp_ne_u32 vcc, 0, v11
    s_add_u32 s45, s45, 1
    s_nop 3
    s_cmp_eq_u64 vcc, -1
    s_cbranch_scc1 L_partok
    s_sleep 8
    buffer_load_dword v157, v151, s[8:11], 0 offen sc1
    s_waitcnt vmcnt(0)
    s_cmp_lt_u32 s45, 20000
    s_cbranch_scc1 L_part
L_partok:
    s_nop 7
    s_xor_b32 s48, s65, 8
    s_mul_i32 s48, s48, 24576
    s_add_u32 s48, s48, 0
    v_cvt_pk_bf16_f32 v80, v28, v29
    v_cvt_pk_bf16_f32 v81, v30, v31
    v_cvt_pk_bf16_f32 v82, v32, v33
    v_cvt_pk_bf16_f32 v83, v34, v35
    buffer_store_dwordx4 v[80:83], v156, s[32:35], s48 offen sc1
    v_cvt_pk_bf16_f32 v84, v36, v37
    v_cvt_pk_bf16_f32 v85, v38, v39
    v_cvt_pk_bf16_f32 v86, v68, v69
    v_cvt_pk_bf16_f32 v87, v70, v71
    buffer_store_dwordx4 v[84:87], v156, s[32:35], s48 offen offset:1024 sc1
    s_xor_b32 s49, s65, 16
    s_mul_i32 s49, s49, 24576
    s_add_u32 s49, s49, 8192
    v_cvt_pk_bf16_f32 v88, v40, v41
    v_cvt_pk_bf16_f32 v89, v42, v43
    v_cvt_pk_bf16_f32 v90, v44, v45
    v_cvt_pk_bf16_f32 v91, v46, v47
    buffer_store_dwordx4 v[88:91], v156, s[32:35], s49 offen sc1
    v_cvt_pk_bf16_f32 v92, v48, v49
    v_cvt_pk_bf16_f32 v93, v50, v51
    v_cvt_pk_bf16_f32 v94, v72, v73
    v_cvt_pk_bf16_f32 v95, v74, v75
    buffer_store_dwordx4 v[92:95], v156, s[32:35], s49 offen offset:1024 sc1
    s_xor_b32 s50, s65, 24
    s_mul_i32 s50, s50, 24576
    s_add_u32 s50, s50, 16384
    v_cvt_pk_bf16_f32 v96, v52, v53
    v_cvt_pk_bf16_f32 v97, v54, v55
    v_cvt_pk_bf16_f32 v98, v56, v57
    v_cvt_pk_bf16_f32 v99, v58, v59
    buffer_store_dwordx4 v[96:99], v156, s[32:35], s50 offen sc1
    v_cvt_pk_bf16_f32 v100, v60, v61
    v_cvt_pk_bf16_f32 v101, v62, v63
    v_cvt_pk_bf16_f32 v102, v76, v77
    v_cvt_pk_bf16_f32 v103, v78, v79
    buffer_store_dwordx4 v[100:103], v156, s[32:35], s50 offen offset:1024 sc1
    s_mul_i32 s44, s40, 208
    s_mul_i32 s45, s42, 48
    s_add_u32 s45, s44, s45
    s_lshl_b32 s45, s45, 10
    s_lshl_b32 s46, s67, 7
    s_lshl_b32 s47, s66, 5
    s_add_u32 s46, s46, s47
    s_add_u32 s45, s45, s46
    s_add_u32 s44, s44, 192
    s_lshl_b32 s44, s44, 10
    s_add_u32 s44, s44, s46
    s_cmp_eq_u32 s42, 0
    s_cselect_b32 s44, s44, 0x40000000
    v_and_b32 v12, 15, v1
    v_lshlrev_b32 v12, 10, v12
    v_lshrrev_b32 v13, 4, v1
    v_lshl_add_u32 v12, v13, 3, v12
    v_add_u32 v13, s44, v12
    v_add_u32 v12, s45, v12
    s_lshl_b32 s44, s42, 10
    s_add_u32 s44, s44, 98304
    v_add_u32 v14, s44, v8
    v_add_u32 v15, 98304, v8
    s_mul_i32 s48, s65, 24576
    s_add_u32 s49, s48, 8192
    s_add_u32 s50, s48, 16384
    s_mov_b32 s45, 0
L_poll2:
    buffer_load_dwordx4 v[160:163], v156, s[32:35], s48 offen sc1
    buffer_load_dwordx4 v[164:167], v156, s[32:35], s48 offen offset:1024 sc1
    buffer_load_dwordx4 v[168:171], v156, s[32:35], s49 offen sc1
    buffer_load_dwordx4 v[172:175], v156, s[32:35], s49 offen offset:1024 sc1
    buffer_load_dwordx4 v[176:179], v156, s[32:35], s50 offen sc1
    buffer_load_dwordx4 v[180:183], v156, s[32:35], s50 offen offset:1024 sc1
    s_waitcnt vmcnt(0)
    v_max_u32 v9, v160, v161
    v_max3_u32 v9, v9, v162, v163
    v_max3_u32 v9, v9, v164, v165
    v_max3_u32 v9, v9, v166, v167
    v_max3_u32 v9, v9, v168, v169
    v_max3_u32 v9, v9, v170, v171
    v_max3_u32 v9, v9, v172, v173
    v_max3_u32 v9, v9, v174, v175
    v_max3_u32 v9, v9, v176, v177
    v_max3_u32 v9, v9, v178, v179
    v_max3_u32 v9, v9, v180, v181
    v_max3_u32 v9, v9, v182, v183
    v_cmp_eq_u32 vcc, -1, v9
    s_add_u32 s45, s45, 1
    s_nop 3
    s_cbranch_vccz L_ready2
    s_sleep 8
    s_cmp_lt_u32 s45, 20000
    s_cbranch_scc1 L_poll2
L_ready2:
    v_lshlrev_b32 v9, 16, v166
    v_and_b32 v10, 0xffff0000, v166
    v_add_f32 v64, v64, v9
    v_add_f32 v65, v65, v10
    v_lshlrev_b32 v9, 16, v167
    v_and_b32 v10, 0xffff0000, v167
    v_add_f32 v66, v66, v9
    v_add_f32 v67, v67, v10
    v_lshlrev_b32 v9, 16, v174
    v_and_b32 v10, 0xffff0000, v174
    v_add_f32 v64, v64, v9
    v_add_f32 v65, v65, v10
    v_lshlrev_b32 v9, 16, v175
    v_and_b32 v10, 0xffff0000, v175
    v_add_f32 v66, v66, v9
    v_add_f32 v67, v67, v10
    v_lshlrev_b32 v9, 16, v182
    v_and_b32 v10, 0xffff0000, v182
    v_add_f32 v64, v64, v9
    v_add_f32 v65, v65, v10
    v_lshlrev_b32 v9, 16, v183
    v_and_b32 v10, 0xffff0000, v183
    v_add_f32 v66, v66, v9
    v_add_f32 v67, v67, v10
    ds_write_b128 v14, v[64:67]
    v_lshlrev_b32 v9, 16, v160
    v_and_b32 v10, 0xffff0000, v160
    v_add_f32 v16, v16, v9
    v_add_f32 v17, v17, v10
    v_lshlrev_b32 v9, 16, v161
    v_and_b32 v10, 0xffff0000, v161
    v_add_f32 v18, v18, v9
    v_add_f32 v19, v19, v10
    v_lshlrev_b32 v9, 16, v168
    v_and_b32 v10, 0xffff0000, v168
    v_add_f32 v16, v16, v9
    v_add_f32 v17, v17, v10
    v_lshlrev_b32 v9, 16, v169
    v_and_b32 v10, 0xffff0000, v169
    v_add_f32 v18, v18, v9
    v_add_f32 v19, v19, v10
    v_lshlrev_b32 v9, 16, v176
    v_and_b32 v10, 0xffff0000, v176
    v_add_f32 v16, v16, v9
    v_add_f32 v17, v17, v10
    v_lshlrev_b32 v9, 16, v177
    v_and_b32 v10, 0xffff0000, v177
    v_add_f32 v18, v18, v9
    v_add_f32 v19, v19, v10
    v_cvt_pk_bf16_f32 v16, v16, v17
    v_cvt_pk_bf16_f32 v17, v18, v19
    s_mov_b32 s46, 0
    buffer_store_dwordx2 v[16:17], v12, s[28:31], s46 offen sc1
    v_lshlrev_b32 v9, 16, v162
    v_and_b32 v10, 0xffff0000, v162
    v_add_f32 v20, v20, v9
    v_add_f32 v21, v21, v10
    v_lshlrev_b32 v9, 16, v163
    v_and_b32 v10, 0xffff0000, v163
    v_add_f32 v22, v22, v9
    v_add_f32 v23, v23, v10
    v_lshlrev_b32 v9, 16, v170
    v_and_b32 v10, 0xffff0000, v170
    v_add_f32 v20, v20, v9
    v_add_f32 v21, v21, v10
    v_lshlrev_b32 v9, 16, v171
    v_and_b32 v10, 0xffff0000, v171
    v_add_f32 v22, v22, v9
    v_add_f32 v23, v23, v10
    v_lshlrev_b32 v9, 16, v178
    v_and_b32 v10, 0xffff0000, v178
    v_add_f32 v20, v20, v9
    v_add_f32 v21, v21, v10
    v_lshlrev_b32 v9, 16, v179
    v_and_b32 v10, 0xffff0000, v179
    v_add_f32 v22, v22, v9
    v_add_f32 v23, v23, v10
    v_cvt_pk_bf16_f32 v20, v20, v21
    v_cvt_pk_bf16_f32 v21, v22, v23
    s_mov_b32 s46, 16384
    buffer_store_dwordx2 v[20:21], v12, s[28:31], s46 offen sc1
    v_lshlrev_b32 v9, 16, v164
    v_and_b32 v10, 0xffff0000, v164
    v_add_f32 v24, v24, v9
    v_add_f32 v25, v25, v10
    v_lshlrev_b32 v9, 16, v165
    v_and_b32 v10, 0xffff0000, v165
    v_add_f32 v26, v26, v9
    v_add_f32 v27, v27, v10
    v_lshlrev_b32 v9, 16, v172
    v_and_b32 v10, 0xffff0000, v172
    v_add_f32 v24, v24, v9
    v_add_f32 v25, v25, v10
    v_lshlrev_b32 v9, 16, v173
    v_and_b32 v10, 0xffff0000, v173
    v_add_f32 v26, v26, v9
    v_add_f32 v27, v27, v10
    v_lshlrev_b32 v9, 16, v180
    v_and_b32 v10, 0xffff0000, v180
    v_add_f32 v24, v24, v9
    v_add_f32 v25, v25, v10
    v_lshlrev_b32 v9, 16, v181
    v_and_b32 v10, 0xffff0000, v181
    v_add_f32 v26, v26, v9
    v_add_f32 v27, v27, v10
    v_cvt_pk_bf16_f32 v24, v24, v25
    v_cvt_pk_bf16_f32 v25, v26, v27
    s_mov_b32 s46, 32768
    buffer_store_dwordx2 v[24:25], v12, s[28:31], s46 offen sc1
    s_waitcnt lgkmcnt(0)
    s_barrier
    ds_read_b128 v[80:83], v15
    ds_read_b128 v[84:87], v15 offset:1024
    ds_read_b128 v[88:91], v15 offset:2048
    ds_read_b128 v[92:95], v15 offset:3072
    s_waitcnt lgkmcnt(2)
    v_add_f32 v80, v80, v84
    s_waitcnt lgkmcnt(0)
    v_add_f32 v88, v88, v92
    v_add_f32 v80, v80, v88
    v_add_f32 v81, v81, v85
    v_add_f32 v89, v89, v93
    v_add_f32 v81, v81, v89
    v_add_f32 v82, v82, v86
    v_add_f32 v90, v90, v94
    v_add_f32 v82, v82, v90
    v_add_f32 v83, v83, v87
    v_add_f32 v91, v91, v95
    v_add_f32 v83, v83, v91
    v_cvt_pk_bf16_f32 v80, v80, v81
    v_cvt_pk_bf16_f32 v81, v82, v83
    buffer_store_dwordx2 v[80:81], v13, s[28:31], 0 offen sc1
L_end:
    s_endpgm
L_stub2:
    s_call_b64 s[58:59], L_rare2
    s_branch L_back2
L_stub3:
    s_call_b64 s[58:59], L_rare3
    s_branch L_back3
L_stub4:
    s_call_b64 s[58:59], L_rare4
    s_branch L_back4
L_stub5:
    s_call_b64 s[58:59], L_rare5
    s_branch L_back5
L_stub6:
    s_call_b64 s[58:59], L_rare6
    s_branch L_back6
L_stub7:
    s_call_b64 s[58:59], L_rare7
    s_branch L_back7
L_stub8:
    s_call_b64 s[58:59], L_rare2
    s_branch L_back8
L_stub9:
    s_call_b64 s[58:59], L_rare3
    s_branch L_back9
L_stub10:
    s_call_b64 s[58:59], L_rare4
    s_branch L_back10
L_stub101:
    s_call_b64 s[58:59], L_rareT6
    s_branch L_back101
L_stub11:
    s_call_b64 s[58:59], L_rare5
    s_branch L_back11
L_stub12:
    s_call_b64 s[58:59], L_rare6
    s_branch L_back12
L_stub13:
    s_call_b64 s[58:59], L_rare7
    s_branch L_back13
L_stub14:
    s_call_b64 s[58:59], L_rare2
    s_branch L_back14
L_stub15:
    s_call_b64 s[58:59], L_rare3
    s_branch L_back15
L_stub16:
    s_call_b64 s[58:59], L_rare4
    s_branch L_back16
L_stub102:
    s_call_b64 s[58:59], L_rareT6
    s_branch L_back102
L_stub17:
    s_call_b64 s[58:59], L_rare5
    s_branch L_back17
L_stub18:
    s_call_b64 s[58:59], L_rare6
    s_branch L_back18
L_stub19:
    s_call_b64 s[58:59], L_rare7
    s_branch L_back19
L_stub20:
    s_call_b64 s[58:59], L_rare20
    s_branch L_back20
L_stub21:
    s_call_b64 s[58:59], L_rare21
    s_branch L_back21
L_stub103:
    s_call_b64 s[58:59], L_rareT6
    s_branch L_back103
L_stub22:
    s_call_b64 s[58:59], L_rare22
    s_branch L_back22
L_stub23:
    s_call_b64 s[58:59], L_rare23
    s_branch L_back23
L_rare2:
    s_nop 15
    s_nop 15
    s_waitcnt lgkmcnt(0)
    v_max_f32 v10, v16, v17
    v_max3_f32 v10, v10, v18, v19
    v_max3_f32 v10, v10, v20, v21
    v_max3_f32 v10, v10, v22, v23
    v_max3_f32 v10, v10, v24, v25
    v_max3_f32 v10, v10, v26, v27
    v_max3_f32 v10, v10, v28, v29
    v_max3_f32 v10, v10, v30, v31
    v_mov_b32 v11, v10
    s_nop 1
    v_permlane32_swap_b32 v10, v11
    v_max_f32 v10, v10, v11
    v_max_f32 v10, 0, v10
    v_exp_f32_e64 v12, -v10
    s_nop 0
    v_mul_f32 v64, v12, v64
    v_mul_f32 v65, v12, v65
    v_mul_f32 v66, v12, v66
    v_mul_f32 v67, v12, v67
    v_mul_f32 v68, v12, v68
    v_mul_f32 v69, v12, v69
    v_mul_f32 v70, v12, v70
    v_mul_f32 v71, v12, v71
    v_mul_f32 v72, v12, v72
    v_mul_f32 v73, v12, v73
    v_mul_f32 v74, v12, v74
    v_mul_f32 v75, v12, v75
    v_mul_f32 v76, v12, v76
    v_mul_f32 v77, v12, v77
    v_mul_f32 v78, v12, v78
    v_mul_f32 v79, v12, v79
    v_mul_f32 v80, v12, v80
    v_mul_f32 v81, v12, v81
    v_mul_f32 v82, v12, v82
    v_mul_f32 v83, v12, v83
    v_mul_f32 v84, v12, v84
    v_mul_f32 v85, v12, v85
    v_mul_f32 v86, v12, v86
    v_mul_f32 v87, v12, v87
    v_mul_f32 v88, v12, v88
    v_mul_f32 v89, v12, v89
    v_mul_f32 v90, v12, v90
    v_mul_f32 v91, v12, v91
    v_mul_f32 v92, v12, v92
    v_mul_f32 v93, v12, v93
    v_mul_f32 v94, v12, v94
    v_mul_f32 v95, v12, v95
    v_mul_f32 v96, v12, v96
    v_mul_f32 v97, v12, v97
    v_mul_f32 v98, v12, v98
    v_mul_f32 v99, v12, v99
    v_mul_f32 v100, v12, v100
    v_mul_f32 v101, v12, v101
    v_mul_f32 v102, v12, v102
    v_mul_f32 v103, v12, v103
    v_mul_f32 v104, v12, v104
    v_mul_f32 v105, v12, v105
    v_mul_f32 v106, v12, v106
    v_mul_f32 v107, v12, v107
    v_mul_f32 v108, v12, v108
    v_mul_f32 v109, v12, v109
    v_mul_f32 v110, v12, v110
    v_mul_f32 v111, v12, v111
    v_mul_f32 v112, v12, v112
    v_mul_f32 v113, v12, v113
    v_mul_f32 v114, v12, v114
    v_mul_f32 v115, v12, v115
    v_mul_f32 v116, v12, v116
    v_mul_f32 v117, v12, v117
    v_mul_f32 v118, v12, v118
    v_mul_f32 v119, v12, v119
    v_mul_f32 v120, v12, v120
    v_mul_f32 v121, v12, v121
    v_mul_f32 v122, v12, v122
    v_mul_f32 v123, v12, v123
    v_mul_f32 v124, v12, v124
    v_mul_f32 v125, v12, v125
    v_mul_f32 v126, v12, v126
    v_mul_f32 v127, v12, v127
    v_mul_f32 v214, v12, v214
    v_sub_f32 v224, v224, v10
    v_sub_f32 v225, v225, v10
    v_sub_f32 v226, v226, v10
    v_sub_f32 v227, v227, v10
    v_sub_f32 v228, v228, v10
    v_sub_f32 v229, v229, v10
    v_sub_f32 v230, v230, v10
    v_sub_f32 v231, v231, v10
    v_sub_f32 v232, v232, v10
    v_sub_f32 v233, v233, v10
    v_sub_f32 v234, v234, v10
    v_sub_f32 v235, v235, v10
    v_sub_f32 v236, v236, v10
    v_sub_f32 v237, v237, v10
    v_sub_f32 v238, v238, v10
    v_sub_f32 v239, v239, v10
    v_sub_f32 v16, v16, v10
    v_sub_f32 v17, v17, v10
    v_sub_f32 v18, v18, v10
    v_sub_f32 v19, v19, v10
    v_sub_f32 v20, v20, v10
    v_sub_f32 v21, v21, v10
    v_sub_f32 v22, v22, v10
    v_sub_f32 v23, v23, v10
    v_sub_f32 v24, v24, v10
    v_sub_f32 v25, v25, v10
    v_sub_f32 v26, v26, v10
    v_sub_f32 v27, v27, v10
    v_sub_f32 v28, v28, v10
    v_sub_f32 v29, v29, v10
    v_sub_f32 v30, v30, v10
    v_sub_f32 v31, v31, v10
    v_sub_f32 v32, v32, v10
    v_sub_f32 v33, v33, v10
    v_sub_f32 v34, v34, v10
    v_sub_f32 v35, v35, v10
    v_sub_f32 v36, v36, v10
    v_sub_f32 v37, v37, v10
    v_sub_f32 v38, v38, v10
    v_sub_f32 v39, v39, v10
    v_sub_f32 v40, v40, v10
    v_sub_f32 v41, v41, v10
    v_sub_f32 v42, v42, v10
    v_sub_f32 v43, v43, v10
    v_sub_f32 v44, v44, v10
    v_sub_f32 v45, v45, v10
    v_sub_f32 v46, v46, v10
    v_sub_f32 v47, v47, v10
    v_exp_f32 v11, v16
    v_exp_f32 v13, v17
    v_add_f32 v213, v214, v11
    v_exp_f32 v14, v18
    v_add_f32 v213, v213, v13
    v_cvt_pk_bf16_f32 v48, v11, v13
    v_exp_f32 v15, v19
    v_add_f32 v213, v213, v14
    v_exp_f32 v11, v20
    v_add_f32 v213, v213, v15
    v_cvt_pk_bf16_f32 v49, v14, v15
    v_exp_f32 v13, v21
    v_add_f32 v213, v213, v11
    v_exp_f32 v14, v22
    v_add_f32 v213, v213, v13
    v_cvt_pk_bf16_f32 v50, v11, v13
    v_exp_f32 v15, v23
    v_add_f32 v213, v213, v14
    v_exp_f32 v11, v24
    v_add_f32 v213, v213, v15
    v_cvt_pk_bf16_f32 v51, v14, v15
    v_exp_f32 v13, v25
    v_add_f32 v213, v213, v11
    v_exp_f32 v14, v26
    v_add_f32 v213, v213, v13
    v_cvt_pk_bf16_f32 v52, v11, v13
    v_exp_f32 v15, v27
    v_add_f32 v213, v213, v14
    v_exp_f32 v11, v28
    v_add_f32 v213, v213, v15
    v_cvt_pk_bf16_f32 v53, v14, v15
    v_exp_f32 v13, v29
    v_add_f32 v213, v213, v11
    v_exp_f32 v14, v30
    v_add_f32 v213, v213, v13
    v_cvt_pk_bf16_f32 v54, v11, v13
    v_exp_f32 v15, v31
    v_add_f32 v213, v213, v14
    v_add_f32 v213, v213, v15
    v_cvt_pk_bf16_f32 v55, v14, v15
    s_nop 3
    s_setpc_b64 s[58:59]
L_rare3:
    s_nop 15
    s_nop 15
    s_waitcnt lgkmcnt(0)
    v_max_f32 v10, v32, v33
    v_max3_f32 v10, v10, v34, v35
    v_max3_f32 v10, v10, v36, v37
    v_max3_f32 v10, v10, v38, v39
    v_max3_f32 v10, v10, v40, v41
    v_max3_f32 v10, v10, v42, v43
    v_max3_f32 v10, v10, v44, v45
    v_max3_f32 v10, v10, v46, v47
    v_mov_b32 v11, v10
    s_nop 1
    v_permlane32_swap_b32 v10, v11
    v_max_f32 v10, v10, v11
    v_max_f32 v10, 0, v10
    v_exp_f32_e64 v12, -v10
    s_nop 0
    v_mul_f32 v64, v12, v64
    v_mul_f32 v65, v12, v65
    v_mul_f32 v66, v12, v66
    v_mul_f32 v67, v12, v67
    v_mul_f32 v68, v12, v68
    v_mul_f32 v69, v12, v69
    v_mul_f32 v70, v12, v70
    v_mul_f32 v71, v12, v71
    v_mul_f32 v72, v12, v72
    v_mul_f32 v73, v12, v73
    v_mul_f32 v74, v12, v74
    v_mul_f32 v75, v12, v75
    v_mul_f32 v76, v12, v76
    v_mul_f32 v77, v12, v77
    v_mul_f32 v78, v12, v78
    v_mul_f32 v79, v12, v79
    v_mul_f32 v80, v12, v80
    v_mul_f32 v81, v12, v81
    v_mul_f32 v82, v12, v82
    v_mul_f32 v83, v12, v83
    v_mul_f32 v84, v12, v84
    v_mul_f32 v85, v12, v85
    v_mul_f32 v86, v12, v86
    v_mul_f32 v87, v12, v87
    v_mul_f32 v88, v12, v88
    v_mul_f32 v89, v12, v89
    v_mul_f32 v90, v12, v90
    v_mul_f32 v91, v12, v91
    v_mul_f32 v92, v12, v92
    v_mul_f32 v93, v12, v93
    v_mul_f32 v94, v12, v94
    v_mul_f32 v95, v12, v95
    v_mul_f32 v96, v12, v96
    v_mul_f32 v97, v12, v97
    v_mul_f32 v98, v12, v98
    v_mul_f32 v99, v12, v99
    v_mul_f32 v100, v12, v100
    v_mul_f32 v101, v12, v101
    v_mul_f32 v102, v12, v102
    v_mul_f32 v103, v12, v103
    v_mul_f32 v104, v12, v104
    v_mul_f32 v105, v12, v105
    v_mul_f32 v106, v12, v106
    v_mul_f32 v107, v12, v107
    v_mul_f32 v108, v12, v108
    v_mul_f32 v109, v12, v109
    v_mul_f32 v110, v12, v110
    v_mul_f32 v111, v12, v111
    v_mul_f32 v112, v12, v112
    v_mul_f32 v113, v12, v113
    v_mul_f32 v114, v12, v114
    v_mul_f32 v115, v12, v115
    v_mul_f32 v116, v12, v116
    v_mul_f32 v117, v12, v117
    v_mul_f32 v118, v12, v118
    v_mul_f32 v119, v12, v119
    v_mul_f32 v120, v12, v120
    v_mul_f32 v121, v12, v121
    v_mul_f32 v122, v12, v122
    v_mul_f32 v123, v12, v123
    v_mul_f32 v124, v12, v124
    v_mul_f32 v125, v12, v125
    v_mul_f32 v126, v12, v126
    v_mul_f32 v127, v12, v127
    v_mul_f32 v213, v12, v213
    v_sub_f32 v224, v224, v10
    v_sub_f32 v225, v225, v10
    v_sub_f32 v226, v226, v10
    v_sub_f32 v227, v227, v10
    v_sub_f32 v228, v228, v10
    v_sub_f32 v229, v229, v10
    v_sub_f32 v230, v230, v10
    v_sub_f32 v231, v231, v10
    v_sub_f32 v232, v232, v10
    v_sub_f32 v233, v233, v10
    v_sub_f32 v234, v234, v10
    v_sub_f32 v235, v235, v10
    v_sub_f32 v236, v236, v10
    v_sub_f32 v237, v237, v10
    v_sub_f32 v238, v238, v10
    v_sub_f32 v239, v239, v10
    v_sub_f32 v32, v32, v10
    v_sub_f32 v33, v33, v10
    v_sub_f32 v34, v34, v10
    v_sub_f32 v35, v35, v10
    v_sub_f32 v36, v36, v10
    v_sub_f32 v37, v37, v10
    v_sub_f32 v38, v38, v10
    v_sub_f32 v39, v39, v10
    v_sub_f32 v40, v40, v10
    v_sub_f32 v41, v41, v10
    v_sub_f32 v42, v42, v10
    v_sub_f32 v43, v43, v10
    v_sub_f32 v44, v44, v10
    v_sub_f32 v45, v45, v10
    v_sub_f32 v46, v46, v10
    v_sub_f32 v47, v47, v10
    v_exp_f32 v11, v32
    v_exp_f32 v13, v33
    v_add_f32 v214, v213, v11
    v_exp_f32 v14, v34
    v_add_f32 v214, v214, v13
    v_cvt_pk_bf16_f32 v56, v11, v13
    v_exp_f32 v15, v35
    v_add_f32 v214, v214, v14
    v_exp_f32 v11, v36
    v_add_f32 v214, v214, v15
    v_cvt_pk_bf16_f32 v57, v14, v15
    v_exp_f32 v13, v37
    v_add_f32 v214, v214, v11
    v_exp_f32 v14, v38
    v_add_f32 v214, v214, v13
    v_cvt_pk_bf16_f32 v58, v11, v13
    v_exp_f32 v15, v39
    v_add_f32 v214, v214, v14
    v_exp_f32 v11, v40
    v_add_f32 v214, v214, v15
    v_cvt_pk_bf16_f32 v59, v14, v15
    v_exp_f32 v13, v41
    v_add_f32 v214, v214, v11
    v_exp_f32 v14, v42
    v_add_f32 v214, v214, v13
    v_cvt_pk_bf16_f32 v60, v11, v13
    v_exp_f32 v15, v43
    v_add_f32 v214, v214, v14
    v_exp_f32 v11, v44
    v_add_f32 v214, v214, v15
    v_cvt_pk_bf16_f32 v61, v14, v15
    v_exp_f32 v13, v45
    v_add_f32 v214, v214, v11
    v_exp_f32 v14, v46
    v_add_f32 v214, v214, v13
    v_cvt_pk_bf16_f32 v62, v11, v13
    v_exp_f32 v15, v47
    v_add_f32 v214, v214, v14
    v_add_f32 v214, v214, v15
    v_cvt_pk_bf16_f32 v63, v14, v15
    s_nop 3
    s_setpc_b64 s[58:59]
L_rare4:
    s_nop 15
    s_nop 15
    s_waitcnt lgkmcnt(0)
    v_max_f32 v10, v16, v17
    v_max3_f32 v10, v10, v18, v19
    v_max3_f32 v10, v10, v20, v21
    v_max3_f32 v10, v10, v22, v23
    v_max3_f32 v10, v10, v24, v25
    v_max3_f32 v10, v10, v26, v27
    v_max3_f32 v10, v10, v28, v29
    v_max3_f32 v10, v10, v30, v31
    v_mov_b32 v11, v10
    s_nop 1
    v_permlane32_swap_b32 v10, v11
    v_max_f32 v10, v10, v11
    v_max_f32 v10, 0, v10
    v_exp_f32_e64 v12, -v10
    s_nop 0
    v_mul_f32 v128, v12, v128
    v_mul_f32 v129, v12, v129
    v_mul_f32 v130, v12, v130
    v_mul_f32 v131, v12, v131
    v_mul_f32 v132, v12, v132
    v_mul_f32 v133, v12, v133
    v_mul_f32 v134, v12, v134
    v_mul_f32 v135, v12, v135
    v_mul_f32 v136, v12, v136
    v_mul_f32 v137, v12, v137
    v_mul_f32 v138, v12, v138
    v_mul_f32 v139, v12, v139
    v_mul_f32 v140, v12, v140
    v_mul_f32 v141, v12, v141
    v_mul_f32 v142, v12, v142
    v_mul_f32 v143, v12, v143
    v_mul_f32 v144, v12, v144
    v_mul_f32 v145, v12, v145
    v_mul_f32 v146, v12, v146
    v_mul_f32 v147, v12, v147
    v_mul_f32 v148, v12, v148
    v_mul_f32 v149, v12, v149
    v_mul_f32 v150, v12, v150
    v_mul_f32 v151, v12, v151
    v_mul_f32 v152, v12, v152
    v_mul_f32 v153, v12, v153
    v_mul_f32 v154, v12, v154
    v_mul_f32 v155, v12, v155
    v_mul_f32 v156, v12, v156
    v_mul_f32 v157, v12, v157
    v_mul_f32 v158, v12, v158
    v_mul_f32 v159, v12, v159
    v_accvgpr_read_b32 v15, a80
    v_mul_f32 v15, v12, v15
    v_accvgpr_write_b32 a80, v15
    v_accvgpr_read_b32 v13, a81
    v_mul_f32 v13, v12, v13
    v_accvgpr_write_b32 a81, v13
    v_accvgpr_read_b32 v14, a82
    v_mul_f32 v14, v12, v14
    v_accvgpr_write_b32 a82, v14
    v_accvgpr_read_b32 v15, a83
    v_mul_f32 v15, v12, v15
    v_accvgpr_write_b32 a83, v15
    v_accvgpr_read_b32 v13, a84
    v_mul_f32 v13, v12, v13
    v_accvgpr_write_b32 a84, v13
    v_accvgpr_read_b32 v14, a85
    v_mul_f32 v14, v12, v14
    v_accvgpr_write_b32 a85, v14
    v_accvgpr_read_b32 v15, a86
    v_mul_f32 v15, v12, v15
    v_accvgpr_write_b32 a86, v15
    v_accvgpr_read_b32 v13, a87
    v_mul_f32 v13, v12, v13
    v_accvgpr_write_b32 a87, v13
    v_accvgpr_read_b32 v14, a88
    v_mul_f32 v14, v12, v14
    v_accvgpr_write_b32 a88, v14
    v_accvgpr_read_b32 v15, a89
    v_mul_f32 v15, v12, v15
    v_accvgpr_write_b32 a89, v15
    v_accvgpr_read_b32 v13, a90
    v_mul_f32 v13, v12, v13
    v_accvgpr_write_b32 a90, v13
    v_accvgpr_read_b32 v14, a91
    v_mul_f32 v14, v12, v14
    v_accvgpr_write_b32 a91, v14
    v_accvgpr_read_b32 v15, a92
    v_mul_f32 v15, v12, v15
    v_accvgpr_write_b32 a92, v15
    v_accvgpr_read_b32 v13, a93
    v_mul_f32 v13, v12, v13
    v_accvgpr_write_b32 a93, v13
    v_accvgpr_read_b32 v14, a94
    v_mul_f32 v14, v12, v14
    v_accvgpr_write_b32 a94, v14
    v_accvgpr_read_b32 v15, a95
    v_mul_f32 v15, v12, v15
    v_accvgpr_write_b32 a95, v15
    v_accvgpr_read_b32 v13, a96
    v_mul_f32 v13, v12, v13
    v_accvgpr_write_b32 a96, v13
    v_accvgpr_read_b32 v14, a97
    v_mul_f32 v14, v12, v14
    v_accvgpr_write_b32 a97, v14
    v_accvgpr_read_b32 v15, a98
    v_mul_f32 v15, v12, v15
    v_accvgpr_write_b32 a98, v15
    v_accvgpr_read_b32 v13, a99
    v_mul_f32 v13, v12, v13
    v_accvgpr_write_b32 a99, v13
    v_accvgpr_read_b32 v14, a100
    v_mul_f32 v14, v12, v14
    v_accvgpr_write_b32 a100, v14
    v_accvgpr_read_b32 v15, a101
    v_mul_f32 v15, v12, v15
    v_accvgpr_write_b32 a101, v15
    v_accvgpr_read_b32 v13, a102
    v_mul_f32 v13, v12, v13
    v_accvgpr_write_b32 a102, v13
    v_accvgpr_read_b32 v14, a103
    v_mul_f32 v14, v12, v14
    v_accvgpr_write_b32 a103, v14
    v_accvgpr_read_b32 v15, a104
    v_mul_f32 v15, v12, v15
    v_accvgpr_write_b32 a104, v15
    v_accvgpr_read_b32 v13, a105
    v_mul_f32 v13, v12, v13
    v_accvgpr_write_b32 a105, v13
    v_accvgpr_read_b32 v14, a106
    v_mul_f32 v14, v12, v14
    v_accvgpr_write_b32 a106, v14
    v_accvgpr_read_b32 v15, a107
    v_mul_f32 v15, v12, v15
    v_accvgpr_write_b32 a107, v15
    v_accvgpr_read_b32 v13, a108
    v_mul_f32 v13, v12, v13
    v_accvgpr_write_b32 a108, v13
    v_accvgpr_read_b32 v14, a109
    v_mul_f32 v14, v12, v14
    v_accvgpr_write_b32 a109, v14
    v_accvgpr_read_b32 v15, a110
    v_mul_f32 v15, v12, v15
    v_accvgpr_write_b32 a110, v15
    v_accvgpr_read_b32 v13, a111
    v_mul_f32 v13, v12, v13
    v_accvgpr_write_b32 a111, v13
    v_mul_f32 v216, v12, v216
    v_sub_f32 v240, v240, v10
    v_sub_f32 v241, v241, v10
    v_sub_f32 v242, v242, v10
    v_sub_f32 v243, v243, v10
    v_sub_f32 v244, v244, v10
    v_sub_f32 v245, v245, v10
    v_sub_f32 v246, v246, v10
    v_sub_f32 v247, v247, v10
    v_sub_f32 v248, v248, v10
    v_sub_f32 v249, v249, v10
    v_sub_f32 v250, v250, v10
    v_sub_f32 v251, v251, v10
    v_sub_f32 v252, v252, v10
    v_sub_f32 v253, v253, v10
    v_sub_f32 v254, v254, v10
    v_sub_f32 v255, v255, v10
    v_sub_f32 v16, v16, v10
    v_sub_f32 v17, v17, v10
    v_sub_f32 v18, v18, v10
    v_sub_f32 v19, v19, v10
    v_sub_f32 v20, v20, v10
    v_sub_f32 v21, v21, v10
    v_sub_f32 v22, v22, v10
    v_sub_f32 v23, v23, v10
    v_sub_f32 v24, v24, v10
    v_sub_f32 v25, v25, v10
    v_sub_f32 v26, v26, v10
    v_sub_f32 v27, v27, v10
    v_sub_f32 v28, v28, v10
    v_sub_f32 v29, v29, v10
    v_sub_f32 v30, v30, v10
    v_sub_f32 v31, v31, v10
    v_exp_f32 v11, v16
    v_exp_f32 v13, v17
    v_add_f32 v215, v216, v11
    v_exp_f32 v14, v18
    v_add_f32 v215, v215, v13
    v_cvt_pk_bf16_f32 v48, v11, v13
    v_exp_f32 v15, v19
    v_add_f32 v215, v215, v14
    v_exp_f32 v11, v20
    v_add_f32 v215, v215, v15
    v_cvt_pk_bf16_f32 v49, v14, v15
    v_exp_f32 v13, v21
    v_add_f32 v215, v215, v11
    v_exp_f32 v14, v22
    v_add_f32 v215, v215, v13
    v_cvt_pk_bf16_f32 v50, v11, v13
    v_exp_f32 v15, v23
    v_add_f32 v215, v215, v14
    v_exp_f32 v11, v24
    v_add_f32 v215, v215, v15
    v_cvt_pk_bf16_f32 v51, v14, v15
    v_exp_f32 v13, v25
    v_add_f32 v215, v215, v11
    v_exp_f32 v14, v26
    v_add_f32 v215, v215, v13
    v_cvt_pk_bf16_f32 v52, v11, v13
    v_exp_f32 v15, v27
    v_add_f32 v215, v215, v14
    v_exp_f32 v11, v28
    v_add_f32 v215, v215, v15
    v_cvt_pk_bf16_f32 v53, v14, v15
    v_exp_f32 v13, v29
    v_add_f32 v215, v215, v11
    v_exp_f32 v14, v30
    v_add_f32 v215, v215, v13
    v_cvt_pk_bf16_f32 v54, v11, v13
    v_exp_f32 v15, v31
    v_add_f32 v215, v215, v14
    v_add_f32 v215, v215, v15
    v_cvt_pk_bf16_f32 v55, v14, v15
    s_nop 3
    s_setpc_b64 s[58:59]
L_rare5:
    s_nop 15
    s_nop 15
    s_waitcnt lgkmcnt(0)
    v_max_f32 v10, v32, v33
    v_max3_f32 v10, v10, v34, v35
    v_max3_f32 v10, v10, v36, v37
    v_max3_f32 v10, v10, v38, v39
    v_max3_f32 v10, v10, v40, v41
    v_max3_f32 v10, v10, v42, v43
    v_max3_f32 v10, v10, v44, v45
    v_max3_f32 v10, v10, v46, v47
    v_mov_b32 v11, v10
    s_nop 1
    v_permlane32_swap_b32 v10, v11
    v_max_f32 v10, v10, v11
    v_max_f32 v10, 0, v10
    v_exp_f32_e64 v12, -v10
    s_nop 0
    v_mul_f32 v64, v12, v64
    v_mul_f32 v65, v12, v65
    v_mul_f32 v66, v12, v66
    v_mul_f32 v67, v12, v67
    v_mul_f32 v68, v12, v68
    v_mul_f32 v69, v12, v69
    v_mul_f32 v70, v12, v70
    v_mul_f32 v71, v12, v71
    v_mul_f32 v72, v12, v72
    v_mul_f32 v73, v12, v73
    v_mul_f32 v74, v12, v74
    v_mul_f32 v75, v12, v75
    v_mul_f32 v76, v12, v76
    v_mul_f32 v77, v12, v77
    v_mul_f32 v78, v12, v78
    v_mul_f32 v79, v12, v79
    v_mul_f32 v80, v12, v80
    v_mul_f32 v81, v12, v81
    v_mul_f32 v82, v12, v82
    v_mul_f32 v83, v12, v83
    v_mul_f32 v84, v12, v84
    v_mul_f32 v85, v12, v85
    v_mul_f32 v86, v12, v86
    v_mul_f32 v87, v12, v87
    v_mul_f32 v88, v12, v88
    v_mul_f32 v89, v12, v89
    v_mul_f32 v90, v12, v90
    v_mul_f32 v91, v12, v91
    v_mul_f32 v92, v12, v92
    v_mul_f32 v93, v12, v93
    v_mul_f32 v94, v12, v94
    v_mul_f32 v95, v12, v95
    v_mul_f32 v96, v12, v96
    v_mul_f32 v97, v12, v97
    v_mul_f32 v98, v12, v98
    v_mul_f32 v99, v12, v99
    v_mul_f32 v100, v12, v100
    v_mul_f32 v101, v12, v101
    v_mul_f32 v102, v12, v102
    v_mul_f32 v103, v12, v103
    v_mul_f32 v104, v12, v104
    v_mul_f32 v105, v12, v105
    v_mul_f32 v106, v12, v106
    v_mul_f32 v107, v12, v107
    v_mul_f32 v108, v12, v108
    v_mul_f32 v109, v12, v109
    v_mul_f32 v110, v12, v110
    v_mul_f32 v111, v12, v111
    v_mul_f32 v112, v12, v112
    v_mul_f32 v113, v12, v113
    v_mul_f32 v114, v12, v114
    v_mul_f32 v115, v12, v115
    v_mul_f32 v116, v12, v116
    v_mul_f32 v117, v12, v117
    v_mul_f32 v118, v12, v118
    v_mul_f32 v119, v12, v119
    v_mul_f32 v120, v12, v120
    v_mul_f32 v121, v12, v121
    v_mul_f32 v122, v12, v122
    v_mul_f32 v123, v12, v123
    v_mul_f32 v124, v12, v124
    v_mul_f32 v125, v12, v125
    v_mul_f32 v126, v12, v126
    v_mul_f32 v127, v12, v127
    v_mul_f32 v214, v12, v214
    v_sub_f32 v224, v224, v10
    v_sub_f32 v225, v225, v10
    v_sub_f32 v226, v226, v10
    v_sub_f32 v227, v227, v10
    v_sub_f32 v228, v228, v10
    v_sub_f32 v229, v229, v10
    v_sub_f32 v230, v230, v10
    v_sub_f32 v231, v231, v10
    v_sub_f32 v232, v232, v10
    v_sub_f32 v233, v233, v10
    v_sub_f32 v234, v234, v10
    v_sub_f32 v235, v235, v10
    v_sub_f32 v236, v236, v10
    v_sub_f32 v237, v237, v10
    v_sub_f32 v238, v238, v10
    v_sub_f32 v239, v239, v10
    v_sub_f32 v32, v32, v10
    v_sub_f32 v33, v33, v10
    v_sub_f32 v34, v34, v10
    v_sub_f32 v35, v35, v10
    v_sub_f32 v36, v36, v10
    v_sub_f32 v37, v37, v10
    v_sub_f32 v38, v38, v10
    v_sub_f32 v39, v39, v10
    v_sub_f32 v40, v40, v10
    v_sub_f32 v41, v41, v10
    v_sub_f32 v42, v42, v10
    v_sub_f32 v43, v43, v10
    v_sub_f32 v44, v44, v10
    v_sub_f32 v45, v45, v10
    v_sub_f32 v46, v46, v10
    v_sub_f32 v47, v47, v10
    v_sub_f32 v16, v16, v10
    v_sub_f32 v17, v17, v10
    v_sub_f32 v18, v18, v10
    v_sub_f32 v19, v19, v10
    v_sub_f32 v20, v20, v10
    v_sub_f32 v21, v21, v10
    v_sub_f32 v22, v22, v10
    v_sub_f32 v23, v23, v10
    v_sub_f32 v24, v24, v10
    v_sub_f32 v25, v25, v10
    v_sub_f32 v26, v26, v10
    v_sub_f32 v27, v27, v10
    v_sub_f32 v28, v28, v10
    v_sub_f32 v29, v29, v10
    v_sub_f32 v30, v30, v10
    v_sub_f32 v31, v31, v10
    v_exp_f32 v11, v32
    v_exp_f32 v13, v33
    v_add_f32 v213, v214, v11
    v_exp_f32 v14, v34
    v_add_f32 v213, v213, v13
    v_cvt_pk_bf16_f32 v56, v11, v13
    v_exp_f32 v15, v35
    v_add_f32 v213, v213, v14
    v_exp_f32 v11, v36
    v_add_f32 v213, v213, v15
    v_cvt_pk_bf16_f32 v57, v14, v15
    v_exp_f32 v13, v37
    v_add_f32 v213, v213, v11
    v_exp_f32 v14, v38
    v_add_f32 v213, v213, v13
    v_cvt_pk_bf16_f32 v58, v11, v13
    v_exp_f32 v15, v39
    v_add_f32 v213, v213, v14
    v_exp_f32 v11, v40
    v_add_f32 v213, v213, v15
    v_cvt_pk_bf16_f32 v59, v14, v15
    v_exp_f32 v13, v41
    v_add_f32 v213, v213, v11
    v_exp_f32 v14, v42
    v_add_f32 v213, v213, v13
    v_cvt_pk_bf16_f32 v60, v11, v13
    v_exp_f32 v15, v43
    v_add_f32 v213, v213, v14
    v_exp_f32 v11, v44
    v_add_f32 v213, v213, v15
    v_cvt_pk_bf16_f32 v61, v14, v15
    v_exp_f32 v13, v45
    v_add_f32 v213, v213, v11
    v_exp_f32 v14, v46
    v_add_f32 v213, v213, v13
    v_cvt_pk_bf16_f32 v62, v11, v13
    v_exp_f32 v15, v47
    v_add_f32 v213, v213, v14
    v_add_f32 v213, v213, v15
    v_cvt_pk_bf16_f32 v63, v14, v15
    s_nop 3
    s_setpc_b64 s[58:59]
L_rare6:
    s_nop 15
    s_nop 15
    s_waitcnt lgkmcnt(0)
    v_max_f32 v10, v16, v17
    v_max3_f32 v10, v10, v18, v19
    v_max3_f32 v10, v10, v20, v21
    v_max3_f32 v10, v10, v22, v23
    v_max3_f32 v10, v10, v24, v25
    v_max3_f32 v10, v10, v26, v27
    v_max3_f32 v10, v10, v28, v29
    v_max3_f32 v10, v10, v30, v31
    v_mov_b32 v11, v10
    s_nop 1
    v_permlane32_swap_b32 v10, v11
    v_max_f32 v10, v10, v11
    v_max_f32 v10, 0, v10
    v_exp_f32_e64 v12, -v10
    s_nop 0
    v_mul_f32 v64, v12, v64
    v_mul_f32 v65, v12, v65
    v_mul_f32 v66, v12, v66
    v_mul_f32 v67, v12, v67
    v_mul_f32 v68, v12, v68
    v_mul_f32 v69, v12, v69
    v_mul_f32 v70, v12, v70
    v_mul_f32 v71, v12, v71
    v_mul_f32 v72, v12, v72
    v_mul_f32 v73, v12, v73
    v_mul_f32 v74, v12, v74
    v_mul_f32 v75, v12, v75
    v_mul_f32 v76, v12, v76
    v_mul_f32 v77, v12, v77
    v_mul_f32 v78, v12, v78
    v_mul_f32 v79, v12, v79
    v_mul_f32 v80, v12, v80
    v_mul_f32 v81, v12, v81
    v_mul_f32 v82, v12, v82
    v_mul_f32 v83, v12, v83
    v_mul_f32 v84, v12, v84
    v_mul_f32 v85, v12, v85
    v_mul_f32 v86, v12, v86
    v_mul_f32 v87, v12, v87
    v_mul_f32 v88, v12, v88
    v_mul_f32 v89, v12, v89
    v_mul_f32 v90, v12, v90
    v_mul_f32 v91, v12, v91
    v_mul_f32 v92, v12, v92
    v_mul_f32 v93, v12, v93
    v_mul_f32 v94, v12, v94
    v_mul_f32 v95, v12, v95
    v_mul_f32 v96, v12, v96
    v_mul_f32 v97, v12, v97
    v_mul_f32 v98, v12, v98
    v_mul_f32 v99, v12, v99
    v_mul_f32 v100, v12, v100
    v_mul_f32 v101, v12, v101
    v_mul_f32 v102, v12, v102
    v_mul_f32 v103, v12, v103
    v_mul_f32 v104, v12, v104
    v_mul_f32 v105, v12, v105
    v_mul_f32 v106, v12, v106
    v_mul_f32 v107, v12, v107
    v_mul_f32 v108, v12, v108
    v_mul_f32 v109, v12, v109
    v_mul_f32 v110, v12, v110
    v_mul_f32 v111, v12, v111
    v_mul_f32 v112, v12, v112
    v_mul_f32 v113, v12, v113
    v_mul_f32 v114, v12, v114
    v_mul_f32 v115, v12, v115
    v_mul_f32 v116, v12, v116
    v_mul_f32 v117, v12, v117
    v_mul_f32 v118, v12, v118
    v_mul_f32 v119, v12, v119
    v_mul_f32 v120, v12, v120
    v_mul_f32 v121, v12, v121
    v_mul_f32 v122, v12, v122
    v_mul_f32 v123, v12, v123
    v_mul_f32 v124, v12, v124
    v_mul_f32 v125, v12, v125
    v_mul_f32 v126, v12, v126
    v_mul_f32 v127, v12, v127
    v_mul_f32 v213, v12, v213
    v_sub_f32 v224, v224, v10
    v_sub_f32 v225, v225, v10
    v_sub_f32 v226, v226, v10
    v_sub_f32 v227, v227, v10
    v_sub_f32 v228, v228, v10
    v_sub_f32 v229, v229, v10
    v_sub_f32 v230, v230, v10
    v_sub_f32 v231, v231, v10
    v_sub_f32 v232, v232, v10
    v_sub_f32 v233, v233, v10
    v_sub_f32 v234, v234, v10
    v_sub_f32 v235, v235, v10
    v_sub_f32 v236, v236, v10
    v_sub_f32 v237, v237, v10
    v_sub_f32 v238, v238, v10
    v_sub_f32 v239, v239, v10
    v_sub_f32 v16, v16, v10
    v_sub_f32 v17, v17, v10
    v_sub_f32 v18, v18, v10
    v_sub_f32 v19, v19, v10
    v_sub_f32 v20, v20, v10
    v_sub_f32 v21, v21, v10
    v_sub_f32 v22, v22, v10
    v_sub_f32 v23, v23, v10
    v_sub_f32 v24, v24, v10
    v_sub_f32 v25, v25, v10
    v_sub_f32 v26, v26, v10
    v_sub_f32 v27, v27, v10
    v_sub_f32 v28, v28, v10
    v_sub_f32 v29, v29, v10
    v_sub_f32 v30, v30, v10
    v_sub_f32 v31, v31, v10
    v_exp_f32 v11, v16
    v_exp_f32 v13, v17
    v_add_f32 v214, v213, v11
    v_exp_f32 v14, v18
    v_add_f32 v214, v214, v13
    v_cvt_pk_bf16_f32 v48, v11, v13
    v_exp_f32 v15, v19
    v_add_f32 v214, v214, v14
    v_exp_f32 v11, v20
    v_add_f32 v214, v214, v15
    v_cvt_pk_bf16_f32 v49, v14, v15
    v_exp_f32 v13, v21
    v_add_f32 v214, v214, v11
    v_exp_f32 v14, v22
    v_add_f32 v214, v214, v13
    v_cvt_pk_bf16_f32 v50, v11, v13
    v_exp_f32 v15, v23
    v_add_f32 v214, v214, v14
    v_exp_f32 v11, v24
    v_add_f32 v214, v214, v15
    v_cvt_pk_bf16_f32 v51, v14, v15
    v_exp_f32 v13, v25
    v_add_f32 v214, v214, v11
    v_exp_f32 v14, v26
    v_add_f32 v214, v214, v13
    v_cvt_pk_bf16_f32 v52, v11, v13
    v_exp_f32 v15, v27
    v_add_f32 v214, v214, v14
    v_exp_f32 v11, v28
    v_add_f32 v214, v214, v15
    v_cvt_pk_bf16_f32 v53, v14, v15
    v_exp_f32 v13, v29
    v_add_f32 v214, v214, v11
    v_exp_f32 v14, v30
    v_add_f32 v214, v214, v13
    v_cvt_pk_bf16_f32 v54, v11, v13
    v_exp_f32 v15, v31
    v_add_f32 v214, v214, v14
    v_add_f32 v214, v214, v15
    v_cvt_pk_bf16_f32 v55, v14, v15
    s_nop 3
    s_setpc_b64 s[58:59]
L_rare7:
    s_nop 15
    s_nop 15
    s_waitcnt lgkmcnt(0)
    v_max_f32 v10, v32, v33
    v_max3_f32 v10, v10, v34, v35
    v_max3_f32 v10, v10, v36, v37
    v_max3_f32 v10, v10, v38, v39
    v_max3_f32 v10, v10, v40, v41
    v_max3_f32 v10, v10, v42, v43
    v_max3_f32 v10, v10, v44, v45
    v_max3_f32 v10, v10, v46, v47
    v_mov_b32 v11, v10
    s_nop 1
    v_permlane32_swap_b32 v10, v11
    v_max_f32 v10, v10, v11
    v_max_f32 v10, 0, v10
    v_exp_f32_e64 v12, -v10
    s_nop 0
    v_mul_f32 v128, v12, v128
    v_mul_f32 v129, v12, v129
    v_mul_f32 v130, v12, v130
    v_mul_f32 v131, v12, v131
    v_mul_f32 v132, v12, v132
    v_mul_f32 v133, v12, v133
    v_mul_f32 v134, v12, v134
    v_mul_f32 v135, v12, v135
    v_mul_f32 v136, v12, v136
    v_mul_f32 v137, v12, v137
    v_mul_f32 v138, v12, v138
    v_mul_f32 v139, v12, v139
    v_mul_f32 v140, v12, v140
    v_mul_f32 v141, v12, v141
    v_mul_f32 v142, v12, v142
    v_mul_f32 v143, v12, v143
    v_mul_f32 v144, v12, v144
    v_mul_f32 v145, v12, v145
    v_mul_f32 v146, v12, v146
    v_mul_f32 v147, v12, v147
    v_mul_f32 v148, v12, v148
    v_mul_f32 v149, v12, v149
    v_mul_f32 v150, v12, v150
    v_mul_f32 v151, v12, v151
    v_mul_f32 v152, v12, v152
    v_mul_f32 v153, v12, v153
    v_mul_f32 v154, v12, v154
    v_mul_f32 v155, v12, v155
    v_mul_f32 v156, v12, v156
    v_mul_f32 v157, v12, v157
    v_mul_f32 v158, v12, v158
    v_mul_f32 v159, v12, v159
    v_accvgpr_read_b32 v15, a80
    v_mul_f32 v15, v12, v15
    v_accvgpr_write_b32 a80, v15
    v_accvgpr_read_b32 v13, a81
    v_mul_f32 v13, v12, v13
    v_accvgpr_write_b32 a81, v13
    v_accvgpr_read_b32 v14, a82
    v_mul_f32 v14, v12, v14
    v_accvgpr_write_b32 a82, v14
    v_accvgpr_read_b32 v15, a83
    v_mul_f32 v15, v12, v15
    v_accvgpr_write_b32 a83, v15
    v_accvgpr_read_b32 v13, a84
    v_mul_f32 v13, v12, v13
    v_accvgpr_write_b32 a84, v13
    v_accvgpr_read_b32 v14, a85
    v_mul_f32 v14, v12, v14
    v_accvgpr_write_b32 a85, v14
    v_accvgpr_read_b32 v15, a86
    v_mul_f32 v15, v12, v15
    v_accvgpr_write_b32 a86, v15
    v_accvgpr_read_b32 v13, a87
    v_mul_f32 v13, v12, v13
    v_accvgpr_write_b32 a87, v13
    v_accvgpr_read_b32 v14, a88
    v_mul_f32 v14, v12, v14
    v_accvgpr_write_b32 a88, v14
    v_accvgpr_read_b32 v15, a89
    v_mul_f32 v15, v12, v15
    v_accvgpr_write_b32 a89, v15
    v_accvgpr_read_b32 v13, a90
    v_mul_f32 v13, v12, v13
    v_accvgpr_write_b32 a90, v13
    v_accvgpr_read_b32 v14, a91
    v_mul_f32 v14, v12, v14
    v_accvgpr_write_b32 a91, v14
    v_accvgpr_read_b32 v15, a92
    v_mul_f32 v15, v12, v15
    v_accvgpr_write_b32 a92, v15
    v_accvgpr_read_b32 v13, a93
    v_mul_f32 v13, v12, v13
    v_accvgpr_write_b32 a93, v13
    v_accvgpr_read_b32 v14, a94
    v_mul_f32 v14, v12, v14
    v_accvgpr_write_b32 a94, v14
    v_accvgpr_read_b32 v15, a95
    v_mul_f32 v15, v12, v15
    v_accvgpr_write_b32 a95, v15
    v_accvgpr_read_b32 v13, a96
    v_mul_f32 v13, v12, v13
    v_accvgpr_write_b32 a96, v13
    v_accvgpr_read_b32 v14, a97
    v_mul_f32 v14, v12, v14
    v_accvgpr_write_b32 a97, v14
    v_accvgpr_read_b32 v15, a98
    v_mul_f32 v15, v12, v15
    v_accvgpr_write_b32 a98, v15
    v_accvgpr_read_b32 v13, a99
    v_mul_f32 v13, v12, v13
    v_accvgpr_write_b32 a99, v13
    v_accvgpr_read_b32 v14, a100
    v_mul_f32 v14, v12, v14
    v_accvgpr_write_b32 a100, v14
    v_accvgpr_read_b32 v15, a101
    v_mul_f32 v15, v12, v15
    v_accvgpr_write_b32 a101, v15
    v_accvgpr_read_b32 v13, a102
    v_mul_f32 v13, v12, v13
    v_accvgpr_write_b32 a102, v13
    v_accvgpr_read_b32 v14, a103
    v_mul_f32 v14, v12, v14
    v_accvgpr_write_b32 a103, v14
    v_accvgpr_read_b32 v15, a104
    v_mul_f32 v15, v12, v15
    v_accvgpr_write_b32 a104, v15
    v_accvgpr_read_b32 v13, a105
    v_mul_f32 v13, v12, v13
    v_accvgpr_write_b32 a105, v13
    v_accvgpr_read_b32 v14, a106
    v_mul_f32 v14, v12, v14
    v_accvgpr_write_b32 a106, v14
    v_accvgpr_read_b32 v15, a107
    v_mul_f32 v15, v12, v15
    v_accvgpr_write_b32 a107, v15
    v_accvgpr_read_b32 v13, a108
    v_mul_f32 v13, v12, v13
    v_accvgpr_write_b32 a108, v13
    v_accvgpr_read_b32 v14, a109
    v_mul_f32 v14, v12, v14
    v_accvgpr_write_b32 a109, v14
    v_accvgpr_read_b32 v15, a110
    v_mul_f32 v15, v12, v15
    v_accvgpr_write_b32 a110, v15
    v_accvgpr_read_b32 v13, a111
    v_mul_f32 v13, v12, v13
    v_accvgpr_write_b32 a111, v13
    v_mul_f32 v215, v12, v215
    v_sub_f32 v240, v240, v10
    v_sub_f32 v241, v241, v10
    v_sub_f32 v242, v242, v10
    v_sub_f32 v243, v243, v10
    v_sub_f32 v244, v244, v10
    v_sub_f32 v245, v245, v10
    v_sub_f32 v246, v246, v10
    v_sub_f32 v247, v247, v10
    v_sub_f32 v248, v248, v10
    v_sub_f32 v249, v249, v10
    v_sub_f32 v250, v250, v10
    v_sub_f32 v251, v251, v10
    v_sub_f32 v252, v252, v10
    v_sub_f32 v253, v253, v10
    v_sub_f32 v254, v254, v10
    v_sub_f32 v255, v255, v10
    v_sub_f32 v32, v32, v10
    v_sub_f32 v33, v33, v10
    v_sub_f32 v34, v34, v10
    v_sub_f32 v35, v35, v10
    v_sub_f32 v36, v36, v10
    v_sub_f32 v37, v37, v10
    v_sub_f32 v38, v38, v10
    v_sub_f32 v39, v39, v10
    v_sub_f32 v40, v40, v10
    v_sub_f32 v41, v41, v10
    v_sub_f32 v42, v42, v10
    v_sub_f32 v43, v43, v10
    v_sub_f32 v44, v44, v10
    v_sub_f32 v45, v45, v10
    v_sub_f32 v46, v46, v10
    v_sub_f32 v47, v47, v10
    v_exp_f32 v11, v32
    v_exp_f32 v13, v33
    v_add_f32 v216, v215, v11
    v_exp_f32 v14, v34
    v_add_f32 v216, v216, v13
    v_cvt_pk_bf16_f32 v56, v11, v13
    v_exp_f32 v15, v35
    v_add_f32 v216, v216, v14
    v_exp_f32 v11, v36
    v_add_f32 v216, v216, v15
    v_cvt_pk_bf16_f32 v57, v14, v15
    v_exp_f32 v13, v37
    v_add_f32 v216, v216, v11
    v_exp_f32 v14, v38
    v_add_f32 v216, v216, v13
    v_cvt_pk_bf16_f32 v58, v11, v13
    v_exp_f32 v15, v39
    v_add_f32 v216, v216, v14
    v_exp_f32 v11, v40
    v_add_f32 v216, v216, v15
    v_cvt_pk_bf16_f32 v59, v14, v15
    v_exp_f32 v13, v41
    v_add_f32 v216, v216, v11
    v_exp_f32 v14, v42
    v_add_f32 v216, v216, v13
    v_cvt_pk_bf16_f32 v60, v11, v13
    v_exp_f32 v15, v43
    v_add_f32 v216, v216, v14
    v_exp_f32 v11, v44
    v_add_f32 v216, v216, v15
    v_cvt_pk_bf16_f32 v61, v14, v15
    v_exp_f32 v13, v45
    v_add_f32 v216, v216, v11
    v_exp_f32 v14, v46
    v_add_f32 v216, v216, v13
    v_cvt_pk_bf16_f32 v62, v11, v13
    v_exp_f32 v15, v47
    v_add_f32 v216, v216, v14
    v_add_f32 v216, v216, v15
    v_cvt_pk_bf16_f32 v63, v14, v15
    s_nop 3
    s_setpc_b64 s[58:59]
L_rare20:
    s_nop 15
    s_nop 15
    s_waitcnt lgkmcnt(0)
    v_max_f32 v10, v16, v17
    v_max3_f32 v10, v10, v18, v19
    v_max3_f32 v10, v10, v20, v21
    v_max3_f32 v10, v10, v22, v23
    v_max3_f32 v10, v10, v24, v25
    v_max3_f32 v10, v10, v26, v27
    v_max3_f32 v10, v10, v28, v29
    v_max3_f32 v10, v10, v30, v31
    v_mov_b32 v11, v10
    s_nop 1
    v_permlane32_swap_b32 v10, v11
    v_max_f32 v10, v10, v11
    v_max_f32 v10, 0, v10
    v_exp_f32_e64 v12, -v10
    s_nop 0
    v_mul_f32 v64, v12, v64
    v_mul_f32 v65, v12, v65
    v_mul_f32 v66, v12, v66
    v_mul_f32 v67, v12, v67
    v_mul_f32 v68, v12, v68
    v_mul_f32 v69, v12, v69
    v_mul_f32 v70, v12, v70
    v_mul_f32 v71, v12, v71
    v_mul_f32 v72, v12, v72
    v_mul_f32 v73, v12, v73
    v_mul_f32 v74, v12, v74
    v_mul_f32 v75, v12, v75
    v_mul_f32 v76, v12, v76
    v_mul_f32 v77, v12, v77
    v_mul_f32 v78, v12, v78
    v_mul_f32 v79, v12, v79
    v_mul_f32 v80, v12, v80
    v_mul_f32 v81, v12, v81
    v_mul_f32 v82, v12, v82
    v_mul_f32 v83, v12, v83
    v_mul_f32 v84, v12, v84
    v_mul_f32 v85, v12, v85
    v_mul_f32 v86, v12, v86
    v_mul_f32 v87, v12, v87
    v_mul_f32 v88, v12, v88
    v_mul_f32 v89, v12, v89
    v_mul_f32 v90, v12, v90
    v_mul_f32 v91, v12, v91
    v_mul_f32 v92, v12, v92
    v_mul_f32 v93, v12, v93
    v_mul_f32 v94, v12, v94
    v_mul_f32 v95, v12, v95
    v_mul_f32 v96, v12, v96
    v_mul_f32 v97, v12, v97
    v_mul_f32 v98, v12, v98
    v_mul_f32 v99, v12, v99
    v_mul_f32 v100, v12, v100
    v_mul_f32 v101, v12, v101
    v_mul_f32 v102, v12, v102
    v_mul_f32 v103, v12, v103
    v_mul_f32 v104, v12, v104
    v_mul_f32 v105, v12, v105
    v_mul_f32 v106, v12, v106
    v_mul_f32 v107, v12, v107
    v_mul_f32 v108, v12, v108
    v_mul_f32 v109, v12, v109
    v_mul_f32 v110, v12, v110
    v_mul_f32 v111, v12, v111
    v_mul_f32 v112, v12, v112
    v_mul_f32 v113, v12, v113
    v_mul_f32 v114, v12, v114
    v_mul_f32 v115, v12, v115
    v_mul_f32 v116, v12, v116
    v_mul_f32 v117, v12, v117
    v_mul_f32 v118, v12, v118
    v_mul_f32 v119, v12, v119
    v_mul_f32 v120, v12, v120
    v_mul_f32 v121, v12, v121
    v_mul_f32 v122, v12, v122
    v_mul_f32 v123, v12, v123
    v_mul_f32 v124, v12, v124
    v_mul_f32 v125, v12, v125
    v_mul_f32 v126, v12, v126
    v_mul_f32 v127, v12, v127
    v_mul_f32 v214, v12, v214
    v_sub_f32 v224, v224, v10
    v_sub_f32 v225, v225, v10
    v_sub_f32 v226, v226, v10
    v_sub_f32 v227, v227, v10
    v_sub_f32 v228, v228, v10
    v_sub_f32 v229, v229, v10
    v_sub_f32 v230, v230, v10
    v_sub_f32 v231, v231, v10
    v_sub_f32 v232, v232, v10
    v_sub_f32 v233, v233, v10
    v_sub_f32 v234, v234, v10
    v_sub_f32 v235, v235, v10
    v_sub_f32 v236, v236, v10
    v_sub_f32 v237, v237, v10
    v_sub_f32 v238, v238, v10
    v_sub_f32 v239, v239, v10
    v_sub_f32 v16, v16, v10
    v_sub_f32 v17, v17, v10
    v_sub_f32 v18, v18, v10
    v_sub_f32 v19, v19, v10
    v_sub_f32 v20, v20, v10
    v_sub_f32 v21, v21, v10
    v_sub_f32 v22, v22, v10
    v_sub_f32 v23, v23, v10
    v_sub_f32 v24, v24, v10
    v_sub_f32 v25, v25, v10
    v_sub_f32 v26, v26, v10
    v_sub_f32 v27, v27, v10
    v_sub_f32 v28, v28, v10
    v_sub_f32 v29, v29, v10
    v_sub_f32 v30, v30, v10
    v_sub_f32 v31, v31, v10
    v_exp_f32 v11, v16
    v_exp_f32 v13, v17
    v_add_f32 v213, v214, v11
    v_exp_f32 v14, v18
    v_add_f32 v213, v213, v13
    v_cvt_pk_bf16_f32 v48, v11, v13
    v_exp_f32 v15, v19
    v_add_f32 v213, v213, v14
    v_exp_f32 v11, v20
    v_add_f32 v213, v213, v15
    v_cvt_pk_bf16_f32 v49, v14, v15
    v_exp_f32 v13, v21
    v_add_f32 v213, v213, v11
    v_exp_f32 v14, v22
    v_add_f32 v213, v213, v13
    v_cvt_pk_bf16_f32 v50, v11, v13
    v_exp_f32 v15, v23
    v_add_f32 v213, v213, v14
    v_exp_f32 v11, v24
    v_add_f32 v213, v213, v15
    v_cvt_pk_bf16_f32 v51, v14, v15
    v_exp_f32 v13, v25
    v_add_f32 v213, v213, v11
    v_exp_f32 v14, v26
    v_add_f32 v213, v213, v13
    v_cvt_pk_bf16_f32 v52, v11, v13
    v_exp_f32 v15, v27
    v_add_f32 v213, v213, v14
    v_exp_f32 v11, v28
    v_add_f32 v213, v213, v15
    v_cvt_pk_bf16_f32 v53, v14, v15
    v_exp_f32 v13, v29
    v_add_f32 v213, v213, v11
    v_exp_f32 v14, v30
    v_add_f32 v213, v213, v13
    v_cvt_pk_bf16_f32 v54, v11, v13
    v_exp_f32 v15, v31
    v_add_f32 v213, v213, v14
    v_add_f32 v213, v213, v15
    v_cvt_pk_bf16_f32 v55, v14, v15
    s_nop 3
    s_setpc_b64 s[58:59]
L_rare21:
    s_nop 15
    s_nop 15
    s_waitcnt lgkmcnt(0)
    v_max_f32 v10, v32, v33
    v_max3_f32 v10, v10, v34, v35
    v_max3_f32 v10, v10, v36, v37
    v_max3_f32 v10, v10, v38, v39
    v_max3_f32 v10, v10, v40, v41
    v_max3_f32 v10, v10, v42, v43
    v_max3_f32 v10, v10, v44, v45
    v_max3_f32 v10, v10, v46, v47
    v_mov_b32 v11, v10
    s_nop 1
    v_permlane32_swap_b32 v10, v11
    v_max_f32 v10, v10, v11
    v_max_f32 v10, 0, v10
    v_exp_f32_e64 v12, -v10
    s_nop 0
    v_mul_f32 v128, v12, v128
    v_mul_f32 v129, v12, v129
    v_mul_f32 v130, v12, v130
    v_mul_f32 v131, v12, v131
    v_mul_f32 v132, v12, v132
    v_mul_f32 v133, v12, v133
    v_mul_f32 v134, v12, v134
    v_mul_f32 v135, v12, v135
    v_mul_f32 v136, v12, v136
    v_mul_f32 v137, v12, v137
    v_mul_f32 v138, v12, v138
    v_mul_f32 v139, v12, v139
    v_mul_f32 v140, v12, v140
    v_mul_f32 v141, v12, v141
    v_mul_f32 v142, v12, v142
    v_mul_f32 v143, v12, v143
    v_mul_f32 v144, v12, v144
    v_mul_f32 v145, v12, v145
    v_mul_f32 v146, v12, v146
    v_mul_f32 v147, v12, v147
    v_mul_f32 v148, v12, v148
    v_mul_f32 v149, v12, v149
    v_mul_f32 v150, v12, v150
    v_mul_f32 v151, v12, v151
    v_mul_f32 v152, v12, v152
    v_mul_f32 v153, v12, v153
    v_mul_f32 v154, v12, v154
    v_mul_f32 v155, v12, v155
    v_mul_f32 v156, v12, v156
    v_mul_f32 v157, v12, v157
    v_mul_f32 v158, v12, v158
    v_mul_f32 v159, v12, v159
    v_accvgpr_read_b32 v15, a80
    v_mul_f32 v15, v12, v15
    v_accvgpr_write_b32 a80, v15
    v_accvgpr_read_b32 v13, a81
    v_mul_f32 v13, v12, v13
    v_accvgpr_write_b32 a81, v13
    v_accvgpr_read_b32 v14, a82
    v_mul_f32 v14, v12, v14
    v_accvgpr_write_b32 a82, v14
    v_accvgpr_read_b32 v15, a83
    v_mul_f32 v15, v12, v15
    v_accvgpr_write_b32 a83, v15
    v_accvgpr_read_b32 v13, a84
    v_mul_f32 v13, v12, v13
    v_accvgpr_write_b32 a84, v13
    v_accvgpr_read_b32 v14, a85
    v_mul_f32 v14, v12, v14
    v_accvgpr_write_b32 a85, v14
    v_accvgpr_read_b32 v15, a86
    v_mul_f32 v15, v12, v15
    v_accvgpr_write_b32 a86, v15
    v_accvgpr_read_b32 v13, a87
    v_mul_f32 v13, v12, v13
    v_accvgpr_write_b32 a87, v13
    v_accvgpr_read_b32 v14, a88
    v_mul_f32 v14, v12, v14
    v_accvgpr_write_b32 a88, v14
    v_accvgpr_read_b32 v15, a89
    v_mul_f32 v15, v12, v15
    v_accvgpr_write_b32 a89, v15
    v_accvgpr_read_b32 v13, a90
    v_mul_f32 v13, v12, v13
    v_accvgpr_write_b32 a90, v13
    v_accvgpr_read_b32 v14, a91
    v_mul_f32 v14, v12, v14
    v_accvgpr_write_b32 a91, v14
    v_accvgpr_read_b32 v15, a92
    v_mul_f32 v15, v12, v15
    v_accvgpr_write_b32 a92, v15
    v_accvgpr_read_b32 v13, a93
    v_mul_f32 v13, v12, v13
    v_accvgpr_write_b32 a93, v13
    v_accvgpr_read_b32 v14, a94
    v_mul_f32 v14, v12, v14
    v_accvgpr_write_b32 a94, v14
    v_accvgpr_read_b32 v15, a95
    v_mul_f32 v15, v12, v15
    v_accvgpr_write_b32 a95, v15
    v_accvgpr_read_b32 v13, a96
    v_mul_f32 v13, v12, v13
    v_accvgpr_write_b32 a96, v13
    v_accvgpr_read_b32 v14, a97
    v_mul_f32 v14, v12, v14
    v_accvgpr_write_b32 a97, v14
    v_accvgpr_read_b32 v15, a98
    v_mul_f32 v15, v12, v15
    v_accvgpr_write_b32 a98, v15
    v_accvgpr_read_b32 v13, a99
    v_mul_f32 v13, v12, v13
    v_accvgpr_write_b32 a99, v13
    v_accvgpr_read_b32 v14, a100
    v_mul_f32 v14, v12, v14
    v_accvgpr_write_b32 a100, v14
    v_accvgpr_read_b32 v15, a101
    v_mul_f32 v15, v12, v15
    v_accvgpr_write_b32 a101, v15
    v_accvgpr_read_b32 v13, a102
    v_mul_f32 v13, v12, v13
    v_accvgpr_write_b32 a102, v13
    v_accvgpr_read_b32 v14, a103
    v_mul_f32 v14, v12, v14
    v_accvgpr_write_b32 a103, v14
    v_accvgpr_read_b32 v15, a104
    v_mul_f32 v15, v12, v15
    v_accvgpr_write_b32 a104, v15
    v_accvgpr_read_b32 v13, a105
    v_mul_f32 v13, v12, v13
    v_accvgpr_write_b32 a105, v13
    v_accvgpr_read_b32 v14, a106
    v_mul_f32 v14, v12, v14
    v_accvgpr_write_b32 a106, v14
    v_accvgpr_read_b32 v15, a107
    v_mul_f32 v15, v12, v15
    v_accvgpr_write_b32 a107, v15
    v_accvgpr_read_b32 v13, a108
    v_mul_f32 v13, v12, v13
    v_accvgpr_write_b32 a108, v13
    v_accvgpr_read_b32 v14, a109
    v_mul_f32 v14, v12, v14
    v_accvgpr_write_b32 a109, v14
    v_accvgpr_read_b32 v15, a110
    v_mul_f32 v15, v12, v15
    v_accvgpr_write_b32 a110, v15
    v_accvgpr_read_b32 v13, a111
    v_mul_f32 v13, v12, v13
    v_accvgpr_write_b32 a111, v13
    v_mul_f32 v216, v12, v216
    v_sub_f32 v240, v240, v10
    v_sub_f32 v241, v241, v10
    v_sub_f32 v242, v242, v10
    v_sub_f32 v243, v243, v10
    v_sub_f32 v244, v244, v10
    v_sub_f32 v245, v245, v10
    v_sub_f32 v246, v246, v10
    v_sub_f32 v247, v247, v10
    v_sub_f32 v248, v248, v10
    v_sub_f32 v249, v249, v10
    v_sub_f32 v250, v250, v10
    v_sub_f32 v251, v251, v10
    v_sub_f32 v252, v252, v10
    v_sub_f32 v253, v253, v10
    v_sub_f32 v254, v254, v10
    v_sub_f32 v255, v255, v10
    v_sub_f32 v32, v32, v10
    v_sub_f32 v33, v33, v10
    v_sub_f32 v34, v34, v10
    v_sub_f32 v35, v35, v10
    v_sub_f32 v36, v36, v10
    v_sub_f32 v37, v37, v10
    v_sub_f32 v38, v38, v10
    v_sub_f32 v39, v39, v10
    v_sub_f32 v40, v40, v10
    v_sub_f32 v41, v41, v10
    v_sub_f32 v42, v42, v10
    v_sub_f32 v43, v43, v10
    v_sub_f32 v44, v44, v10
    v_sub_f32 v45, v45, v10
    v_sub_f32 v46, v46, v10
    v_sub_f32 v47, v47, v10
    v_exp_f32 v11, v32
    v_exp_f32 v13, v33
    v_add_f32 v215, v216, v11
    v_exp_f32 v14, v34
    v_add_f32 v215, v215, v13
    v_cvt_pk_bf16_f32 v56, v11, v13
    v_exp_f32 v15, v35
    v_add_f32 v215, v215, v14
    v_exp_f32 v11, v36
    v_add_f32 v215, v215, v15
    v_cvt_pk_bf16_f32 v57, v14, v15
    v_exp_f32 v13, v37
    v_add_f32 v215, v215, v11
    v_exp_f32 v14, v38
    v_add_f32 v215, v215, v13
    v_cvt_pk_bf16_f32 v58, v11, v13
    v_exp_f32 v15, v39
    v_add_f32 v215, v215, v14
    v_exp_f32 v11, v40
    v_add_f32 v215, v215, v15
    v_cvt_pk_bf16_f32 v59, v14, v15
    v_exp_f32 v13, v41
    v_add_f32 v215, v215, v11
    v_exp_f32 v14, v42
    v_add_f32 v215, v215, v13
    v_cvt_pk_bf16_f32 v60, v11, v13
    v_exp_f32 v15, v43
    v_add_f32 v215, v215, v14
    v_exp_f32 v11, v44
    v_add_f32 v215, v215, v15
    v_cvt_pk_bf16_f32 v61, v14, v15
    v_exp_f32 v13, v45
    v_add_f32 v215, v215, v11
    v_exp_f32 v14, v46
    v_add_f32 v215, v215, v13
    v_cvt_pk_bf16_f32 v62, v11, v13
    v_exp_f32 v15, v47
    v_add_f32 v215, v215, v14
    v_add_f32 v215, v215, v15
    v_cvt_pk_bf16_f32 v63, v14, v15
    s_nop 3
    s_setpc_b64 s[58:59]
L_rare22:
    s_nop 15
    s_nop 15
    s_waitcnt lgkmcnt(0)
    v_max_f32 v10, v16, v17
    v_max3_f32 v10, v10, v18, v19
    v_max3_f32 v10, v10, v20, v21
    v_max3_f32 v10, v10, v22, v23
    v_max3_f32 v10, v10, v24, v25
    v_max3_f32 v10, v10, v26, v27
    v_max3_f32 v10, v10, v28, v29
    v_max3_f32 v10, v10, v30, v31
    v_mov_b32 v11, v10
    s_nop 1
    v_permlane32_swap_b32 v10, v11
    v_max_f32 v10, v10, v11
    v_max_f32 v10, 0, v10
    v_exp_f32_e64 v12, -v10
    s_nop 0
    v_mul_f32 v64, v12, v64
    v_mul_f32 v65, v12, v65
    v_mul_f32 v66, v12, v66
    v_mul_f32 v67, v12, v67
    v_mul_f32 v68, v12, v68
    v_mul_f32 v69, v12, v69
    v_mul_f32 v70, v12, v70
    v_mul_f32 v71, v12, v71
    v_mul_f32 v72, v12, v72
    v_mul_f32 v73, v12, v73
    v_mul_f32 v74, v12, v74
    v_mul_f32 v75, v12, v75
    v_mul_f32 v76, v12, v76
    v_mul_f32 v77, v12, v77
    v_mul_f32 v78, v12, v78
    v_mul_f32 v79, v12, v79
    v_mul_f32 v80, v12, v80
    v_mul_f32 v81, v12, v81
    v_mul_f32 v82, v12, v82
    v_mul_f32 v83, v12, v83
    v_mul_f32 v84, v12, v84
    v_mul_f32 v85, v12, v85
    v_mul_f32 v86, v12, v86
    v_mul_f32 v87, v12, v87
    v_mul_f32 v88, v12, v88
    v_mul_f32 v89, v12, v89
    v_mul_f32 v90, v12, v90
    v_mul_f32 v91, v12, v91
    v_mul_f32 v92, v12, v92
    v_mul_f32 v93, v12, v93
    v_mul_f32 v94, v12, v94
    v_mul_f32 v95, v12, v95
    v_mul_f32 v96, v12, v96
    v_mul_f32 v97, v12, v97
    v_mul_f32 v98, v12, v98
    v_mul_f32 v99, v12, v99
    v_mul_f32 v100, v12, v100
    v_mul_f32 v101, v12, v101
    v_mul_f32 v102, v12, v102
    v_mul_f32 v103, v12, v103
    v_mul_f32 v104, v12, v104
    v_mul_f32 v105, v12, v105
    v_mul_f32 v106, v12, v106
    v_mul_f32 v107, v12, v107
    v_mul_f32 v108, v12, v108
    v_mul_f32 v109, v12, v109
    v_mul_f32 v110, v12, v110
    v_mul_f32 v111, v12, v111
    v_mul_f32 v112, v12, v112
    v_mul_f32 v113, v12, v113
    v_mul_f32 v114, v12, v114
    v_mul_f32 v115, v12, v115
    v_mul_f32 v116, v12, v116
    v_mul_f32 v117, v12, v117
    v_mul_f32 v118, v12, v118
    v_mul_f32 v119, v12, v119
    v_mul_f32 v120, v12, v120
    v_mul_f32 v121, v12, v121
    v_mul_f32 v122, v12, v122
    v_mul_f32 v123, v12, v123
    v_mul_f32 v124, v12, v124
    v_mul_f32 v125, v12, v125
    v_mul_f32 v126, v12, v126
    v_mul_f32 v127, v12, v127
    v_mul_f32 v213, v12, v213
    v_sub_f32 v224, v224, v10
    v_sub_f32 v225, v225, v10
    v_sub_f32 v226, v226, v10
    v_sub_f32 v227, v227, v10
    v_sub_f32 v228, v228, v10
    v_sub_f32 v229, v229, v10
    v_sub_f32 v230, v230, v10
    v_sub_f32 v231, v231, v10
    v_sub_f32 v232, v232, v10
    v_sub_f32 v233, v233, v10
    v_sub_f32 v234, v234, v10
    v_sub_f32 v235, v235, v10
    v_sub_f32 v236, v236, v10
    v_sub_f32 v237, v237, v10
    v_sub_f32 v238, v238, v10
    v_sub_f32 v239, v239, v10
    v_sub_f32 v16, v16, v10
    v_sub_f32 v17, v17, v10
    v_sub_f32 v18, v18, v10
    v_sub_f32 v19, v19, v10
    v_sub_f32 v20, v20, v10
    v_sub_f32 v21, v21, v10
    v_sub_f32 v22, v22, v10
    v_sub_f32 v23, v23, v10
    v_sub_f32 v24, v24, v10
    v_sub_f32 v25, v25, v10
    v_sub_f32 v26, v26, v10
    v_sub_f32 v27, v27, v10
    v_sub_f32 v28, v28, v10
    v_sub_f32 v29, v29, v10
    v_sub_f32 v30, v30, v10
    v_sub_f32 v31, v31, v10
    v_sub_f32 v32, v32, v10
    v_sub_f32 v33, v33, v10
    v_sub_f32 v34, v34, v10
    v_sub_f32 v35, v35, v10
    v_sub_f32 v36, v36, v10
    v_sub_f32 v37, v37, v10
    v_sub_f32 v38, v38, v10
    v_sub_f32 v39, v39, v10
    v_sub_f32 v40, v40, v10
    v_sub_f32 v41, v41, v10
    v_sub_f32 v42, v42, v10
    v_sub_f32 v43, v43, v10
    v_sub_f32 v44, v44, v10
    v_sub_f32 v45, v45, v10
    v_sub_f32 v46, v46, v10
    v_sub_f32 v47, v47, v10
    v_exp_f32 v11, v16
    v_exp_f32 v13, v17
    v_add_f32 v214, v213, v11
    v_exp_f32 v14, v18
    v_add_f32 v214, v214, v13
    v_cvt_pk_bf16_f32 v48, v11, v13
    v_exp_f32 v15, v19
    v_add_f32 v214, v214, v14
    v_exp_f32 v11, v20
    v_add_f32 v214, v214, v15
    v_cvt_pk_bf16_f32 v49, v14, v15
    v_exp_f32 v13, v21
    v_add_f32 v214, v214, v11
    v_exp_f32 v14, v22
    v_add_f32 v214, v214, v13
    v_cvt_pk_bf16_f32 v50, v11, v13
    v_exp_f32 v15, v23
    v_add_f32 v214, v214, v14
    v_exp_f32 v11, v24
    v_add_f32 v214, v214, v15
    v_cvt_pk_bf16_f32 v51, v14, v15
    v_exp_f32 v13, v25
    v_add_f32 v214, v214, v11
    v_exp_f32 v14, v26
    v_add_f32 v214, v214, v13
    v_cvt_pk_bf16_f32 v52, v11, v13
    v_exp_f32 v15, v27
    v_add_f32 v214, v214, v14
    v_exp_f32 v11, v28
    v_add_f32 v214, v214, v15
    v_cvt_pk_bf16_f32 v53, v14, v15
    v_exp_f32 v13, v29
    v_add_f32 v214, v214, v11
    v_exp_f32 v14, v30
    v_add_f32 v214, v214, v13
    v_cvt_pk_bf16_f32 v54, v11, v13
    v_exp_f32 v15, v31
    v_add_f32 v214, v214, v14
    v_add_f32 v214, v214, v15
    v_cvt_pk_bf16_f32 v55, v14, v15
    s_nop 3
    s_setpc_b64 s[58:59]
L_rare23:
    s_nop 15
    s_nop 15
    s_waitcnt lgkmcnt(0)
    v_max_f32 v10, v32, v33
    v_max3_f32 v10, v10, v34, v35
    v_max3_f32 v10, v10, v36, v37
    v_max3_f32 v10, v10, v38, v39
    v_max3_f32 v10, v10, v40, v41
    v_max3_f32 v10, v10, v42, v43
    v_max3_f32 v10, v10, v44, v45
    v_max3_f32 v10, v10, v46, v47
    v_mov_b32 v11, v10
    s_nop 1
    v_permlane32_swap_b32 v10, v11
    v_max_f32 v10, v10, v11
    v_max_f32 v10, 0, v10
    v_exp_f32_e64 v12, -v10
    s_nop 0
    v_mul_f32 v64, v12, v64
    v_mul_f32 v65, v12, v65
    v_mul_f32 v66, v12, v66
    v_mul_f32 v67, v12, v67
    v_mul_f32 v68, v12, v68
    v_mul_f32 v69, v12, v69
    v_mul_f32 v70, v12, v70
    v_mul_f32 v71, v12, v71
    v_mul_f32 v72, v12, v72
    v_mul_f32 v73, v12, v73
    v_mul_f32 v74, v12, v74
    v_mul_f32 v75, v12, v75
    v_mul_f32 v76, v12, v76
    v_mul_f32 v77, v12, v77
    v_mul_f32 v78, v12, v78
    v_mul_f32 v79, v12, v79
    v_mul_f32 v80, v12, v80
    v_mul_f32 v81, v12, v81
    v_mul_f32 v82, v12, v82
    v_mul_f32 v83, v12, v83
    v_mul_f32 v84, v12, v84
    v_mul_f32 v85, v12, v85
    v_mul_f32 v86, v12, v86
    v_mul_f32 v87, v12, v87
    v_mul_f32 v88, v12, v88
    v_mul_f32 v89, v12, v89
    v_mul_f32 v90, v12, v90
    v_mul_f32 v91, v12, v91
    v_mul_f32 v92, v12, v92
    v_mul_f32 v93, v12, v93
    v_mul_f32 v94, v12, v94
    v_mul_f32 v95, v12, v95
    v_mul_f32 v96, v12, v96
    v_mul_f32 v97, v12, v97
    v_mul_f32 v98, v12, v98
    v_mul_f32 v99, v12, v99
    v_mul_f32 v100, v12, v100
    v_mul_f32 v101, v12, v101
    v_mul_f32 v102, v12, v102
    v_mul_f32 v103, v12, v103
    v_mul_f32 v104, v12, v104
    v_mul_f32 v105, v12, v105
    v_mul_f32 v106, v12, v106
    v_mul_f32 v107, v12, v107
    v_mul_f32 v108, v12, v108
    v_mul_f32 v109, v12, v109
    v_mul_f32 v110, v12, v110
    v_mul_f32 v111, v12, v111
    v_mul_f32 v112, v12, v112
    v_mul_f32 v113, v12, v113
    v_mul_f32 v114, v12, v114
    v_mul_f32 v115, v12, v115
    v_mul_f32 v116, v12, v116
    v_mul_f32 v117, v12, v117
    v_mul_f32 v118, v12, v118
    v_mul_f32 v119, v12, v119
    v_mul_f32 v120, v12, v120
    v_mul_f32 v121, v12, v121
    v_mul_f32 v122, v12, v122
    v_mul_f32 v123, v12, v123
    v_mul_f32 v124, v12, v124
    v_mul_f32 v125, v12, v125
    v_mul_f32 v126, v12, v126
    v_mul_f32 v127, v12, v127
    v_mul_f32 v214, v12, v214
    v_sub_f32 v224, v224, v10
    v_sub_f32 v225, v225, v10
    v_sub_f32 v226, v226, v10
    v_sub_f32 v227, v227, v10
    v_sub_f32 v228, v228, v10
    v_sub_f32 v229, v229, v10
    v_sub_f32 v230, v230, v10
    v_sub_f32 v231, v231, v10
    v_sub_f32 v232, v232, v10
    v_sub_f32 v233, v233, v10
    v_sub_f32 v234, v234, v10
    v_sub_f32 v235, v235, v10
    v_sub_f32 v236, v236, v10
    v_sub_f32 v237, v237, v10
    v_sub_f32 v238, v238, v10
    v_sub_f32 v239, v239, v10
    v_sub_f32 v32, v32, v10
    v_sub_f32 v33, v33, v10
    v_sub_f32 v34, v34, v10
    v_sub_f32 v35, v35, v10
    v_sub_f32 v36, v36, v10
    v_sub_f32 v37, v37, v10
    v_sub_f32 v38, v38, v10
    v_sub_f32 v39, v39, v10
    v_sub_f32 v40, v40, v10
    v_sub_f32 v41, v41, v10
    v_sub_f32 v42, v42, v10
    v_sub_f32 v43, v43, v10
    v_sub_f32 v44, v44, v10
    v_sub_f32 v45, v45, v10
    v_sub_f32 v46, v46, v10
    v_sub_f32 v47, v47, v10
    v_exp_f32 v11, v32
    v_exp_f32 v13, v33
    v_add_f32 v213, v214, v11
    v_exp_f32 v14, v34
    v_add_f32 v213, v213, v13
    v_cvt_pk_bf16_f32 v56, v11, v13
    v_exp_f32 v15, v35
    v_add_f32 v213, v213, v14
    v_exp_f32 v11, v36
    v_add_f32 v213, v213, v15
    v_cvt_pk_bf16_f32 v57, v14, v15
    v_exp_f32 v13, v37
    v_add_f32 v213, v213, v11
    v_exp_f32 v14, v38
    v_add_f32 v213, v213, v13
    v_cvt_pk_bf16_f32 v58, v11, v13
    v_exp_f32 v15, v39
    v_add_f32 v213, v213, v14
    v_exp_f32 v11, v40
    v_add_f32 v213, v213, v15
    v_cvt_pk_bf16_f32 v59, v14, v15
    v_exp_f32 v13, v41
    v_add_f32 v213, v213, v11
    v_exp_f32 v14, v42
    v_add_f32 v213, v213, v13
    v_cvt_pk_bf16_f32 v60, v11, v13
    v_exp_f32 v15, v43
    v_add_f32 v213, v213, v14
    v_exp_f32 v11, v44
    v_add_f32 v213, v213, v15
    v_cvt_pk_bf16_f32 v61, v14, v15
    v_exp_f32 v13, v45
    v_add_f32 v213, v213, v11
    v_exp_f32 v14, v46
    v_add_f32 v213, v213, v13
    v_cvt_pk_bf16_f32 v62, v11, v13
    v_exp_f32 v15, v47
    v_add_f32 v213, v213, v14
    v_add_f32 v213, v213, v15
    v_cvt_pk_bf16_f32 v63, v14, v15
    s_nop 3
    s_setpc_b64 s[58:59]
L_rareT6:
    s_nop 15
    s_nop 15
    s_waitcnt lgkmcnt(0)
    v_max_f32 v10, v160, v161
    v_max3_f32 v10, v10, v162, v163
    v_max3_f32 v10, v10, v164, v165
    v_max3_f32 v10, v10, v166, v167
    ds_bpermute_b32 v11, v219, v10
    s_waitcnt lgkmcnt(0)
    v_max_f32 v10, v10, v11
    v_mov_b32 v11, v10
    s_nop 1
    v_permlane32_swap_b32 v10, v11
    v_max_f32 v10, v10, v11
    v_max_f32 v10, 0, v10
    v_exp_f32_e64 v12, -v10
    v_accvgpr_read_b32 v13, a112
    v_mul_f32 v13, v12, v13
    v_accvgpr_write_b32 a112, v13
    v_accvgpr_read_b32 v14, a113
    v_mul_f32 v14, v12, v14
    v_accvgpr_write_b32 a113, v14
    v_accvgpr_read_b32 v15, a114
    v_mul_f32 v15, v12, v15
    v_accvgpr_write_b32 a114, v15
    v_accvgpr_read_b32 v13, a115
    v_mul_f32 v13, v12, v13
    v_accvgpr_write_b32 a115, v13
    v_accvgpr_read_b32 v14, a116
    v_mul_f32 v14, v12, v14
    v_accvgpr_write_b32 a116, v14
    v_accvgpr_read_b32 v15, a117
    v_mul_f32 v15, v12, v15
    v_accvgpr_write_b32 a117, v15
    v_accvgpr_read_b32 v13, a118
    v_mul_f32 v13, v12, v13
    v_accvgpr_write_b32 a118, v13
    v_accvgpr_read_b32 v14, a119
    v_mul_f32 v14, v12, v14
    v_accvgpr_write_b32 a119, v14
    v_accvgpr_read_b32 v15, a120
    v_mul_f32 v15, v12, v15
    v_accvgpr_write_b32 a120, v15
    v_accvgpr_read_b32 v13, a121
    v_mul_f32 v13, v12, v13
    v_accvgpr_write_b32 a121, v13
    v_accvgpr_read_b32 v14, a122
    v_mul_f32 v14, v12, v14
    v_accvgpr_write_b32 a122, v14
    v_accvgpr_read_b32 v15, a123
    v_mul_f32 v15, v12, v15
    v_accvgpr_write_b32 a123, v15
    v_accvgpr_read_b32 v13, a124
    v_mul_f32 v13, v12, v13
    v_accvgpr_write_b32 a124, v13
    v_accvgpr_read_b32 v14, a125
    v_mul_f32 v14, v12, v14
    v_accvgpr_write_b32 a125, v14
    v_accvgpr_read_b32 v15, a126
    v_mul_f32 v15, v12, v15
    v_accvgpr_write_b32 a126, v15
    v_accvgpr_read_b32 v13, a127
    v_mul_f32 v13, v12, v13
    v_accvgpr_write_b32 a127, v13
    v_accvgpr_read_b32 v14, a128
    v_mul_f32 v14, v12, v14
    v_accvgpr_write_b32 a128, v14
    v_accvgpr_read_b32 v15, a129
    v_mul_f32 v15, v12, v15
    v_accvgpr_write_b32 a129, v15
    v_accvgpr_read_b32 v13, a130
    v_mul_f32 v13, v12, v13
    v_accvgpr_write_b32 a130, v13
    v_accvgpr_read_b32 v14, a131
    v_mul_f32 v14, v12, v14
    v_accvgpr_write_b32 a131, v14
    v_accvgpr_read_b32 v15, a132
    v_mul_f32 v15, v12, v15
    v_accvgpr_write_b32 a132, v15
    v_accvgpr_read_b32 v13, a133
    v_mul_f32 v13, v12, v13
    v_accvgpr_write_b32 a133, v13
    v_accvgpr_read_b32 v14, a134
    v_mul_f32 v14, v12, v14
    v_accvgpr_write_b32 a134, v14
    v_accvgpr_read_b32 v15, a135
    v_mul_f32 v15, v12, v15
    v_accvgpr_write_b32 a135, v15
    v_accvgpr_read_b32 v13, a136
    v_mul_f32 v13, v12, v13
    v_accvgpr_write_b32 a136, v13
    v_accvgpr_read_b32 v14, a137
    v_mul_f32 v14, v12, v14
    v_accvgpr_write_b32 a137, v14
    v_accvgpr_read_b32 v15, a138
    v_mul_f32 v15, v12, v15
    v_accvgpr_write_b32 a138, v15
    v_accvgpr_read_b32 v13, a139
    v_mul_f32 v13, v12, v13
    v_accvgpr_write_b32 a139, v13
    v_accvgpr_read_b32 v14, a140
    v_mul_f32 v14, v12, v14
    v_accvgpr_write_b32 a140, v14
    v_accvgpr_read_b32 v15, a141
    v_mul_f32 v15, v12, v15
    v_accvgpr_write_b32 a141, v15
    v_accvgpr_read_b32 v13, a142
    v_mul_f32 v13, v12, v13
    v_accvgpr_write_b32 a142, v13
    v_accvgpr_read_b32 v14, a143
    v_mul_f32 v14, v12, v14
    v_accvgpr_write_b32 a143, v14
    v_mul_f32 v217, v12, v217
    v_sub_f32 v172, v172, v10
    v_sub_f32 v173, v173, v10
    v_sub_f32 v174, v174, v10
    v_sub_f32 v175, v175, v10
    v_sub_f32 v160, v160, v10
    v_sub_f32 v161, v161, v10
    v_sub_f32 v162, v162, v10
    v_sub_f32 v163, v163, v10
    v_sub_f32 v164, v164, v10
    v_sub_f32 v165, v165, v10
    v_sub_f32 v166, v166, v10
    v_sub_f32 v167, v167, v10
    v_exp_f32 v11, v160
    v_exp_f32 v13, v161
    v_add_f32 v218, v217, v11
    v_exp_f32 v14, v162
    v_add_f32 v218, v218, v13
    v_cvt_pk_bf16_f32 v168, v11, v13
    v_exp_f32 v15, v163
    v_add_f32 v218, v218, v14
    v_exp_f32 v11, v164
    v_add_f32 v218, v218, v15
    v_cvt_pk_bf16_f32 v169, v14, v15
    v_exp_f32 v13, v165
    v_add_f32 v218, v218, v11
    v_exp_f32 v14, v166
    v_add_f32 v218, v218, v13
    v_cvt_pk_bf16_f32 v170, v11, v13
    v_exp_f32 v15, v167
    v_add_f32 v218, v218, v14
    v_add_f32 v218, v218, v15
    v_cvt_pk_bf16_f32 v171, v14, v15
    s_nop 3
    s_setpc_b64 s[58:59]
L_codeend:
.section .rodata,"a"
.p2align 6
.amdhsa_kernel standalone__mha_block_cached__near_ridge_kernel
  .amdhsa_next_free_vgpr 512
  .amdhsa_next_free_sgpr 102
  .amdhsa_accum_offset 256
  .amdhsa_group_segment_fixed_size 0
  .amdhsa_kernarg_size 64
  .amdhsa_user_sgpr_count 2
  .amdhsa_user_sgpr_kernarg_segment_ptr 1
  .amdhsa_system_sgpr_workgroup_id_x 1
.end_amdhsa_kernel
```
